```python
import torch

def _softmax(x, axis=-1):
    return torch.softmax(x, dim=axis)

def _gelu(x):
    return torch.nn.functional.gelu(x, approximate='tanh')

def _silu(x):
    return torch.nn.functional.silu(x)

def _sigmoid(x):
    return torch.sigmoid(x)

def _layernorm(x, axis=-1, eps=1e-05):
    m = x.mean(dim=axis, keepdim=True)
    v = x.var(dim=axis, keepdim=True, unbiased=False)
    return (x - m) / torch.sqrt(v + eps)

def _scatter_add(tgt, idx, src, axis=0):
    return tgt.clone().index_add_(axis, idx, src)

def _segment_sum(src, seg, n):
    out = torch.zeros((n,) + src.shape[1:], dtype=src.dtype)
    return out.index_add_(0, seg, src)

def _pad(x, pw):
    flat = tuple((v for pair in reversed(pw) for v in pair))
    return torch.nn.functional.pad(x, flat)
kernel_name = 'adaLN_cond__grouped_kv_mqa__mixer_gmlp__prompt'

def setup_inputs():

    _w = lambda a: (lambda t: t.to(torch.bfloat16) if t.is_floating_point() else t)(torch.as_tensor(a))

    def _A_setup():
        B, S, D, H = (1, 2048, 1024, 32)
        Dh = D // H
        return {'x': _w((lambda *s: torch.randn(*s, dtype=torch.bfloat16) * 0.05)(B, S, D)), 'wq': _w((lambda *s: torch.randn(*s, dtype=torch.bfloat16) * 0.05)(D, H * Dh)), 'wk': _w((lambda *s: torch.randn(*s, dtype=torch.bfloat16) * 0.05)(D, Dh)), 'wv': _w((lambda *s: torch.randn(*s, dtype=torch.bfloat16) * 0.05)(D, Dh)), 'wo': _w((lambda *s: torch.randn(*s, dtype=torch.bfloat16) * 0.05)(H * Dh, D))}
    _A_in = _A_setup()

    def _B_setup():
        B, S, D, F = (1, 2048, 1024, 3584)
        Fh = F // 2
        return {'x': _w((lambda *s: torch.randn(*s, dtype=torch.bfloat16) * 0.05)(B, S, D)), 'w_in': _w((lambda *s: torch.randn(*s, dtype=torch.bfloat16) * 0.8)(D, 2 * Fh)), 'w_sp': _w(0.01 * (lambda *s: torch.randn(*s, dtype=torch.bfloat16) * 0.8)(S, S)), 'b_sp': _w(1.0 + 0.01 * (lambda *s: torch.randn(*s, dtype=torch.bfloat16) * 0.05)(S)), 'w_out': _w((lambda *s: torch.randn(*s, dtype=torch.bfloat16) * 0.05)(Fh, D))}
    _B_in = _B_setup()
    return {'A_x': _A_in['x'], 'A_wq': _A_in['wq'], 'A_wk': _A_in['wk'], 'A_wv': _A_in['wv'], 'A_wo': _A_in['wo'], 'B_x': _B_in['x'], 'B_w_in': _B_in['w_in'], 'B_w_sp': _B_in['w_sp'], 'B_b_sp': _B_in['b_sp'], 'B_w_out': _B_in['w_out'], 'c': _w((lambda *s: torch.randn(*s, dtype=torch.bfloat16) * 0.1)(1, 1024) * 8.0), 'w_mod': _w((lambda *s: torch.randn(*s, dtype=torch.bfloat16) * 0.1)(1024, 6 * 1024) * 1024 ** (-0.5) * 8.0)}

def reference(A_x, A_wq, A_wk, A_wv, A_wo, B_x, B_w_in, B_w_sp, B_b_sp, B_w_out, c, w_mod):

    def _A_ref(x, wq, wk, wv, wo):
        B, S, D = x.shape
        H = 32
        Dh = D // H
        q = (lambda x, *d: x.permute(*d))((x @ wq).reshape(B, S, H, Dh), 0, 2, 1, 3)
        k = x @ wk
        v = x @ wv
        scores = torch.einsum('bhqd,bkd->bhqk', q, k) * Dh ** (-0.5)
        p = _softmax(scores, axis=-1)
        o = torch.einsum('bhqk,bkd->bhqd', p, v)
        return (lambda x, *d: x.permute(*d))(o, 0, 2, 1, 3).reshape(B, S, H * Dh) @ wo

    def _B_ref(x, w_in, w_sp, b_sp, w_out):
        B, S, D = x.shape
        F = w_in.shape[-1]
        Fh = F // 2
        z = _gelu(torch.einsum('bsd,df->bsf', x, w_in))
        z1 = z[..., :Fh].clone()
        z2 = _layernorm(z[..., Fh:], axis=-1)
        g = torch.einsum('ts,bsf->btf', w_sp, z2) + b_sp[None, :, None]
        return torch.einsum('bsf,fd->bsd', z1 * g, w_out)
    x = A_x
    mod = (_silu(c) @ w_mod).reshape(c.shape[0], 6, 1, -1)
    sa, ca, ga, sb, cb, gb = (mod[:, 0].clone(), mod[:, 1].clone(), mod[:, 2].clone(), mod[:, 3].clone(), mod[:, 4].clone(), mod[:, 5].clone())
    h = _layernorm(x, axis=-1) * (1 + ca) + sa
    x = x + ga * _A_ref(h, A_wq, A_wk, A_wv, A_wo)
    h = _layernorm(x, axis=-1) * (1 + cb) + sb
    x = x + gb * _B_ref(h, B_w_in, B_w_sp, B_b_sp, B_w_out)
    return x
```

```asm
; @launch grid=(256,1,1) block=(512,1,1) lds=163840
.amdgcn_target "amdgcn-amd-amdhsa--gfx950"
.text
.globl adaLN_cond__grouped_kv_mqa__mixer_gmlp__prompt_kernel
.p2align 8
.type adaLN_cond__grouped_kv_mqa__mixer_gmlp__prompt_kernel,@function
adaLN_cond__grouped_kv_mqa__mixer_gmlp__prompt_kernel:
    s_load_dwordx16 s[64:79], s[0:1], 0
    s_load_dwordx8 s[80:87], s[0:1], 64
    s_load_dwordx4 s[88:91], s[0:1], 96
    s_load_dwordx2 s[92:93], s[0:1], 112
    s_cmp_ge_u32 s2, 256
    s_cbranch_scc1 adaLN_cond__grouped_kv_mqa__mixer_gmlp__prompt_kernel_end
    v_lshrrev_b32 v1, 6, v0
    v_mov_b32 v2, v0
    v_readfirstlane_b32 s42, v1
    v_and_b32 v0, 63, v0
    s_and_b32 s45, s2, 7
    s_lshr_b32 s46, s2, 3
    s_lshr_b32 s47, s45, 1
    s_lshl_b32 s47, s47, 2
    s_lshr_b32 s48, s46, 3
    s_add_u32 s40, s47, s48
    s_and_b32 s47, s45, 1
    s_lshl_b32 s47, s47, 3
    s_and_b32 s48, s46, 7
    s_add_u32 s41, s47, s48
    s_and_b32 s43, s42, 3
    s_lshl_b32 s44, s40, 2
    s_add_u32 s44, s44, s43
    s_xor_b32 s101, s41, s40
    s_and_b32 s101, s101, 1
    s_lshl_b32 s47, s40, 3
    s_lshr_b32 s48, s41, 1
    s_add_u32 s100, s47, s48
    s_and_b32 s58, s100, 31
    s_lshr_b32 s59, s100, 5
    v_lshrrev_b32 v196, 3, v2
    v_and_b32 v197, 7, v2
    v_mul_u32_u24 v198, 49152, v196
    v_lshl_add_u32 v198, v197, 4, v198
    v_lshlrev_b32 v199, 3, v196
    s_mul_i32 s55, s59, 3145728
    s_lshl_b32 s48, s58, 7
    s_add_u32 s55, s55, s48
    s_lshl_b32 s57, s59, 9
    s_mul_i32 s56, s42, 393216
    s_add_u32 s56, s56, s55
    s_cmp_lg_u32 s101, 0
    s_waitcnt lgkmcnt(0)
    s_load_dword s94, s[86:87], s56
    s_mov_b32 s32, s84
    s_mov_b32 s33, s85
    s_mov_b32 s34, 0x800
    s_mov_b32 s35, 0x00020000
    s_mov_b32 s96, s86
    s_mov_b32 s97, s87
    s_mov_b32 s98, 0xc00000
    s_mov_b32 s99, 0x00020000
    s_cbranch_scc1 adaLN_cond__grouped_kv_mqa__mixer_gmlp__prompt_kernel_m1
    buffer_load_dwordx2 v[200:201], v199, s[32:35], s57 offen
    buffer_load_dwordx4 v[208:211], v198, s[96:99], s55 offen
    s_add_u32 s55, s55, 12288
    buffer_load_dwordx4 v[212:215], v198, s[96:99], s55 offen
    s_add_u32 s55, s55, 12288
    buffer_load_dwordx4 v[216:219], v198, s[96:99], s55 offen
    s_add_u32 s55, s55, 12288
    buffer_load_dwordx4 v[220:223], v198, s[96:99], s55 offen
adaLN_cond__grouped_kv_mqa__mixer_gmlp__prompt_kernel_m1:
    s_and_b32 s50, s41, 1
    s_lshr_b32 s51, s41, 2
    s_lshl_b32 s47, s40, 2
    s_add_u32 s51, s51, s47
    s_bfe_u32 s52, s41, 0x10001
    v_and_b32 v14, 15, v0
    v_lshrrev_b32 v15, 4, v0
    v_lshlrev_b32 v3, 4, v0
    s_add_u32 s48, s92, 1703936
    s_addc_u32 s49, s93, 0
    s_load_dword s95, s[48:49], 0
    s_mov_b32 s4, s92
    s_mov_b32 s5, s93
    s_mov_b32 s6, 0x10000000
    s_mov_b32 s7, 0x00020000
    s_mov_b32 s8, s64
    s_mov_b32 s9, s65
    s_mov_b32 s10, 0x400000
    s_mov_b32 s11, 0x00020000
    s_cmp_lg_u32 s101, 0
    s_cbranch_scc1 adaLN_cond__grouped_kv_mqa__mixer_gmlp__prompt_kernel_m2
    v_lshlrev_b32 v196, 5, v197
    v_bfe_u32 v232, v0, 4, 1
    v_lshl_add_u32 v196, v232, 3, v196
    v_lshrrev_b32 v232, 5, v0
    v_lshl_add_u32 v196, v232, 2, v196
    v_lshl_add_u32 v196, v1, 8, v196
    v_add_u32 v196, 148480, v196
    s_waitcnt vmcnt(4)
    v_and_b32 v203, 0xffff0000, v201
    v_lshlrev_b32 v202, 16, v201
    v_and_b32 v201, 0xffff0000, v200
    v_lshlrev_b32 v200, 16, v200
    v_mul_f32 v204, 0xbfb8aa3b, v200
    v_mul_f32 v205, 0xbfb8aa3b, v201
    v_mul_f32 v206, 0xbfb8aa3b, v202
    v_mul_f32 v207, 0xbfb8aa3b, v203
    v_exp_f32 v204, v204
    v_exp_f32 v205, v205
    v_exp_f32 v206, v206
    v_exp_f32 v207, v207
    s_nop 0
    v_add_f32 v204, 1.0, v204
    v_add_f32 v205, 1.0, v205
    v_add_f32 v206, 1.0, v206
    v_add_f32 v207, 1.0, v207
    v_rcp_f32 v204, v204
    v_rcp_f32 v205, v205
    v_rcp_f32 v206, v206
    v_rcp_f32 v207, v207
    s_nop 0
    v_mul_f32 v200, v200, v204
    v_mul_f32 v201, v201, v205
    v_mul_f32 v202, v202, v206
    v_mul_f32 v203, v203, v207
    v_cvt_pk_bf16_f32 v200, v200, v200
    v_cvt_pk_bf16_f32 v201, v201, v201
    v_cvt_pk_bf16_f32 v202, v202, v202
    v_cvt_pk_bf16_f32 v203, v203, v203
    v_lshlrev_b32 v200, 16, v200
    v_lshlrev_b32 v201, 16, v201
    v_lshlrev_b32 v202, 16, v202
    v_lshlrev_b32 v203, 16, v203
    s_waitcnt vmcnt(3)
    v_lshlrev_b32 v232, 16, v208
    v_and_b32 v233, 0xffff0000, v208
    v_mul_f32 v224, v232, v200
    v_mul_f32 v225, v233, v200
    v_lshlrev_b32 v232, 16, v209
    v_and_b32 v233, 0xffff0000, v209
    v_mul_f32 v226, v232, v200
    v_mul_f32 v227, v233, v200
    v_lshlrev_b32 v232, 16, v210
    v_and_b32 v233, 0xffff0000, v210
    v_mul_f32 v228, v232, v200
    v_mul_f32 v229, v233, v200
    v_lshlrev_b32 v232, 16, v211
    v_and_b32 v233, 0xffff0000, v211
    v_mul_f32 v230, v232, v200
    v_mul_f32 v231, v233, v200
    s_waitcnt vmcnt(2)
    v_lshlrev_b32 v232, 16, v212
    v_and_b32 v233, 0xffff0000, v212
    v_fmac_f32 v224, v232, v201
    v_fmac_f32 v225, v233, v201
    v_lshlrev_b32 v232, 16, v213
    v_and_b32 v233, 0xffff0000, v213
    v_fmac_f32 v226, v232, v201
    v_fmac_f32 v227, v233, v201
    v_lshlrev_b32 v232, 16, v214
    v_and_b32 v233, 0xffff0000, v214
    v_fmac_f32 v228, v232, v201
    v_fmac_f32 v229, v233, v201
    v_lshlrev_b32 v232, 16, v215
    v_and_b32 v233, 0xffff0000, v215
    v_fmac_f32 v230, v232, v201
    v_fmac_f32 v231, v233, v201
    s_waitcnt vmcnt(1)
    v_lshlrev_b32 v232, 16, v216
    v_and_b32 v233, 0xffff0000, v216
    v_fmac_f32 v224, v232, v202
    v_fmac_f32 v225, v233, v202
    v_lshlrev_b32 v232, 16, v217
    v_and_b32 v233, 0xffff0000, v217
    v_fmac_f32 v226, v232, v202
    v_fmac_f32 v227, v233, v202
    v_lshlrev_b32 v232, 16, v218
    v_and_b32 v233, 0xffff0000, v218
    v_fmac_f32 v228, v232, v202
    v_fmac_f32 v229, v233, v202
    v_lshlrev_b32 v232, 16, v219
    v_and_b32 v233, 0xffff0000, v219
    v_fmac_f32 v230, v232, v202
    v_fmac_f32 v231, v233, v202
    s_waitcnt vmcnt(0)
    v_lshlrev_b32 v232, 16, v220
    v_and_b32 v233, 0xffff0000, v220
    v_fmac_f32 v224, v232, v203
    v_fmac_f32 v225, v233, v203
    v_lshlrev_b32 v232, 16, v221
    v_and_b32 v233, 0xffff0000, v221
    v_fmac_f32 v226, v232, v203
    v_fmac_f32 v227, v233, v203
    v_lshlrev_b32 v232, 16, v222
    v_and_b32 v233, 0xffff0000, v222
    v_fmac_f32 v228, v232, v203
    v_fmac_f32 v229, v233, v203
    v_lshlrev_b32 v232, 16, v223
    v_and_b32 v233, 0xffff0000, v223
    v_fmac_f32 v230, v232, v203
    v_fmac_f32 v231, v233, v203
    s_nop 1
    v_permlane32_swap_b32 v224, v225
    v_permlane32_swap_b32 v226, v227
    v_permlane32_swap_b32 v228, v229
    v_permlane32_swap_b32 v230, v231
    v_add_f32 v224, v224, v225
    v_add_f32 v226, v226, v227
    v_add_f32 v228, v228, v229
    v_add_f32 v230, v230, v231
    s_nop 1
    v_permlane16_swap_b32 v224, v226
    v_permlane16_swap_b32 v228, v230
    v_add_f32 v224, v224, v226
    v_add_f32 v228, v228, v230
    s_nop 1
    v_add_f32_dpp v225, v224, v224 row_ror:8 row_mask:0xf bank_mask:0xf
    v_add_f32_dpp v229, v228, v228 row_ror:8 row_mask:0xf bank_mask:0xf
    ds_write_b32 v196, v225
    ds_write_b32 v196, v229 offset:16
    s_waitcnt lgkmcnt(0)
adaLN_cond__grouped_kv_mqa__mixer_gmlp__prompt_kernel_m2:
    s_cmp_ge_u32 s42, 4
    s_cbranch_scc1 adaLN_cond__grouped_kv_mqa__mixer_gmlp__prompt_kernel_helper
    s_setprio 2
    v_and_b32 v12, 12, v14
    v_lshlrev_b32 v12, 1, v12
    v_and_b32 v8, 16, v14
    v_lshrrev_b32 v8, 2, v8
    v_or_b32 v12, v12, v8
    v_and_b32 v8, 3, v14
    v_or_b32 v12, v12, v8
    v_lshlrev_b32 v12, 11, v12
    v_lshl_add_u32 v12, v15, 4, v12
    s_lshl_b32 s53, s51, 16
    s_lshl_b32 s48, s52, 13
    s_add_u32 s53, s53, s48
    s_lshl_b32 s48, s43, 9
    s_add_u32 s53, s53, s48
    s_bfe_u32 s57, s41, 0x20001
    s_lshl_b32 s48, s57, 7
    s_add_u32 s53, s53, s48
    s_xor_b32 s54, s53, 128
    s_xor_b32 s55, s53, 256
    s_xor_b32 s56, s53, 384
    s_cmp_lg_u32 s101, 0
    s_cbranch_scc1 adaLN_cond__grouped_kv_mqa__mixer_gmlp__prompt_kernel_c1
    s_barrier
    s_barrier
adaLN_cond__grouped_kv_mqa__mixer_gmlp__prompt_kernel_c1:
    buffer_load_dwordx4 v[16:19], v12, s[8:11], s53 offen offset:0
    buffer_load_dwordx4 v[20:23], v12, s[8:11], s53 offen offset:64
    buffer_load_dwordx4 v[24:27], v12, s[8:11], s54 offen offset:0
    buffer_load_dwordx4 v[28:31], v12, s[8:11], s54 offen offset:64
    buffer_load_dwordx4 v[32:35], v12, s[8:11], s55 offen offset:0
    buffer_load_dwordx4 v[36:39], v12, s[8:11], s55 offen offset:64
    buffer_load_dwordx4 v[40:43], v12, s[8:11], s56 offen offset:0
    buffer_load_dwordx4 v[44:47], v12, s[8:11], s56 offen offset:64
    s_cmp_eq_u32 s101, 0
    s_cbranch_scc1 adaLN_cond__grouped_kv_mqa__mixer_gmlp__prompt_kernel_c2
    s_barrier
adaLN_cond__grouped_kv_mqa__mixer_gmlp__prompt_kernel_c2:
    s_waitcnt vmcnt(7)
    v_lshlrev_b32 v48, 16, v16
    v_and_b32 v49, 0xffff0000, v16
    v_lshlrev_b32 v50, 16, v17
    v_and_b32 v51, 0xffff0000, v17
    v_lshlrev_b32 v52, 16, v18
    v_and_b32 v53, 0xffff0000, v18
    v_lshlrev_b32 v54, 16, v19
    v_and_b32 v55, 0xffff0000, v19
    v_pk_add_f32 v[8:9], v[48:49], v[50:51]
    v_pk_add_f32 v[10:11], v[52:53], v[54:55]
    s_waitcnt vmcnt(6)
    v_lshlrev_b32 v56, 16, v20
    v_and_b32 v57, 0xffff0000, v20
    v_lshlrev_b32 v58, 16, v21
    v_and_b32 v59, 0xffff0000, v21
    v_lshlrev_b32 v60, 16, v22
    v_and_b32 v61, 0xffff0000, v22
    v_lshlrev_b32 v62, 16, v23
    v_and_b32 v63, 0xffff0000, v23
    v_pk_add_f32 v[8:9], v[8:9], v[56:57]
    v_pk_add_f32 v[10:11], v[10:11], v[58:59]
    v_pk_add_f32 v[8:9], v[8:9], v[60:61]
    v_pk_add_f32 v[10:11], v[10:11], v[62:63]
    s_waitcnt vmcnt(5)
    v_lshlrev_b32 v64, 16, v24
    v_and_b32 v65, 0xffff0000, v24
    v_lshlrev_b32 v66, 16, v25
    v_and_b32 v67, 0xffff0000, v25
    v_lshlrev_b32 v68, 16, v26
    v_and_b32 v69, 0xffff0000, v26
    v_lshlrev_b32 v70, 16, v27
    v_and_b32 v71, 0xffff0000, v27
    v_pk_add_f32 v[8:9], v[8:9], v[64:65]
    v_pk_add_f32 v[10:11], v[10:11], v[66:67]
    v_pk_add_f32 v[8:9], v[8:9], v[68:69]
    v_pk_add_f32 v[10:11], v[10:11], v[70:71]
    s_waitcnt vmcnt(4)
    v_lshlrev_b32 v72, 16, v28
    v_and_b32 v73, 0xffff0000, v28
    v_lshlrev_b32 v74, 16, v29
    v_and_b32 v75, 0xffff0000, v29
    v_lshlrev_b32 v76, 16, v30
    v_and_b32 v77, 0xffff0000, v30
    v_lshlrev_b32 v78, 16, v31
    v_and_b32 v79, 0xffff0000, v31
    v_pk_add_f32 v[8:9], v[8:9], v[72:73]
    v_pk_add_f32 v[10:11], v[10:11], v[74:75]
    v_pk_add_f32 v[8:9], v[8:9], v[76:77]
    v_pk_add_f32 v[10:11], v[10:11], v[78:79]
    s_waitcnt vmcnt(3)
    v_lshlrev_b32 v80, 16, v32
    v_and_b32 v81, 0xffff0000, v32
    v_lshlrev_b32 v82, 16, v33
    v_and_b32 v83, 0xffff0000, v33
    v_lshlrev_b32 v84, 16, v34
    v_and_b32 v85, 0xffff0000, v34
    v_lshlrev_b32 v86, 16, v35
    v_and_b32 v87, 0xffff0000, v35
    v_pk_add_f32 v[8:9], v[8:9], v[80:81]
    v_pk_add_f32 v[10:11], v[10:11], v[82:83]
    v_pk_add_f32 v[8:9], v[8:9], v[84:85]
    v_pk_add_f32 v[10:11], v[10:11], v[86:87]
    s_waitcnt vmcnt(2)
    v_lshlrev_b32 v88, 16, v36
    v_and_b32 v89, 0xffff0000, v36
    v_lshlrev_b32 v90, 16, v37
    v_and_b32 v91, 0xffff0000, v37
    v_lshlrev_b32 v92, 16, v38
    v_and_b32 v93, 0xffff0000, v38
    v_lshlrev_b32 v94, 16, v39
    v_and_b32 v95, 0xffff0000, v39
    v_pk_add_f32 v[8:9], v[8:9], v[88:89]
    v_pk_add_f32 v[10:11], v[10:11], v[90:91]
    v_pk_add_f32 v[8:9], v[8:9], v[92:93]
    v_pk_add_f32 v[10:11], v[10:11], v[94:95]
    s_waitcnt vmcnt(1)
    v_lshlrev_b32 v96, 16, v40
    v_and_b32 v97, 0xffff0000, v40
    v_lshlrev_b32 v98, 16, v41
    v_and_b32 v99, 0xffff0000, v41
    v_lshlrev_b32 v100, 16, v42
    v_and_b32 v101, 0xffff0000, v42
    v_lshlrev_b32 v102, 16, v43
    v_and_b32 v103, 0xffff0000, v43
    v_pk_add_f32 v[8:9], v[8:9], v[96:97]
    v_pk_add_f32 v[10:11], v[10:11], v[98:99]
    v_pk_add_f32 v[8:9], v[8:9], v[100:101]
    v_pk_add_f32 v[10:11], v[10:11], v[102:103]
    s_waitcnt vmcnt(0)
    v_lshlrev_b32 v104, 16, v44
    v_and_b32 v105, 0xffff0000, v44
    v_lshlrev_b32 v106, 16, v45
    v_and_b32 v107, 0xffff0000, v45
    v_lshlrev_b32 v108, 16, v46
    v_and_b32 v109, 0xffff0000, v46
    v_lshlrev_b32 v110, 16, v47
    v_and_b32 v111, 0xffff0000, v47
    v_pk_add_f32 v[8:9], v[8:9], v[104:105]
    v_pk_add_f32 v[10:11], v[10:11], v[106:107]
    v_pk_add_f32 v[8:9], v[8:9], v[108:109]
    v_pk_add_f32 v[10:11], v[10:11], v[110:111]
    v_pk_add_f32 v[8:9], v[8:9], v[10:11]
    v_add_f32 v8, v8, v9
    v_mov_b32 v9, v8
    s_nop 1
    v_permlane16_swap_b32 v8, v9
    v_add_f32 v8, v8, v9
    v_mov_b32 v9, v8
    s_nop 1
    v_permlane32_swap_b32 v8, v9
    v_add_f32 v8, v8, v9
    v_mul_f32 v8, 0x3b800000, v8
    v_pk_add_f32 v[16:17], v[48:49], v[8:9] op_sel_hi:[1,0] neg_lo:[0,1] neg_hi:[0,1]
    v_pk_mul_f32 v[10:11], v[16:17], v[16:17]
    v_pk_add_f32 v[18:19], v[50:51], v[8:9] op_sel_hi:[1,0] neg_lo:[0,1] neg_hi:[0,1]
    v_pk_mul_f32 v[12:13], v[18:19], v[18:19]
    v_pk_add_f32 v[20:21], v[52:53], v[8:9] op_sel_hi:[1,0] neg_lo:[0,1] neg_hi:[0,1]
    v_pk_fma_f32 v[10:11], v[20:21], v[20:21], v[10:11]
    v_pk_add_f32 v[22:23], v[54:55], v[8:9] op_sel_hi:[1,0] neg_lo:[0,1] neg_hi:[0,1]
    v_pk_fma_f32 v[12:13], v[22:23], v[22:23], v[12:13]
    v_pk_add_f32 v[16:17], v[56:57], v[8:9] op_sel_hi:[1,0] neg_lo:[0,1] neg_hi:[0,1]
    v_pk_fma_f32 v[10:11], v[16:17], v[16:17], v[10:11]
    v_pk_add_f32 v[18:19], v[58:59], v[8:9] op_sel_hi:[1,0] neg_lo:[0,1] neg_hi:[0,1]
    v_pk_fma_f32 v[12:13], v[18:19], v[18:19], v[12:13]
    v_pk_add_f32 v[20:21], v[60:61], v[8:9] op_sel_hi:[1,0] neg_lo:[0,1] neg_hi:[0,1]
    v_pk_fma_f32 v[10:11], v[20:21], v[20:21], v[10:11]
    v_pk_add_f32 v[22:23], v[62:63], v[8:9] op_sel_hi:[1,0] neg_lo:[0,1] neg_hi:[0,1]
    v_pk_fma_f32 v[12:13], v[22:23], v[22:23], v[12:13]
    v_pk_add_f32 v[16:17], v[64:65], v[8:9] op_sel_hi:[1,0] neg_lo:[0,1] neg_hi:[0,1]
    v_pk_fma_f32 v[10:11], v[16:17], v[16:17], v[10:11]
    v_pk_add_f32 v[18:19], v[66:67], v[8:9] op_sel_hi:[1,0] neg_lo:[0,1] neg_hi:[0,1]
    v_pk_fma_f32 v[12:13], v[18:19], v[18:19], v[12:13]
    v_pk_add_f32 v[20:21], v[68:69], v[8:9] op_sel_hi:[1,0] neg_lo:[0,1] neg_hi:[0,1]
    v_pk_fma_f32 v[10:11], v[20:21], v[20:21], v[10:11]
    v_pk_add_f32 v[22:23], v[70:71], v[8:9] op_sel_hi:[1,0] neg_lo:[0,1] neg_hi:[0,1]
    v_pk_fma_f32 v[12:13], v[22:23], v[22:23], v[12:13]
    v_pk_add_f32 v[16:17], v[72:73], v[8:9] op_sel_hi:[1,0] neg_lo:[0,1] neg_hi:[0,1]
    v_pk_fma_f32 v[10:11], v[16:17], v[16:17], v[10:11]
    v_pk_add_f32 v[18:19], v[74:75], v[8:9] op_sel_hi:[1,0] neg_lo:[0,1] neg_hi:[0,1]
    v_pk_fma_f32 v[12:13], v[18:19], v[18:19], v[12:13]
    v_pk_add_f32 v[20:21], v[76:77], v[8:9] op_sel_hi:[1,0] neg_lo:[0,1] neg_hi:[0,1]
    v_pk_fma_f32 v[10:11], v[20:21], v[20:21], v[10:11]
    v_pk_add_f32 v[22:23], v[78:79], v[8:9] op_sel_hi:[1,0] neg_lo:[0,1] neg_hi:[0,1]
    v_pk_fma_f32 v[12:13], v[22:23], v[22:23], v[12:13]
    v_pk_add_f32 v[16:17], v[80:81], v[8:9] op_sel_hi:[1,0] neg_lo:[0,1] neg_hi:[0,1]
    v_pk_fma_f32 v[10:11], v[16:17], v[16:17], v[10:11]
    v_pk_add_f32 v[18:19], v[82:83], v[8:9] op_sel_hi:[1,0] neg_lo:[0,1] neg_hi:[0,1]
    v_pk_fma_f32 v[12:13], v[18:19], v[18:19], v[12:13]
    v_pk_add_f32 v[20:21], v[84:85], v[8:9] op_sel_hi:[1,0] neg_lo:[0,1] neg_hi:[0,1]
    v_pk_fma_f32 v[10:11], v[20:21], v[20:21], v[10:11]
    v_pk_add_f32 v[22:23], v[86:87], v[8:9] op_sel_hi:[1,0] neg_lo:[0,1] neg_hi:[0,1]
    v_pk_fma_f32 v[12:13], v[22:23], v[22:23], v[12:13]
    v_pk_add_f32 v[16:17], v[88:89], v[8:9] op_sel_hi:[1,0] neg_lo:[0,1] neg_hi:[0,1]
    v_pk_fma_f32 v[10:11], v[16:17], v[16:17], v[10:11]
    v_pk_add_f32 v[18:19], v[90:91], v[8:9] op_sel_hi:[1,0] neg_lo:[0,1] neg_hi:[0,1]
    v_pk_fma_f32 v[12:13], v[18:19], v[18:19], v[12:13]
    v_pk_add_f32 v[20:21], v[92:93], v[8:9] op_sel_hi:[1,0] neg_lo:[0,1] neg_hi:[0,1]
    v_pk_fma_f32 v[10:11], v[20:21], v[20:21], v[10:11]
    v_pk_add_f32 v[22:23], v[94:95], v[8:9] op_sel_hi:[1,0] neg_lo:[0,1] neg_hi:[0,1]
    v_pk_fma_f32 v[12:13], v[22:23], v[22:23], v[12:13]
    v_pk_add_f32 v[16:17], v[96:97], v[8:9] op_sel_hi:[1,0] neg_lo:[0,1] neg_hi:[0,1]
    v_pk_fma_f32 v[10:11], v[16:17], v[16:17], v[10:11]
    v_pk_add_f32 v[18:19], v[98:99], v[8:9] op_sel_hi:[1,0] neg_lo:[0,1] neg_hi:[0,1]
    v_pk_fma_f32 v[12:13], v[18:19], v[18:19], v[12:13]
    v_pk_add_f32 v[20:21], v[100:101], v[8:9] op_sel_hi:[1,0] neg_lo:[0,1] neg_hi:[0,1]
    v_pk_fma_f32 v[10:11], v[20:21], v[20:21], v[10:11]
    v_pk_add_f32 v[22:23], v[102:103], v[8:9] op_sel_hi:[1,0] neg_lo:[0,1] neg_hi:[0,1]
    v_pk_fma_f32 v[12:13], v[22:23], v[22:23], v[12:13]
    v_pk_add_f32 v[16:17], v[104:105], v[8:9] op_sel_hi:[1,0] neg_lo:[0,1] neg_hi:[0,1]
    v_pk_fma_f32 v[10:11], v[16:17], v[16:17], v[10:11]
    v_pk_add_f32 v[18:19], v[106:107], v[8:9] op_sel_hi:[1,0] neg_lo:[0,1] neg_hi:[0,1]
    v_pk_fma_f32 v[12:13], v[18:19], v[18:19], v[12:13]
    v_pk_add_f32 v[20:21], v[108:109], v[8:9] op_sel_hi:[1,0] neg_lo:[0,1] neg_hi:[0,1]
    v_pk_fma_f32 v[10:11], v[20:21], v[20:21], v[10:11]
    v_pk_add_f32 v[22:23], v[110:111], v[8:9] op_sel_hi:[1,0] neg_lo:[0,1] neg_hi:[0,1]
    v_pk_fma_f32 v[12:13], v[22:23], v[22:23], v[12:13]
    v_pk_add_f32 v[10:11], v[10:11], v[12:13]
    v_add_f32 v9, v10, v11
    v_mov_b32 v10, v9
    s_nop 1
    v_permlane16_swap_b32 v9, v10
    v_add_f32 v9, v9, v10
    v_mov_b32 v10, v9
    s_nop 1
    v_permlane32_swap_b32 v9, v10
    v_add_f32 v9, v9, v10
    v_lshlrev_b32 v10, 5, v14
    v_add_u32 v10, 139264, v10
    v_lshl_add_u32 v11, v1, 3, v10
    ds_write_b64 v11, v[8:9]
    v_mov_b32 v12, 140032
    v_mov_b32 v13, 1
    s_mov_b64 exec, 1
    s_waitcnt lgkmcnt(0)
    ds_add_u32 v12, v13
    s_mov_b64 exec, -1
    s_mul_i32 s95, s95, 0x9e3779b1
    s_add_u32 s95, s95, 0x7f4a7c15
    v_lshrrev_b32 v8, 4, v0
    v_bfe_u32 v9, v0, 2, 2
    v_lshl_add_u32 v248, v8, 3, v9
    v_lshlrev_b32 v248, 7, v248
    v_and_b32 v8, 1, v8
    v_lshrrev_b32 v9, 1, v9
    v_lshl_add_u32 v8, v8, 1, v9
    v_and_b32 v9, 3, v0
    v_lshl_add_u32 v248, v9, 3, v248
    v_xor_b32 v9, 3, v8
    v_lshl_add_u32 v251, v9, 5, v248
    v_xor_b32 v9, 2, v8
    v_lshl_add_u32 v250, v9, 5, v248
    v_xor_b32 v9, 1, v8
    v_lshl_add_u32 v249, v9, 5, v248
    v_xor_b32 v9, 0, v8
    v_lshl_add_u32 v248, v9, 5, v248
    v_add_u32 v5, 65536, v3
    v_and_b32 v8, 31, v0
    v_and_b32 v6, 12, v8
    v_lshlrev_b32 v6, 1, v6
    v_and_b32 v9, 16, v8
    v_lshrrev_b32 v9, 2, v9
    v_or_b32 v6, v6, v9
    v_and_b32 v9, 3, v8
    v_or_b32 v6, v6, v9
    v_lshlrev_b32 v6, 11, v6
    v_lshrrev_b32 v8, 5, v0
    v_lshl_add_u32 v6, v8, 4, v6
    v_lshlrev_b32 v7, 5, v8
    v_add_u32 v7, 135168, v7
    s_lshl_b32 s46, s44, 16
    s_lshl_b32 s47, s41, 7
    s_add_u32 s49, s46, s47
    s_and_b32 s46, s2, 31
    s_lshl_b32 s46, s46, 9
    s_lshl_b32 s47, s43, 7
    s_add_u32 s46, s46, s47
    s_add_u32 s46, s46, 1638400
    v_lshlrev_b32 v12, 2, v0
    s_mov_b32 s47, 262144
    s_mov_b32 exec_hi, 0
adaLN_cond__grouped_kv_mqa__mixer_gmlp__prompt_kernel_pm:
    v_mov_b32 v13, 0
    buffer_atomic_or v13, v12, s[4:7], s46 offen sc0 sc1
    s_sub_u32 s47, s47, 1
    s_waitcnt vmcnt(0)
    v_cmp_ne_u32 vcc, s95, v13
    s_cmp_eq_u32 s47, 0
    s_cbranch_scc1 adaLN_cond__grouped_kv_mqa__mixer_gmlp__prompt_kernel_pm_x
    s_cbranch_vccnz adaLN_cond__grouped_kv_mqa__mixer_gmlp__prompt_kernel_pm
adaLN_cond__grouped_kv_mqa__mixer_gmlp__prompt_kernel_pm_x:
    s_mov_b64 exec, -1
    s_lshl_b32 s46, s43, 10
    s_add_u32 s47, s46, 0
    buffer_load_dwordx4 v[112:115], v3, s[4:7], s47 offen sc1
    s_add_u32 s47, s46, 24576
    buffer_load_dwordx4 v[116:119], v3, s[4:7], s47 offen sc1
    s_add_u32 s47, s46, 49152
    buffer_load_dwordx4 v[120:123], v3, s[4:7], s47 offen sc1
    s_add_u32 s47, s46, 73728
    buffer_load_dwordx4 v[124:127], v3, s[4:7], s47 offen sc1
    s_add_u32 s47, s46, 4096
    buffer_load_dwordx4 v[128:131], v3, s[4:7], s47 offen sc1
    s_add_u32 s47, s46, 28672
    buffer_load_dwordx4 v[132:135], v3, s[4:7], s47 offen sc1
    s_add_u32 s47, s46, 53248
    buffer_load_dwordx4 v[136:139], v3, s[4:7], s47 offen sc1
    s_add_u32 s47, s46, 77824
    buffer_load_dwordx4 v[140:143], v3, s[4:7], s47 offen sc1
    v_mov_b32 v12, 140040
    v_mov_b32 v13, 1
    s_mov_b64 exec, 1
    s_waitcnt lgkmcnt(0)
    ds_add_u32 v12, v13
    s_mov_b64 exec, -1
    v_mov_b32 v12, 140032
    s_mov_b32 s47, 2097152
adaLN_cond__grouped_kv_mqa__mixer_gmlp__prompt_kernel_ls0:
    ds_read_b32 v13, v12
    s_sub_u32 s47, s47, 1
    s_waitcnt lgkmcnt(0)
    v_cmp_gt_u32 vcc, 4, v13
    s_cmp_eq_u32 s47, 0
    s_cbranch_scc1 adaLN_cond__grouped_kv_mqa__mixer_gmlp__prompt_kernel_ls0_x
    s_cbranch_vccnz adaLN_cond__grouped_kv_mqa__mixer_gmlp__prompt_kernel_ls0
adaLN_cond__grouped_kv_mqa__mixer_gmlp__prompt_kernel_ls0_x:
    ds_read_b128 v[16:19], v10 offset:0
    ds_read_b128 v[20:23], v10 offset:16
    v_lshlrev_b32 v4, 9, v15
    v_lshl_add_u32 v4, v14, 4, v4
    s_lshl_b32 s53, s51, 16
    s_lshl_b32 s48, s52, 8
    s_add_u32 s53, s53, s48
    s_lshl_b32 s48, s43, 14
    s_add_u32 s53, s53, s48
    s_lshl_b32 s48, s57, 12
    s_add_u32 s53, s53, s48
    s_add_u32 s53, s53, 2097152
    s_cmp_eq_u32 s101, 0
    s_cselect_b32 s53, 536870912, s53
    s_xor_b32 s54, s53, 4096
    s_xor_b32 s55, s53, 8192
    s_xor_b32 s56, s53, 12288
    s_waitcnt lgkmcnt(0)
    v_pk_add_f32 v[8:9], v[16:17], v[18:19]
    v_pk_add_f32 v[8:9], v[8:9], v[20:21]
    v_pk_add_f32 v[8:9], v[8:9], v[22:23]
    v_mul_f32 v8, 0x3e800000, v8
    v_mov_b32 v12, 0
    v_sub_f32 v13, v16, v8
    v_fmac_f32 v12, v13, v13
    v_sub_f32 v13, v18, v8
    v_fmac_f32 v12, v13, v13
    v_sub_f32 v13, v20, v8
    v_fmac_f32 v12, v13, v13
    v_sub_f32 v13, v22, v8
    v_fmac_f32 v12, v13, v13
    v_fmac_f32 v9, 0x43800000, v12
    v_mov_b32 v12, 0x3727c5ac
    v_fmac_f32 v12, 0x3a800000, v9
    v_rsq_f32 v12, v12
    s_lshl_b32 s48, s43, 11
    s_add_u32 s48, s48, 131072
    v_mul_f32 v13, v8, v12
    v_sub_f32 v13, 0, v13
    v_pk_fma_f32 v[48:49], v[48:49], v[12:13], v[12:13] op_sel:[0,0,1] op_sel_hi:[1,0,1]
    v_pk_fma_f32 v[50:51], v[50:51], v[12:13], v[12:13] op_sel:[0,0,1] op_sel_hi:[1,0,1]
    v_pk_fma_f32 v[52:53], v[52:53], v[12:13], v[12:13] op_sel:[0,0,1] op_sel_hi:[1,0,1]
    v_pk_fma_f32 v[54:55], v[54:55], v[12:13], v[12:13] op_sel:[0,0,1] op_sel_hi:[1,0,1]
    v_pk_fma_f32 v[56:57], v[56:57], v[12:13], v[12:13] op_sel:[0,0,1] op_sel_hi:[1,0,1]
    v_pk_fma_f32 v[58:59], v[58:59], v[12:13], v[12:13] op_sel:[0,0,1] op_sel_hi:[1,0,1]
    v_pk_fma_f32 v[60:61], v[60:61], v[12:13], v[12:13] op_sel:[0,0,1] op_sel_hi:[1,0,1]
    v_pk_fma_f32 v[62:63], v[62:63], v[12:13], v[12:13] op_sel:[0,0,1] op_sel_hi:[1,0,1]
    v_pk_fma_f32 v[64:65], v[64:65], v[12:13], v[12:13] op_sel:[0,0,1] op_sel_hi:[1,0,1]
    v_pk_fma_f32 v[66:67], v[66:67], v[12:13], v[12:13] op_sel:[0,0,1] op_sel_hi:[1,0,1]
    v_pk_fma_f32 v[68:69], v[68:69], v[12:13], v[12:13] op_sel:[0,0,1] op_sel_hi:[1,0,1]
    v_pk_fma_f32 v[70:71], v[70:71], v[12:13], v[12:13] op_sel:[0,0,1] op_sel_hi:[1,0,1]
    v_pk_fma_f32 v[72:73], v[72:73], v[12:13], v[12:13] op_sel:[0,0,1] op_sel_hi:[1,0,1]
    v_pk_fma_f32 v[74:75], v[74:75], v[12:13], v[12:13] op_sel:[0,0,1] op_sel_hi:[1,0,1]
    v_pk_fma_f32 v[76:77], v[76:77], v[12:13], v[12:13] op_sel:[0,0,1] op_sel_hi:[1,0,1]
    v_pk_fma_f32 v[78:79], v[78:79], v[12:13], v[12:13] op_sel:[0,0,1] op_sel_hi:[1,0,1]
    v_pk_fma_f32 v[80:81], v[80:81], v[12:13], v[12:13] op_sel:[0,0,1] op_sel_hi:[1,0,1]
    v_pk_fma_f32 v[82:83], v[82:83], v[12:13], v[12:13] op_sel:[0,0,1] op_sel_hi:[1,0,1]
    v_pk_fma_f32 v[84:85], v[84:85], v[12:13], v[12:13] op_sel:[0,0,1] op_sel_hi:[1,0,1]
    v_pk_fma_f32 v[86:87], v[86:87], v[12:13], v[12:13] op_sel:[0,0,1] op_sel_hi:[1,0,1]
    v_pk_fma_f32 v[88:89], v[88:89], v[12:13], v[12:13] op_sel:[0,0,1] op_sel_hi:[1,0,1]
    v_pk_fma_f32 v[90:91], v[90:91], v[12:13], v[12:13] op_sel:[0,0,1] op_sel_hi:[1,0,1]
    v_pk_fma_f32 v[92:93], v[92:93], v[12:13], v[12:13] op_sel:[0,0,1] op_sel_hi:[1,0,1]
    v_pk_fma_f32 v[94:95], v[94:95], v[12:13], v[12:13] op_sel:[0,0,1] op_sel_hi:[1,0,1]
    v_pk_fma_f32 v[96:97], v[96:97], v[12:13], v[12:13] op_sel:[0,0,1] op_sel_hi:[1,0,1]
    v_pk_fma_f32 v[98:99], v[98:99], v[12:13], v[12:13] op_sel:[0,0,1] op_sel_hi:[1,0,1]
    v_pk_fma_f32 v[100:101], v[100:101], v[12:13], v[12:13] op_sel:[0,0,1] op_sel_hi:[1,0,1]
    v_pk_fma_f32 v[102:103], v[102:103], v[12:13], v[12:13] op_sel:[0,0,1] op_sel_hi:[1,0,1]
    v_pk_fma_f32 v[104:105], v[104:105], v[12:13], v[12:13] op_sel:[0,0,1] op_sel_hi:[1,0,1]
    v_pk_fma_f32 v[106:107], v[106:107], v[12:13], v[12:13] op_sel:[0,0,1] op_sel_hi:[1,0,1]
    v_pk_fma_f32 v[108:109], v[108:109], v[12:13], v[12:13] op_sel:[0,0,1] op_sel_hi:[1,0,1]
    v_pk_fma_f32 v[110:111], v[110:111], v[12:13], v[12:13] op_sel:[0,0,1] op_sel_hi:[1,0,1]
    v_add_u32 v9, s48, v3
    s_lshl_b32 s47, s57, 8
    s_add_u32 s48, s48, s47
    v_lshlrev_b32 v10, 5, v15
    v_add_u32 v240, s48, v10
    v_xor_b32 v241, 256, v240
    v_xor_b32 v242, 512, v240
    v_xor_b32 v243, 768, v240
    s_waitcnt vmcnt(4)
    v_pk_add_f32 v[112:113], v[112:113], v[116:117]
    v_pk_add_f32 v[114:115], v[114:115], v[118:119]
    v_pk_add_f32 v[112:113], v[112:113], v[120:121]
    v_pk_add_f32 v[114:115], v[114:115], v[122:123]
    v_pk_add_f32 v[112:113], v[112:113], v[124:125]
    v_pk_add_f32 v[114:115], v[114:115], v[126:127]
    v_cvt_pk_bf16_f32 v112, v112, v113
    v_cvt_pk_bf16_f32 v114, v114, v115
    v_and_b32 v113, 0xffff0000, v112
    v_lshlrev_b32 v112, 16, v112
    v_and_b32 v115, 0xffff0000, v114
    v_lshlrev_b32 v114, 16, v114
    ds_write_b128 v9, v[112:115] offset:0
    s_waitcnt vmcnt(0)
    v_pk_add_f32 v[128:129], v[128:129], v[132:133]
    v_pk_add_f32 v[130:131], v[130:131], v[134:135]
    v_pk_add_f32 v[128:129], v[128:129], v[136:137]
    v_pk_add_f32 v[130:131], v[130:131], v[138:139]
    v_pk_add_f32 v[128:129], v[128:129], v[140:141]
    v_pk_add_f32 v[130:131], v[130:131], v[142:143]
    v_cvt_pk_bf16_f32 v128, v128, v129
    v_cvt_pk_bf16_f32 v130, v130, v131
    v_and_b32 v129, 0xffff0000, v128
    v_lshlrev_b32 v128, 16, v128
    v_and_b32 v131, 0xffff0000, v130
    v_lshlrev_b32 v130, 16, v130
    v_add_f32 v128, 1.0, v128
    v_add_f32 v129, 1.0, v129
    v_add_f32 v130, 1.0, v130
    v_add_f32 v131, 1.0, v131
    v_cvt_pk_bf16_f32 v128, v128, v129
    v_cvt_pk_bf16_f32 v130, v130, v131
    v_and_b32 v129, 0xffff0000, v128
    v_lshlrev_b32 v128, 16, v128
    v_and_b32 v131, 0xffff0000, v130
    v_lshlrev_b32 v130, 16, v130
    ds_write_b128 v9, v[128:131] offset:1024
    s_waitcnt lgkmcnt(0)
    ds_read_b128 v[112:115], v240 offset:0
    ds_read_b128 v[116:119], v240 offset:16
    ds_read_b128 v[120:123], v240 offset:1024
    ds_read_b128 v[124:127], v240 offset:1040
    ds_read_b128 v[128:131], v240 offset:128
    ds_read_b128 v[132:135], v240 offset:144
    ds_read_b128 v[136:139], v240 offset:1152
    ds_read_b128 v[140:143], v240 offset:1168
    ds_read_b128 v[144:147], v241 offset:0
    ds_read_b128 v[148:151], v241 offset:16
    ds_read_b128 v[152:155], v241 offset:1024
    ds_read_b128 v[156:159], v241 offset:1040
    s_waitcnt lgkmcnt(8)
    v_pk_fma_f32 v[48:49], v[48:49], v[120:121], v[112:113]
    v_pk_fma_f32 v[50:51], v[50:51], v[122:123], v[114:115]
    v_pk_fma_f32 v[52:53], v[52:53], v[124:125], v[116:117]
    v_pk_fma_f32 v[54:55], v[54:55], v[126:127], v[118:119]
    ds_read_b128 v[112:115], v241 offset:128
    ds_read_b128 v[116:119], v241 offset:144
    ds_read_b128 v[120:123], v241 offset:1152
    ds_read_b128 v[124:127], v241 offset:1168
    v_cvt_pk_bf16_f32 v16, v48, v49
    v_cvt_pk_bf16_f32 v17, v50, v51
    v_cvt_pk_bf16_f32 v18, v52, v53
    v_cvt_pk_bf16_f32 v19, v54, v55
    buffer_store_dwordx4 v[16:19], v4, s[4:7], s53 offen offset:0 sc1
    s_waitcnt lgkmcnt(8)
    v_pk_fma_f32 v[56:57], v[56:57], v[136:137], v[128:129]
    v_pk_fma_f32 v[58:59], v[58:59], v[138:139], v[130:131]
    v_pk_fma_f32 v[60:61], v[60:61], v[140:141], v[132:133]
    v_pk_fma_f32 v[62:63], v[62:63], v[142:143], v[134:135]
    ds_read_b128 v[128:131], v242 offset:0
    ds_read_b128 v[132:135], v242 offset:16
    ds_read_b128 v[136:139], v242 offset:1024
    ds_read_b128 v[140:143], v242 offset:1040
    v_cvt_pk_bf16_f32 v20, v56, v57
    v_cvt_pk_bf16_f32 v21, v58, v59
    v_cvt_pk_bf16_f32 v22, v60, v61
    v_cvt_pk_bf16_f32 v23, v62, v63
    buffer_store_dwordx4 v[20:23], v4, s[4:7], s53 offen offset:2048 sc1
    s_waitcnt lgkmcnt(8)
    v_pk_fma_f32 v[64:65], v[64:65], v[152:153], v[144:145]
    v_pk_fma_f32 v[66:67], v[66:67], v[154:155], v[146:147]
    v_pk_fma_f32 v[68:69], v[68:69], v[156:157], v[148:149]
    v_pk_fma_f32 v[70:71], v[70:71], v[158:159], v[150:151]
    ds_read_b128 v[144:147], v242 offset:128
    ds_read_b128 v[148:151], v242 offset:144
    ds_read_b128 v[152:155], v242 offset:1152
    ds_read_b128 v[156:159], v242 offset:1168
    v_cvt_pk_bf16_f32 v24, v64, v65
    v_cvt_pk_bf16_f32 v25, v66, v67
    v_cvt_pk_bf16_f32 v26, v68, v69
    v_cvt_pk_bf16_f32 v27, v70, v71
    buffer_store_dwordx4 v[24:27], v4, s[4:7], s54 offen offset:0 sc1
    s_waitcnt lgkmcnt(8)
    v_pk_fma_f32 v[72:73], v[72:73], v[120:121], v[112:113]
    v_pk_fma_f32 v[74:75], v[74:75], v[122:123], v[114:115]
    v_pk_fma_f32 v[76:77], v[76:77], v[124:125], v[116:117]
    v_pk_fma_f32 v[78:79], v[78:79], v[126:127], v[118:119]
    ds_read_b128 v[112:115], v243 offset:0
    ds_read_b128 v[116:119], v243 offset:16
    ds_read_b128 v[120:123], v243 offset:1024
    ds_read_b128 v[124:127], v243 offset:1040
    v_cvt_pk_bf16_f32 v28, v72, v73
    v_cvt_pk_bf16_f32 v29, v74, v75
    v_cvt_pk_bf16_f32 v30, v76, v77
    v_cvt_pk_bf16_f32 v31, v78, v79
    buffer_store_dwordx4 v[28:31], v4, s[4:7], s54 offen offset:2048 sc1
    s_waitcnt lgkmcnt(8)
    v_pk_fma_f32 v[80:81], v[80:81], v[136:137], v[128:129]
    v_pk_fma_f32 v[82:83], v[82:83], v[138:139], v[130:131]
    v_pk_fma_f32 v[84:85], v[84:85], v[140:141], v[132:133]
    v_pk_fma_f32 v[86:87], v[86:87], v[142:143], v[134:135]
    ds_read_b128 v[128:131], v243 offset:128
    ds_read_b128 v[132:135], v243 offset:144
    ds_read_b128 v[136:139], v243 offset:1152
    ds_read_b128 v[140:143], v243 offset:1168
    v_cvt_pk_bf16_f32 v32, v80, v81
    v_cvt_pk_bf16_f32 v33, v82, v83
    v_cvt_pk_bf16_f32 v34, v84, v85
    v_cvt_pk_bf16_f32 v35, v86, v87
    buffer_store_dwordx4 v[32:35], v4, s[4:7], s55 offen offset:0 sc1
    s_waitcnt lgkmcnt(8)
    v_pk_fma_f32 v[88:89], v[88:89], v[152:153], v[144:145]
    v_pk_fma_f32 v[90:91], v[90:91], v[154:155], v[146:147]
    v_pk_fma_f32 v[92:93], v[92:93], v[156:157], v[148:149]
    v_pk_fma_f32 v[94:95], v[94:95], v[158:159], v[150:151]
    v_cvt_pk_bf16_f32 v36, v88, v89
    v_cvt_pk_bf16_f32 v37, v90, v91
    v_cvt_pk_bf16_f32 v38, v92, v93
    v_cvt_pk_bf16_f32 v39, v94, v95
    buffer_store_dwordx4 v[36:39], v4, s[4:7], s55 offen offset:2048 sc1
    s_waitcnt lgkmcnt(4)
    v_pk_fma_f32 v[96:97], v[96:97], v[120:121], v[112:113]
    v_pk_fma_f32 v[98:99], v[98:99], v[122:123], v[114:115]
    v_pk_fma_f32 v[100:101], v[100:101], v[124:125], v[116:117]
    v_pk_fma_f32 v[102:103], v[102:103], v[126:127], v[118:119]
    v_cvt_pk_bf16_f32 v40, v96, v97
    v_cvt_pk_bf16_f32 v41, v98, v99
    v_cvt_pk_bf16_f32 v42, v100, v101
    v_cvt_pk_bf16_f32 v43, v102, v103
    buffer_store_dwordx4 v[40:43], v4, s[4:7], s56 offen offset:0 sc1
    s_waitcnt lgkmcnt(0)
    v_pk_fma_f32 v[104:105], v[104:105], v[136:137], v[128:129]
    v_pk_fma_f32 v[106:107], v[106:107], v[138:139], v[130:131]
    v_pk_fma_f32 v[108:109], v[108:109], v[140:141], v[132:133]
    v_pk_fma_f32 v[110:111], v[110:111], v[142:143], v[134:135]
    v_cvt_pk_bf16_f32 v44, v104, v105
    v_cvt_pk_bf16_f32 v45, v106, v107
    v_cvt_pk_bf16_f32 v46, v108, v109
    v_cvt_pk_bf16_f32 v47, v110, v111
    buffer_store_dwordx4 v[44:47], v4, s[4:7], s56 offen offset:2048 sc1
    v_bfe_u32 v11, v0, 2, 2
    v_lshl_add_u32 v11, v15, 3, v11
    v_lshlrev_b32 v11, 6, v11
    v_and_b32 v10, 3, v0
    v_lshl_add_u32 v11, v10, 3, v11
    s_lshl_b32 s53, s57, 12
    s_lshl_b32 s48, s43, 14
    s_add_u32 s53, s53, s48
    s_add_u32 s53, s53, 65536
    v_add_u32 v240, s53, v11
    v_xor_b32 v241, 4096, v240
    v_xor_b32 v242, 8192, v240
    v_xor_b32 v243, 12288, v240
    v_mov_b32 v12, 140040
    s_mov_b32 s47, 2097152
adaLN_cond__grouped_kv_mqa__mixer_gmlp__prompt_kernel_ls2:
    ds_read_b32 v13, v12
    s_sub_u32 s47, s47, 1
    s_waitcnt lgkmcnt(0)
    v_cmp_gt_u32 vcc, 4, v13
    s_cmp_eq_u32 s47, 0
    s_cbranch_scc1 adaLN_cond__grouped_kv_mqa__mixer_gmlp__prompt_kernel_ls2_x
    s_cbranch_vccnz adaLN_cond__grouped_kv_mqa__mixer_gmlp__prompt_kernel_ls2
adaLN_cond__grouped_kv_mqa__mixer_gmlp__prompt_kernel_ls2_x:
    s_cmp_eq_u32 s101, 0
    s_cbranch_scc1 adaLN_cond__grouped_kv_mqa__mixer_gmlp__prompt_kernel_c3
    s_lshl_b32 s46, s51, 7
    s_add_u32 s46, s46, 1605632
    v_mov_b32 v2, 1
    s_mov_b64 exec, 1
    s_waitcnt vmcnt(0)
    buffer_atomic_add v2, off, s[4:7], s46 sc1
    s_mov_b64 exec, -1
adaLN_cond__grouped_kv_mqa__mixer_gmlp__prompt_kernel_c3:
    v_mov_b32 v12, 140036
    s_mov_b32 s47, 2097152
adaLN_cond__grouped_kv_mqa__mixer_gmlp__prompt_kernel_ls1:
    ds_read_b32 v13, v12
    s_sub_u32 s47, s47, 1
    s_waitcnt lgkmcnt(0)
    v_cmp_gt_u32 vcc, 4, v13
    s_cmp_eq_u32 s47, 0
    s_cbranch_scc1 adaLN_cond__grouped_kv_mqa__mixer_gmlp__prompt_kernel_ls1_x
    s_cbranch_vccnz adaLN_cond__grouped_kv_mqa__mixer_gmlp__prompt_kernel_ls1
adaLN_cond__grouped_kv_mqa__mixer_gmlp__prompt_kernel_ls1_x:
    ds_read_b64_tr_b16 v[160:161], v240 offset:0
    ds_read_b64_tr_b16 v[162:163], v240 offset:256
    ds_read_b64_tr_b16 v[164:165], v240 offset:32
    ds_read_b64_tr_b16 v[166:167], v240 offset:288
    ds_read_b64_tr_b16 v[168:169], v240 offset:2048
    ds_read_b64_tr_b16 v[170:171], v240 offset:2304
    ds_read_b64_tr_b16 v[172:173], v240 offset:2080
    ds_read_b64_tr_b16 v[174:175], v240 offset:2336
    ds_read_b64_tr_b16 v[176:177], v241 offset:0
    ds_read_b64_tr_b16 v[178:179], v241 offset:256
    ds_read_b64_tr_b16 v[180:181], v241 offset:32
    ds_read_b64_tr_b16 v[182:183], v241 offset:288
    ds_read_b64_tr_b16 v[184:185], v241 offset:2048
    ds_read_b64_tr_b16 v[186:187], v241 offset:2304
    ds_read_b64_tr_b16 v[188:189], v241 offset:2080
    ds_read_b64_tr_b16 v[190:191], v241 offset:2336
    ds_read_b64_tr_b16 v[192:193], v242 offset:0
    ds_read_b64_tr_b16 v[194:195], v242 offset:256
    ds_read_b64_tr_b16 v[196:197], v242 offset:32
    ds_read_b64_tr_b16 v[198:199], v242 offset:288
    ds_read_b64_tr_b16 v[200:201], v242 offset:2048
    ds_read_b64_tr_b16 v[202:203], v242 offset:2304
    ds_read_b64_tr_b16 v[204:205], v242 offset:2080
    ds_read_b64_tr_b16 v[206:207], v242 offset:2336
    ds_read_b64_tr_b16 v[208:209], v243 offset:0
    ds_read_b64_tr_b16 v[210:211], v243 offset:256
    ds_read_b64_tr_b16 v[212:213], v243 offset:32
    ds_read_b64_tr_b16 v[214:215], v243 offset:288
    ds_read_b64_tr_b16 v[216:217], v243 offset:2048
    ds_read_b64_tr_b16 v[218:219], v243 offset:2304
    ds_read_b64_tr_b16 v[220:221], v243 offset:2080
    ds_read_b64_tr_b16 v[222:223], v243 offset:2336
    s_waitcnt lgkmcnt(0)
    s_cmp_eq_u32 s50, 0
    s_cbranch_scc0 adaLN_cond__grouped_kv_mqa__mixer_gmlp__prompt_kernel_v
    v_mfma_f32_16x16x32_bf16 v[48:51], v[160:163], v[16:19], 0
    v_mfma_f32_16x16x32_bf16 v[52:55], v[164:167], v[16:19], 0
    v_mfma_f32_16x16x32_bf16 v[48:51], v[168:171], v[20:23], v[48:51]
    v_mfma_f32_16x16x32_bf16 v[52:55], v[172:175], v[20:23], v[52:55]
    v_mfma_f32_16x16x32_bf16 v[48:51], v[176:179], v[24:27], v[48:51]
    v_mfma_f32_16x16x32_bf16 v[52:55], v[180:183], v[24:27], v[52:55]
    v_mfma_f32_16x16x32_bf16 v[48:51], v[184:187], v[28:31], v[48:51]
    v_mfma_f32_16x16x32_bf16 v[52:55], v[188:191], v[28:31], v[52:55]
    v_mfma_f32_16x16x32_bf16 v[48:51], v[192:195], v[32:35], v[48:51]
    v_mfma_f32_16x16x32_bf16 v[52:55], v[196:199], v[32:35], v[52:55]
    v_mfma_f32_16x16x32_bf16 v[48:51], v[200:203], v[36:39], v[48:51]
    v_mfma_f32_16x16x32_bf16 v[52:55], v[204:207], v[36:39], v[52:55]
    v_mfma_f32_16x16x32_bf16 v[48:51], v[208:211], v[40:43], v[48:51]
    v_mfma_f32_16x16x32_bf16 v[52:55], v[212:215], v[40:43], v[52:55]
    v_mfma_f32_16x16x32_bf16 v[48:51], v[216:219], v[44:47], v[48:51]
    v_mfma_f32_16x16x32_bf16 v[52:55], v[220:223], v[44:47], v[52:55]
    s_branch adaLN_cond__grouped_kv_mqa__mixer_gmlp__prompt_kernel_kv
adaLN_cond__grouped_kv_mqa__mixer_gmlp__prompt_kernel_v:
    v_mfma_f32_16x16x32_bf16 v[48:51], v[16:19], v[160:163], 0
    v_mfma_f32_16x16x32_bf16 v[52:55], v[16:19], v[164:167], 0
    v_mfma_f32_16x16x32_bf16 v[48:51], v[20:23], v[168:171], v[48:51]
    v_mfma_f32_16x16x32_bf16 v[52:55], v[20:23], v[172:175], v[52:55]
    v_mfma_f32_16x16x32_bf16 v[48:51], v[24:27], v[176:179], v[48:51]
    v_mfma_f32_16x16x32_bf16 v[52:55], v[24:27], v[180:183], v[52:55]
    v_mfma_f32_16x16x32_bf16 v[48:51], v[28:31], v[184:187], v[48:51]
    v_mfma_f32_16x16x32_bf16 v[52:55], v[28:31], v[188:191], v[52:55]
    v_mfma_f32_16x16x32_bf16 v[48:51], v[32:35], v[192:195], v[48:51]
    v_mfma_f32_16x16x32_bf16 v[52:55], v[32:35], v[196:199], v[52:55]
    v_mfma_f32_16x16x32_bf16 v[48:51], v[36:39], v[200:203], v[48:51]
    v_mfma_f32_16x16x32_bf16 v[52:55], v[36:39], v[204:207], v[52:55]
    v_mfma_f32_16x16x32_bf16 v[48:51], v[40:43], v[208:211], v[48:51]
    v_mfma_f32_16x16x32_bf16 v[52:55], v[40:43], v[212:215], v[52:55]
    v_mfma_f32_16x16x32_bf16 v[48:51], v[44:47], v[216:219], v[48:51]
    v_mfma_f32_16x16x32_bf16 v[52:55], v[44:47], v[220:223], v[52:55]
adaLN_cond__grouped_kv_mqa__mixer_gmlp__prompt_kernel_kv:
    v_lshl_add_u32 v10, v1, 11, v3
    v_add_u32 v10, 140288, v10
    s_mov_b32 s32, s88
    s_mov_b32 s33, s89
    s_mov_b32 s34, 0x400000
    s_mov_b32 s35, 0x00020000
    s_mov_b32 s36, s80
    s_mov_b32 s37, s81
    s_mov_b32 s38, 0x1000
    s_mov_b32 s39, 0x00020000
    ds_write_b128 v10, v[48:51]
    ds_write_b128 v10, v[52:55] offset:1024
    s_waitcnt lgkmcnt(0)
    s_barrier
    s_mov_b32 s51, 0
    v_mov_b32 v240, v248
    v_mov_b32 v241, v249
    v_mov_b32 v242, v250
    v_mov_b32 v243, v251
    ds_read_b64_tr_b16 v[48:49], v240 offset:0
    ds_read_b64_tr_b16 v[50:51], v240 offset:512
    ds_read_b64_tr_b16 v[52:53], v240 offset:4096
    ds_read_b64_tr_b16 v[54:55], v240 offset:4608
    ds_read_b64_tr_b16 v[56:57], v241 offset:0
    ds_read_b64_tr_b16 v[58:59], v241 offset:512
    ds_read_b64_tr_b16 v[60:61], v241 offset:4096
    ds_read_b64_tr_b16 v[62:63], v241 offset:4608
    ds_read_b64_tr_b16 v[64:65], v242 offset:0
    ds_read_b64_tr_b16 v[66:67], v242 offset:512
    ds_read_b64_tr_b16 v[68:69], v242 offset:4096
    ds_read_b64_tr_b16 v[70:71], v242 offset:4608
    v_pk_mul_f32 v[16:17], 0, 0
    v_pk_mul_f32 v[18:19], 0, 0
    v_pk_mul_f32 v[20:21], 0, 0
    v_pk_mul_f32 v[22:23], 0, 0
    v_pk_mul_f32 v[24:25], 0, 0
    v_pk_mul_f32 v[26:27], 0, 0
    v_pk_mul_f32 v[28:29], 0, 0
    v_pk_mul_f32 v[30:31], 0, 0
    v_pk_mul_f32 v[32:33], 0, 0
    v_pk_mul_f32 v[34:35], 0, 0
    v_pk_mul_f32 v[36:37], 0, 0
    v_pk_mul_f32 v[38:39], 0, 0
    v_pk_mul_f32 v[40:41], 0, 0
    v_pk_mul_f32 v[42:43], 0, 0
    v_pk_mul_f32 v[44:45], 0, 0
    v_pk_mul_f32 v[46:47], 0, 0
    v_pk_mul_f32 v[88:89], 0, 0
    v_pk_mul_f32 v[90:91], 0, 0
    v_pk_mul_f32 v[92:93], 0, 0
    v_pk_mul_f32 v[94:95], 0, 0
    v_pk_mul_f32 v[96:97], 0, 0
    v_pk_mul_f32 v[98:99], 0, 0
    v_pk_mul_f32 v[100:101], 0, 0
    v_pk_mul_f32 v[102:103], 0, 0
    v_pk_mul_f32 v[104:105], 0, 0
    v_pk_mul_f32 v[106:107], 0, 0
    v_pk_mul_f32 v[108:109], 0, 0
    v_pk_mul_f32 v[110:111], 0, 0
    v_pk_mul_f32 v[112:113], 0, 0
    v_pk_mul_f32 v[114:115], 0, 0
    v_pk_mul_f32 v[116:117], 0, 0
    v_pk_mul_f32 v[118:119], 0, 0
    v_pk_mul_f32 v[120:121], 0, 0
    v_pk_mul_f32 v[122:123], 0, 0
    v_pk_mul_f32 v[124:125], 0, 0
    v_pk_mul_f32 v[126:127], 0, 0
    v_pk_mul_f32 v[128:129], 0, 0
    v_pk_mul_f32 v[130:131], 0, 0
    v_pk_mul_f32 v[132:133], 0, 0
    v_pk_mul_f32 v[134:135], 0, 0
    v_pk_mul_f32 v[148:149], 0, 0
    v_pk_mul_f32 v[150:151], 0, 0
    v_mov_b32 v156, 0xdddddddd
    v_and_b32 v8, 7, v0
    v_mov_b32 v9, 0x3f803f80
    v_cmp_eq_u32 vcc, 0, v8
    v_add_u32 v157, 131072, v3
    s_nop 0
    v_cndmask_b32 v152, 0, v9, vcc
    v_cndmask_b32 v153, 0, v9, vcc
    v_cmp_eq_u32 vcc, 4, v8
    s_nop 1
    v_cndmask_b32 v154, 0, v9, vcc
    v_cndmask_b32 v155, 0, v9, vcc
    s_mov_b32 s63, 3
    s_mov_b32 s62, 0
    s_mul_i32 s45, s44, 65536
    s_add_u32 s45, s45, 2097152
    s_add_u32 s96, s92, s45
    s_addc_u32 s97, s93, 0
    s_mov_b32 s98, 65536
    s_mov_b32 s50, 0
    s_lshl_b32 s46, s44, 7
    s_add_u32 s46, s46, 1605632
    s_mov_b32 s47, 262144
    s_mov_b64 exec, 1
adaLN_cond__grouped_kv_mqa__mixer_gmlp__prompt_kernel_ph:
    v_mov_b32 v1, 0
    buffer_atomic_add v1, off, s[4:7], s46 sc0 sc1
    s_sub_u32 s47, s47, 1
    s_waitcnt vmcnt(0)
    v_cmp_gt_u32 vcc, 8, v1
    s_cmp_eq_u32 s47, 0
    s_cbranch_scc1 adaLN_cond__grouped_kv_mqa__mixer_gmlp__prompt_kernel_ph_x
    s_cbranch_vccnz adaLN_cond__grouped_kv_mqa__mixer_gmlp__prompt_kernel_ph
adaLN_cond__grouped_kv_mqa__mixer_gmlp__prompt_kernel_ph_x:
    s_mov_b64 exec, -1
adaLN_cond__grouped_kv_mqa__mixer_gmlp__prompt_kernel_small:
    buffer_load_dwordx4 v[160:163], v4, s[96:99], s50 offen offset:0 sc1
    buffer_load_dwordx4 v[164:167], v4, s[96:99], s50 offen offset:2048 sc1
    buffer_load_dwordx4 v[168:171], v4, s[96:99], s50 offen offset:256 sc1
    buffer_load_dwordx4 v[172:175], v4, s[96:99], s50 offen offset:2304 sc1
    s_add_u32 s50, s50, 4096
    buffer_load_dwordx4 v[176:179], v4, s[96:99], s50 offen offset:0 sc1
    buffer_load_dwordx4 v[180:183], v4, s[96:99], s50 offen offset:2048 sc1
    buffer_load_dwordx4 v[184:187], v4, s[96:99], s50 offen offset:256 sc1
    buffer_load_dwordx4 v[188:191], v4, s[96:99], s50 offen offset:2304 sc1
    s_add_u32 s50, s50, 4096
    buffer_load_dwordx4 v[192:195], v4, s[96:99], s50 offen offset:0 sc1
    buffer_load_dwordx4 v[196:199], v4, s[96:99], s50 offen offset:2048 sc1
    buffer_load_dwordx4 v[200:203], v4, s[96:99], s50 offen offset:256 sc1
    buffer_load_dwordx4 v[204:207], v4, s[96:99], s50 offen offset:2304 sc1
    s_add_u32 s50, s50, 4096
.p2align 6
adaLN_cond__grouped_kv_mqa__mixer_gmlp__prompt_kernel_ls:
    s_waitcnt vmcnt(8) lgkmcnt(8)
    v_mfma_f32_16x16x32_bf16 v[16:19], v[48:51], v[160:163], v[16:19]
    ds_read_b64_tr_b16 v[72:73], v243 offset:0
    v_mfma_f32_16x16x32_bf16 v[16:19], v[52:55], v[164:167], v[16:19]
    ds_read_b64_tr_b16 v[74:75], v243 offset:512
    buffer_load_dwordx4 v[208:211], v4, s[96:99], s50 offen offset:0 sc1
    v_mfma_f32_16x16x32_bf16 v[20:23], v[52:55], v[172:175], v[20:23]
    ds_read_b64_tr_b16 v[76:77], v243 offset:4096
    s_add_u32 s51, s51, 32768
    v_mfma_f32_16x16x32_bf16 v[20:23], v[48:51], v[168:171], v[20:23]
    ds_read_b64_tr_b16 v[78:79], v243 offset:4608
    s_waitcnt lgkmcnt(8)
    v_mfma_f32_16x16x32_bf16 v[28:31], v[56:59], v[168:171], v[28:31]
    ds_read_b64_tr_b16 v[48:49], v240 offset:8192
    v_mfma_f32_16x16x32_bf16 v[28:31], v[60:63], v[172:175], v[28:31]
    ds_read_b64_tr_b16 v[50:51], v240 offset:8704
    buffer_load_dwordx4 v[212:215], v4, s[96:99], s50 offen offset:2048 sc1
    v_mfma_f32_16x16x32_bf16 v[24:27], v[60:63], v[164:167], v[24:27]
    ds_read_b64_tr_b16 v[52:53], v240 offset:12288
    s_cmp_eq_u32 s51, 163840
    v_mfma_f32_16x16x32_bf16 v[24:27], v[56:59], v[160:163], v[24:27]
    ds_read_b64_tr_b16 v[54:55], v240 offset:12800
    s_waitcnt lgkmcnt(8)
    v_mfma_f32_16x16x32_bf16 v[32:35], v[64:67], v[160:163], v[32:35]
    ds_read_b64_tr_b16 v[56:57], v241 offset:8192
    v_mfma_f32_16x16x32_bf16 v[32:35], v[68:71], v[164:167], v[32:35]
    ds_read_b64_tr_b16 v[58:59], v241 offset:8704
    buffer_load_dwordx4 v[216:219], v4, s[96:99], s50 offen offset:256 sc1
    v_mfma_f32_16x16x32_bf16 v[36:39], v[68:71], v[172:175], v[36:39]
    ds_read_b64_tr_b16 v[60:61], v241 offset:12288
    s_cselect_b32 s51, 0, s51
    v_mfma_f32_16x16x32_bf16 v[36:39], v[64:67], v[168:171], v[36:39]
    ds_read_b64_tr_b16 v[62:63], v241 offset:12800
    s_waitcnt lgkmcnt(8)
    v_mfma_f32_16x16x32_bf16 v[44:47], v[72:75], v[168:171], v[44:47]
    ds_read_b64_tr_b16 v[64:65], v242 offset:8192
    v_mfma_f32_16x16x32_bf16 v[44:47], v[76:79], v[172:175], v[44:47]
    ds_read_b64_tr_b16 v[66:67], v242 offset:8704
    buffer_load_dwordx4 v[220:223], v4, s[96:99], s50 offen offset:2304 sc1
    v_mfma_f32_16x16x32_bf16 v[40:43], v[76:79], v[164:167], v[40:43]
    ds_read_b64_tr_b16 v[68:69], v242 offset:12288
    s_add_u32 s50, s50, 4096
    v_mfma_f32_16x16x32_bf16 v[40:43], v[72:75], v[160:163], v[40:43]
    ds_read_b64_tr_b16 v[70:71], v242 offset:12800
    s_waitcnt vmcnt(8) lgkmcnt(8)
    v_mfma_f32_16x16x32_bf16 v[16:19], v[48:51], v[176:179], v[16:19]
    ds_read_b64_tr_b16 v[72:73], v243 offset:8192
    v_mfma_f32_16x16x32_bf16 v[16:19], v[52:55], v[180:183], v[16:19]
    ds_read_b64_tr_b16 v[74:75], v243 offset:8704
    buffer_load_dwordx4 v[160:163], v4, s[96:99], s50 offen offset:0 sc1
    v_mfma_f32_16x16x32_bf16 v[20:23], v[52:55], v[188:191], v[20:23]
    ds_read_b64_tr_b16 v[76:77], v243 offset:12288
    v_mfma_f32_16x16x32_bf16 v[20:23], v[48:51], v[184:187], v[20:23]
    ds_read_b64_tr_b16 v[78:79], v243 offset:12800
    s_waitcnt lgkmcnt(8)
    v_mfma_f32_16x16x32_bf16 v[28:31], v[56:59], v[184:187], v[28:31]
    ds_read_b64_tr_b16 v[48:49], v240 offset:16384
    v_mfma_f32_16x16x32_bf16 v[28:31], v[60:63], v[188:191], v[28:31]
    ds_read_b64_tr_b16 v[50:51], v240 offset:16896
    buffer_load_dwordx4 v[164:167], v4, s[96:99], s50 offen offset:2048 sc1
    v_mfma_f32_16x16x32_bf16 v[24:27], v[60:63], v[180:183], v[24:27]
    ds_read_b64_tr_b16 v[52:53], v240 offset:20480
    v_mfma_f32_16x16x32_bf16 v[24:27], v[56:59], v[176:179], v[24:27]
    ds_read_b64_tr_b16 v[54:55], v240 offset:20992
    s_waitcnt lgkmcnt(8)
    v_mfma_f32_16x16x32_bf16 v[32:35], v[64:67], v[176:179], v[32:35]
    ds_read_b64_tr_b16 v[56:57], v241 offset:16384
    v_mfma_f32_16x16x32_bf16 v[32:35], v[68:71], v[180:183], v[32:35]
    ds_read_b64_tr_b16 v[58:59], v241 offset:16896
    buffer_load_dwordx4 v[168:171], v4, s[96:99], s50 offen offset:256 sc1
    v_mfma_f32_16x16x32_bf16 v[36:39], v[68:71], v[188:191], v[36:39]
    ds_read_b64_tr_b16 v[60:61], v241 offset:20480
    v_mfma_f32_16x16x32_bf16 v[36:39], v[64:67], v[184:187], v[36:39]
    ds_read_b64_tr_b16 v[62:63], v241 offset:20992
    s_waitcnt lgkmcnt(8)
    v_mfma_f32_16x16x32_bf16 v[44:47], v[72:75], v[184:187], v[44:47]
    ds_read_b64_tr_b16 v[64:65], v242 offset:16384
    v_mfma_f32_16x16x32_bf16 v[44:47], v[76:79], v[188:191], v[44:47]
    ds_read_b64_tr_b16 v[66:67], v242 offset:16896
    buffer_load_dwordx4 v[172:175], v4, s[96:99], s50 offen offset:2304 sc1
    v_mfma_f32_16x16x32_bf16 v[40:43], v[76:79], v[180:183], v[40:43]
    ds_read_b64_tr_b16 v[68:69], v242 offset:20480
    s_add_u32 s50, s50, 4096
    v_mfma_f32_16x16x32_bf16 v[40:43], v[72:75], v[176:179], v[40:43]
    ds_read_b64_tr_b16 v[70:71], v242 offset:20992
    s_waitcnt vmcnt(8) lgkmcnt(8)
    v_mfma_f32_16x16x32_bf16 v[16:19], v[48:51], v[192:195], v[16:19]
    ds_read_b64_tr_b16 v[72:73], v243 offset:16384
    v_mfma_f32_16x16x32_bf16 v[16:19], v[52:55], v[196:199], v[16:19]
    ds_read_b64_tr_b16 v[74:75], v243 offset:16896
    buffer_load_dwordx4 v[176:179], v4, s[96:99], s50 offen offset:0 sc1
    v_mfma_f32_16x16x32_bf16 v[20:23], v[52:55], v[204:207], v[20:23]
    ds_read_b64_tr_b16 v[76:77], v243 offset:20480
    v_mfma_f32_16x16x32_bf16 v[20:23], v[48:51], v[200:203], v[20:23]
    ds_read_b64_tr_b16 v[78:79], v243 offset:20992
    s_waitcnt lgkmcnt(8)
    v_mfma_f32_16x16x32_bf16 v[28:31], v[56:59], v[200:203], v[28:31]
    ds_read_b64_tr_b16 v[48:49], v240 offset:24576
    v_mfma_f32_16x16x32_bf16 v[28:31], v[60:63], v[204:207], v[28:31]
    ds_read_b64_tr_b16 v[50:51], v240 offset:25088
    buffer_load_dwordx4 v[180:183], v4, s[96:99], s50 offen offset:2048 sc1
    v_mfma_f32_16x16x32_bf16 v[24:27], v[60:63], v[196:199], v[24:27]
    ds_read_b64_tr_b16 v[52:53], v240 offset:28672
    v_mfma_f32_16x16x32_bf16 v[24:27], v[56:59], v[192:195], v[24:27]
    ds_read_b64_tr_b16 v[54:55], v240 offset:29184
    s_waitcnt lgkmcnt(8)
    v_mfma_f32_16x16x32_bf16 v[32:35], v[64:67], v[192:195], v[32:35]
    ds_read_b64_tr_b16 v[56:57], v241 offset:24576
    v_add_u32 v240, s51, v248
    v_mfma_f32_16x16x32_bf16 v[32:35], v[68:71], v[196:199], v[32:35]
    ds_read_b64_tr_b16 v[58:59], v241 offset:25088
    buffer_load_dwordx4 v[184:187], v4, s[96:99], s50 offen offset:256 sc1
    v_mfma_f32_16x16x32_bf16 v[36:39], v[68:71], v[204:207], v[36:39]
    ds_read_b64_tr_b16 v[60:61], v241 offset:28672
    v_mfma_f32_16x16x32_bf16 v[36:39], v[64:67], v[200:203], v[36:39]
    ds_read_b64_tr_b16 v[62:63], v241 offset:29184
    s_waitcnt lgkmcnt(8)
    v_mfma_f32_16x16x32_bf16 v[44:47], v[72:75], v[200:203], v[44:47]
    ds_read_b64_tr_b16 v[64:65], v242 offset:24576
    v_add_u32 v241, s51, v249
    v_mfma_f32_16x16x32_bf16 v[44:47], v[76:79], v[204:207], v[44:47]
    ds_read_b64_tr_b16 v[66:67], v242 offset:25088
    buffer_load_dwordx4 v[188:191], v4, s[96:99], s50 offen offset:2304 sc1
    v_mfma_f32_16x16x32_bf16 v[40:43], v[76:79], v[196:199], v[40:43]
    ds_read_b64_tr_b16 v[68:69], v242 offset:28672
    s_add_u32 s50, s50, 4096
    v_mfma_f32_16x16x32_bf16 v[40:43], v[72:75], v[192:195], v[40:43]
    ds_read_b64_tr_b16 v[70:71], v242 offset:29184
    s_waitcnt vmcnt(8) lgkmcnt(8)
    v_mfma_f32_16x16x32_bf16 v[16:19], v[48:51], v[208:211], v[16:19]
    ds_read_b64_tr_b16 v[72:73], v243 offset:24576
    v_add_u32 v242, s51, v250
    v_mfma_f32_16x16x32_bf16 v[16:19], v[52:55], v[212:215], v[16:19]
    ds_read_b64_tr_b16 v[74:75], v243 offset:25088
    buffer_load_dwordx4 v[192:195], v4, s[96:99], s50 offen offset:0 sc1
    v_mfma_f32_16x16x32_bf16 v[20:23], v[52:55], v[220:223], v[20:23]
    ds_read_b64_tr_b16 v[76:77], v243 offset:28672
    v_mfma_f32_16x16x32_bf16 v[20:23], v[48:51], v[216:219], v[20:23]
    ds_read_b64_tr_b16 v[78:79], v243 offset:29184
    s_barrier
    s_waitcnt lgkmcnt(8)
    v_mfma_f32_16x16x32_bf16 v[28:31], v[56:59], v[216:219], v[28:31]
    ds_read_b64_tr_b16 v[48:49], v240 offset:0
    v_add_u32 v243, s51, v251
    v_mfma_f32_16x16x32_bf16 v[28:31], v[60:63], v[220:223], v[28:31]
    ds_read_b64_tr_b16 v[50:51], v240 offset:512
    buffer_load_dwordx4 v[196:199], v4, s[96:99], s50 offen offset:2048 sc1
    v_mfma_f32_16x16x32_bf16 v[24:27], v[60:63], v[212:215], v[24:27]
    ds_read_b64_tr_b16 v[52:53], v240 offset:4096
    v_mfma_f32_16x16x32_bf16 v[24:27], v[56:59], v[208:211], v[24:27]
    ds_read_b64_tr_b16 v[54:55], v240 offset:4608
    s_waitcnt lgkmcnt(8)
    v_mfma_f32_16x16x32_bf16 v[32:35], v[64:67], v[208:211], v[32:35]
    ds_read_b64_tr_b16 v[56:57], v241 offset:0
    v_mfma_f32_16x16x32_bf16 v[32:35], v[68:71], v[212:215], v[32:35]
    ds_read_b64_tr_b16 v[58:59], v241 offset:512
    buffer_load_dwordx4 v[200:203], v4, s[96:99], s50 offen offset:256 sc1
    v_mfma_f32_16x16x32_bf16 v[36:39], v[68:71], v[220:223], v[36:39]
    ds_read_b64_tr_b16 v[60:61], v241 offset:4096
    v_mfma_f32_16x16x32_bf16 v[36:39], v[64:67], v[216:219], v[36:39]
    ds_read_b64_tr_b16 v[62:63], v241 offset:4608
    s_waitcnt lgkmcnt(8)
    v_mfma_f32_16x16x32_bf16 v[44:47], v[72:75], v[216:219], v[44:47]
    ds_read_b64_tr_b16 v[64:65], v242 offset:0
    v_mfma_f32_16x16x32_bf16 v[44:47], v[76:79], v[220:223], v[44:47]
    ds_read_b64_tr_b16 v[66:67], v242 offset:512
    buffer_load_dwordx4 v[204:207], v4, s[96:99], s50 offen offset:2304 sc1
    v_mfma_f32_16x16x32_bf16 v[40:43], v[76:79], v[212:215], v[40:43]
    ds_read_b64_tr_b16 v[68:69], v242 offset:4096
    s_add_u32 s50, s50, 4096
    s_sub_u32 s63, s63, 1
    s_cmp_lg_u32 s63, 0
    v_mfma_f32_16x16x32_bf16 v[40:43], v[72:75], v[208:211], v[40:43]
    ds_read_b64_tr_b16 v[70:71], v242 offset:4608
    s_cbranch_scc1 adaLN_cond__grouped_kv_mqa__mixer_gmlp__prompt_kernel_ls
    s_waitcnt vmcnt(8) lgkmcnt(8)
    v_mfma_f32_16x16x32_bf16 v[16:19], v[48:51], v[160:163], v[16:19]
    ds_read_b64_tr_b16 v[72:73], v243 offset:0
    v_mfma_f32_16x16x32_bf16 v[16:19], v[52:55], v[164:167], v[16:19]
    ds_read_b64_tr_b16 v[74:75], v243 offset:512
    buffer_load_dwordx4 v[208:211], v4, s[96:99], s50 offen offset:0 sc1
    v_mfma_f32_16x16x32_bf16 v[20:23], v[52:55], v[172:175], v[20:23]
    ds_read_b64_tr_b16 v[76:77], v243 offset:4096
    v_mfma_f32_16x16x32_bf16 v[20:23], v[48:51], v[168:171], v[20:23]
    ds_read_b64_tr_b16 v[78:79], v243 offset:4608
    s_waitcnt lgkmcnt(8)
    v_mfma_f32_16x16x32_bf16 v[28:31], v[56:59], v[168:171], v[28:31]
    ds_read_b64_tr_b16 v[48:49], v240 offset:8192
    v_mfma_f32_16x16x32_bf16 v[28:31], v[60:63], v[172:175], v[28:31]
    ds_read_b64_tr_b16 v[50:51], v240 offset:8704
    buffer_load_dwordx4 v[212:215], v4, s[96:99], s50 offen offset:2048 sc1
    v_mfma_f32_16x16x32_bf16 v[24:27], v[60:63], v[164:167], v[24:27]
    ds_read_b64_tr_b16 v[52:53], v240 offset:12288
    v_mfma_f32_16x16x32_bf16 v[24:27], v[56:59], v[160:163], v[24:27]
    ds_read_b64_tr_b16 v[54:55], v240 offset:12800
    s_waitcnt lgkmcnt(8)
    v_mfma_f32_16x16x32_bf16 v[32:35], v[64:67], v[160:163], v[32:35]
    ds_read_b64_tr_b16 v[56:57], v241 offset:8192
    v_mfma_f32_16x16x32_bf16 v[32:35], v[68:71], v[164:167], v[32:35]
    ds_read_b64_tr_b16 v[58:59], v241 offset:8704
    buffer_load_dwordx4 v[216:219], v4, s[96:99], s50 offen offset:256 sc1
    v_mfma_f32_16x16x32_bf16 v[36:39], v[68:71], v[172:175], v[36:39]
    ds_read_b64_tr_b16 v[60:61], v241 offset:12288
    v_mfma_f32_16x16x32_bf16 v[36:39], v[64:67], v[168:171], v[36:39]
    ds_read_b64_tr_b16 v[62:63], v241 offset:12800
    s_waitcnt lgkmcnt(8)
    v_mfma_f32_16x16x32_bf16 v[44:47], v[72:75], v[168:171], v[44:47]
    ds_read_b64_tr_b16 v[64:65], v242 offset:8192
    v_mfma_f32_16x16x32_bf16 v[44:47], v[76:79], v[172:175], v[44:47]
    ds_read_b64_tr_b16 v[66:67], v242 offset:8704
    buffer_load_dwordx4 v[220:223], v4, s[96:99], s50 offen offset:2304 sc1
    v_mfma_f32_16x16x32_bf16 v[40:43], v[76:79], v[164:167], v[40:43]
    ds_read_b64_tr_b16 v[68:69], v242 offset:12288
    s_add_u32 s50, s50, 4096
    v_mfma_f32_16x16x32_bf16 v[40:43], v[72:75], v[160:163], v[40:43]
    ds_read_b64_tr_b16 v[70:71], v242 offset:12800
    s_barrier
    s_waitcnt vmcnt(8) lgkmcnt(8)
    v_mfma_f32_16x16x32_bf16 v[16:19], v[48:51], v[176:179], v[16:19]
    ds_read_b64_tr_b16 v[72:73], v243 offset:8192
    v_mfma_f32_16x16x32_bf16 v[16:19], v[52:55], v[180:183], v[16:19]
    ds_read_b64_tr_b16 v[74:75], v243 offset:8704
    v_mfma_f32_16x16x32_bf16 v[20:23], v[52:55], v[188:191], v[20:23]
    ds_read_b64_tr_b16 v[76:77], v243 offset:12288
    v_mfma_f32_16x16x32_bf16 v[20:23], v[48:51], v[184:187], v[20:23]
    ds_read_b64_tr_b16 v[78:79], v243 offset:12800
    s_waitcnt lgkmcnt(8)
    v_mfma_f32_16x16x32_bf16 v[28:31], v[56:59], v[184:187], v[28:31]
    ds_read_b64_tr_b16 v[48:49], v240 offset:16384
    v_mfma_f32_16x16x32_bf16 v[28:31], v[60:63], v[188:191], v[28:31]
    ds_read_b64_tr_b16 v[50:51], v240 offset:16896
    v_mfma_f32_16x16x32_bf16 v[24:27], v[60:63], v[180:183], v[24:27]
    ds_read_b64_tr_b16 v[52:53], v240 offset:20480
    v_mfma_f32_16x16x32_bf16 v[24:27], v[56:59], v[176:179], v[24:27]
    ds_read_b64_tr_b16 v[54:55], v240 offset:20992
    s_waitcnt lgkmcnt(8)
    v_mfma_f32_16x16x32_bf16 v[32:35], v[64:67], v[176:179], v[32:35]
    ds_read_b64_tr_b16 v[56:57], v241 offset:16384
    v_mfma_f32_16x16x32_bf16 v[32:35], v[68:71], v[180:183], v[32:35]
    ds_read_b64_tr_b16 v[58:59], v241 offset:16896
    v_mfma_f32_16x16x32_bf16 v[36:39], v[68:71], v[188:191], v[36:39]
    ds_read_b64_tr_b16 v[60:61], v241 offset:20480
    v_mfma_f32_16x16x32_bf16 v[36:39], v[64:67], v[184:187], v[36:39]
    ds_read_b64_tr_b16 v[62:63], v241 offset:20992
    s_waitcnt lgkmcnt(8)
    v_mfma_f32_16x16x32_bf16 v[44:47], v[72:75], v[184:187], v[44:47]
    ds_read_b64_tr_b16 v[64:65], v242 offset:16384
    v_mfma_f32_16x16x32_bf16 v[44:47], v[76:79], v[188:191], v[44:47]
    ds_read_b64_tr_b16 v[66:67], v242 offset:16896
    v_mfma_f32_16x16x32_bf16 v[40:43], v[76:79], v[180:183], v[40:43]
    ds_read_b64_tr_b16 v[68:69], v242 offset:20480
    v_mfma_f32_16x16x32_bf16 v[40:43], v[72:75], v[176:179], v[40:43]
    ds_read_b64_tr_b16 v[70:71], v242 offset:20992
    s_waitcnt vmcnt(4) lgkmcnt(8)
    v_mfma_f32_16x16x32_bf16 v[16:19], v[48:51], v[192:195], v[16:19]
    ds_read_b64_tr_b16 v[72:73], v243 offset:16384
    v_mfma_f32_16x16x32_bf16 v[16:19], v[52:55], v[196:199], v[16:19]
    ds_read_b64_tr_b16 v[74:75], v243 offset:16896
    v_mfma_f32_16x16x32_bf16 v[20:23], v[52:55], v[204:207], v[20:23]
    ds_read_b64_tr_b16 v[76:77], v243 offset:20480
    v_mfma_f32_16x16x32_bf16 v[20:23], v[48:51], v[200:203], v[20:23]
    ds_read_b64_tr_b16 v[78:79], v243 offset:20992
    s_waitcnt lgkmcnt(8)
    v_mfma_f32_16x16x32_bf16 v[28:31], v[56:59], v[200:203], v[28:31]
    ds_read_b64_tr_b16 v[48:49], v240 offset:24576
    v_mfma_f32_16x16x32_bf16 v[28:31], v[60:63], v[204:207], v[28:31]
    ds_read_b64_tr_b16 v[50:51], v240 offset:25088
    v_mfma_f32_16x16x32_bf16 v[24:27], v[60:63], v[196:199], v[24:27]
    ds_read_b64_tr_b16 v[52:53], v240 offset:28672
    v_mfma_f32_16x16x32_bf16 v[24:27], v[56:59], v[192:195], v[24:27]
    ds_read_b64_tr_b16 v[54:55], v240 offset:29184
    s_waitcnt lgkmcnt(8)
    v_mfma_f32_16x16x32_bf16 v[32:35], v[64:67], v[192:195], v[32:35]
    ds_read_b64_tr_b16 v[56:57], v241 offset:24576
    v_mfma_f32_16x16x32_bf16 v[32:35], v[68:71], v[196:199], v[32:35]
    ds_read_b64_tr_b16 v[58:59], v241 offset:25088
    v_mfma_f32_16x16x32_bf16 v[36:39], v[68:71], v[204:207], v[36:39]
    ds_read_b64_tr_b16 v[60:61], v241 offset:28672
    v_mfma_f32_16x16x32_bf16 v[36:39], v[64:67], v[200:203], v[36:39]
    ds_read_b64_tr_b16 v[62:63], v241 offset:29184
    s_waitcnt lgkmcnt(8)
    v_mfma_f32_16x16x32_bf16 v[44:47], v[72:75], v[200:203], v[44:47]
    ds_read_b64_tr_b16 v[64:65], v242 offset:24576
    v_mfma_f32_16x16x32_bf16 v[44:47], v[76:79], v[204:207], v[44:47]
    ds_read_b64_tr_b16 v[66:67], v242 offset:25088
    v_mfma_f32_16x16x32_bf16 v[40:43], v[76:79], v[196:199], v[40:43]
    ds_read_b64_tr_b16 v[68:69], v242 offset:28672
    v_mfma_f32_16x16x32_bf16 v[40:43], v[72:75], v[192:195], v[40:43]
    ds_read_b64_tr_b16 v[70:71], v242 offset:29184
    s_waitcnt vmcnt(0) lgkmcnt(8)
    v_mfma_f32_16x16x32_bf16 v[16:19], v[48:51], v[208:211], v[16:19]
    ds_read_b64_tr_b16 v[72:73], v243 offset:24576
    v_mfma_f32_16x16x32_bf16 v[16:19], v[52:55], v[212:215], v[16:19]
    ds_read_b64_tr_b16 v[74:75], v243 offset:25088
    v_mfma_f32_16x16x32_bf16 v[20:23], v[52:55], v[220:223], v[20:23]
    ds_read_b64_tr_b16 v[76:77], v243 offset:28672
    v_mfma_f32_16x16x32_bf16 v[20:23], v[48:51], v[216:219], v[20:23]
    ds_read_b64_tr_b16 v[78:79], v243 offset:29184
    s_waitcnt lgkmcnt(8)
    v_mfma_f32_16x16x32_bf16 v[28:31], v[56:59], v[216:219], v[28:31]
    v_mfma_f32_16x16x32_bf16 v[28:31], v[60:63], v[220:223], v[28:31]
    v_mfma_f32_16x16x32_bf16 v[24:27], v[60:63], v[212:215], v[24:27]
    v_mfma_f32_16x16x32_bf16 v[24:27], v[56:59], v[208:211], v[24:27]
    s_waitcnt lgkmcnt(4)
    v_mfma_f32_16x16x32_bf16 v[32:35], v[64:67], v[208:211], v[32:35]
    v_mfma_f32_16x16x32_bf16 v[32:35], v[68:71], v[212:215], v[32:35]
    v_mfma_f32_16x16x32_bf16 v[36:39], v[68:71], v[220:223], v[36:39]
    v_mfma_f32_16x16x32_bf16 v[36:39], v[64:67], v[216:219], v[36:39]
    s_waitcnt lgkmcnt(0)
    v_mfma_f32_16x16x32_bf16 v[44:47], v[72:75], v[216:219], v[44:47]
    v_mfma_f32_16x16x32_bf16 v[44:47], v[76:79], v[220:223], v[44:47]
    v_mfma_f32_16x16x32_bf16 v[40:43], v[76:79], v[212:215], v[40:43]
    v_mfma_f32_16x16x32_bf16 v[40:43], v[72:75], v[208:211], v[40:43]
    s_cmp_eq_u32 s62, 1
    s_cbranch_scc1 adaLN_cond__grouped_kv_mqa__mixer_gmlp__prompt_kernel_after_wo
    s_cmp_eq_u32 s62, 2
    s_cbranch_scc1 adaLN_cond__grouped_kv_mqa__mixer_gmlp__prompt_kernel_after_wout
    buffer_load_dwordx4 v[224:227], v6, s[8:11], s49 offen offset:0
    buffer_load_dwordx4 v[228:231], v6, s[8:11], s49 offen offset:32
    buffer_load_dwordx4 v[232:235], v6, s[8:11], s49 offen offset:64
    buffer_load_dwordx4 v[236:239], v6, s[8:11], s49 offen offset:96
    v_and_b32 v8, 0xfffff800, v6
    s_lshl_b32 s45, s44, 16
    buffer_load_dwordx4 v[244:247], v8, s[8:11], s45 offen
    s_barrier
    ds_read_b128 v[136:139], v157 offset:0
    ds_read_b128 v[140:143], v157 offset:1024
    v_cvt_pk_bf16_f32 v48, v16, v17
    v_cvt_pk_bf16_f32 v49, v18, v19
    v_cvt_pk_bf16_f32 v50, v20, v21
    v_cvt_pk_bf16_f32 v51, v22, v23
    v_cvt_pk_bf16_f32 v52, v24, v25
    v_cvt_pk_bf16_f32 v53, v26, v27
    v_cvt_pk_bf16_f32 v54, v28, v29
    v_cvt_pk_bf16_f32 v55, v30, v31
    v_cvt_pk_bf16_f32 v56, v32, v33
    v_cvt_pk_bf16_f32 v57, v34, v35
    v_cvt_pk_bf16_f32 v58, v36, v37
    v_cvt_pk_bf16_f32 v59, v38, v39
    v_cvt_pk_bf16_f32 v60, v40, v41
    v_cvt_pk_bf16_f32 v61, v42, v43
    v_cvt_pk_bf16_f32 v62, v44, v45
    v_cvt_pk_bf16_f32 v63, v46, v47
    s_nop 1
    v_permlane16_swap_b32 v48, v50
    v_permlane16_swap_b32 v49, v51
    v_permlane16_swap_b32 v52, v54
    v_permlane16_swap_b32 v53, v55
    v_permlane16_swap_b32 v56, v58
    v_permlane16_swap_b32 v57, v59
    v_permlane16_swap_b32 v60, v62
    v_permlane16_swap_b32 v61, v63
    s_nop 0
    s_waitcnt lgkmcnt(0)
    v_mfma_f32_32x32x16_bf16 v[64:79], v[136:139], v[48:51], 0
    v_mfma_f32_32x32x16_bf16 v[64:79], v[140:143], v[52:55], v[64:79]
    ds_read_b128 v[144:147], v157 offset:2048
    s_mov_b32 s52, 0x4103210
    s_mov_b32 s58, 0
    s_nop 8
    s_mov_b32 s63, 8
adaLN_cond__grouped_kv_mqa__mixer_gmlp__prompt_kernel_aloop:
    v_exp_f32 v64, v64
    v_smfmac_f32_32x32x32_bf16 v[112:127], v[148:151], v[88:95], v156
    ds_read_b128 v[148:151], v157 offset:3072
    v_exp_f32 v65, v65
    v_exp_f32 v66, v66
    v_exp_f32 v67, v67
    v_smfmac_f32_16x16x64_bf16 v[132:135], v[152:155], v[88:95], v156
    v_exp_f32 v68, v68
    v_mfma_f32_32x32x16_bf16 v[80:95], v[136:139], v[56:59], 0
    v_exp_f32 v69, v69
    v_exp_f32 v70, v70
    v_exp_f32 v71, v71
    v_mfma_f32_32x32x16_bf16 v[80:95], v[140:143], v[60:63], v[80:95]
    s_waitcnt lgkmcnt(0)
    v_exp_f32 v72, v72
    v_exp_f32 v73, v73
    v_exp_f32 v74, v74
    v_exp_f32 v75, v75
    v_smfmac_f32_32x32x32_bf16 v[96:111], v[144:147], v[64:71], v156
    ds_read_b128 v[136:139], v157 offset:4096
    v_exp_f32 v76, v76
    v_exp_f32 v77, v77
    v_exp_f32 v78, v78
    v_exp_f32 v79, v79
    v_smfmac_f32_16x16x64_bf16 v[128:131], v[152:155], v[64:71], v156
    ds_read_b128 v[140:143], v157 offset:5120
    v_exp_f32 v80, v80
    v_smfmac_f32_32x32x32_bf16 v[96:111], v[148:151], v[72:79], v156
    v_exp_f32 v81, v81
    v_exp_f32 v82, v82
    v_exp_f32 v83, v83
    v_smfmac_f32_16x16x64_bf16 v[128:131], v[152:155], v[72:79], v156
    s_waitcnt lgkmcnt(0)
    v_exp_f32 v84, v84
    v_mfma_f32_32x32x16_bf16 v[64:79], v[136:139], v[48:51], 0
    v_exp_f32 v85, v85
    v_exp_f32 v86, v86
    v_exp_f32 v87, v87
    v_mfma_f32_32x32x16_bf16 v[64:79], v[140:143], v[52:55], v[64:79]
    v_exp_f32 v88, v88
    v_exp_f32 v89, v89
    v_exp_f32 v90, v90
    v_exp_f32 v91, v91
    v_smfmac_f32_32x32x32_bf16 v[112:127], v[144:147], v[80:87], v156
    ds_read_b128 v[144:147], v157 offset:6144
    v_exp_f32 v92, v92
    v_exp_f32 v93, v93
    v_exp_f32 v94, v94
    v_exp_f32 v95, v95
    v_smfmac_f32_16x16x64_bf16 v[132:135], v[152:155], v[80:87], v156
    s_and_b32 s53, s52, 15
    v_exp_f32 v64, v64
    v_smfmac_f32_32x32x32_bf16 v[112:127], v[148:151], v[88:95], v156
    ds_read_b128 v[148:151], v157 offset:7168
    v_exp_f32 v65, v65
    v_exp_f32 v66, v66
    v_exp_f32 v67, v67
    v_smfmac_f32_16x16x64_bf16 v[132:135], v[152:155], v[88:95], v156
    v_exp_f32 v68, v68
    v_mfma_f32_32x32x16_bf16 v[80:95], v[136:139], v[56:59], 0
    v_exp_f32 v69, v69
    v_exp_f32 v70, v70
    v_exp_f32 v71, v71
    v_mfma_f32_32x32x16_bf16 v[80:95], v[140:143], v[60:63], v[80:95]
    s_waitcnt lgkmcnt(0)
    v_exp_f32 v72, v72
    v_exp_f32 v73, v73
    v_exp_f32 v74, v74
    v_exp_f32 v75, v75
    v_smfmac_f32_32x32x32_bf16 v[96:111], v[144:147], v[64:71], v156
    ds_read_b128 v[136:139], v157 offset:8192
    v_exp_f32 v76, v76
    v_exp_f32 v77, v77
    v_exp_f32 v78, v78
    v_exp_f32 v79, v79
    v_smfmac_f32_16x16x64_bf16 v[128:131], v[152:155], v[64:71], v156
    ds_read_b128 v[140:143], v157 offset:9216
    v_exp_f32 v80, v80
    v_smfmac_f32_32x32x32_bf16 v[96:111], v[148:151], v[72:79], v156
    v_exp_f32 v81, v81
    v_exp_f32 v82, v82
    v_exp_f32 v83, v83
    v_smfmac_f32_16x16x64_bf16 v[128:131], v[152:155], v[72:79], v156
    s_waitcnt lgkmcnt(0)
    v_exp_f32 v84, v84
    v_mfma_f32_32x32x16_bf16 v[64:79], v[136:139], v[48:51], 0
    v_exp_f32 v85, v85
    v_exp_f32 v86, v86
    v_exp_f32 v87, v87
    v_mfma_f32_32x32x16_bf16 v[64:79], v[140:143], v[52:55], v[64:79]
    v_exp_f32 v88, v88
    v_exp_f32 v89, v89
    v_exp_f32 v90, v90
    v_exp_f32 v91, v91
    v_smfmac_f32_32x32x32_bf16 v[112:127], v[144:147], v[80:87], v156
    ds_read_b128 v[144:147], v157 offset:10240
    v_exp_f32 v92, v92
    v_exp_f32 v93, v93
    v_exp_f32 v94, v94
    v_exp_f32 v95, v95
    v_smfmac_f32_16x16x64_bf16 v[132:135], v[152:155], v[80:87], v156
    s_lshl_b32 s53, s53, 15
    v_exp_f32 v64, v64
    v_smfmac_f32_32x32x32_bf16 v[112:127], v[148:151], v[88:95], v156
    ds_read_b128 v[148:151], v157 offset:11264
    v_exp_f32 v65, v65
    v_exp_f32 v66, v66
    v_exp_f32 v67, v67
    v_smfmac_f32_16x16x64_bf16 v[132:135], v[152:155], v[88:95], v156
    v_exp_f32 v68, v68
    v_mfma_f32_32x32x16_bf16 v[80:95], v[136:139], v[56:59], 0
    v_exp_f32 v69, v69
    v_exp_f32 v70, v70
    v_exp_f32 v71, v71
    v_mfma_f32_32x32x16_bf16 v[80:95], v[140:143], v[60:63], v[80:95]
    s_waitcnt lgkmcnt(0)
    v_exp_f32 v72, v72
    v_exp_f32 v73, v73
    v_exp_f32 v74, v74
    v_exp_f32 v75, v75
    v_smfmac_f32_32x32x32_bf16 v[96:111], v[144:147], v[64:71], v156
    ds_read_b128 v[136:139], v157 offset:12288
    v_exp_f32 v76, v76
    v_exp_f32 v77, v77
    v_exp_f32 v78, v78
    v_exp_f32 v79, v79
    v_smfmac_f32_16x16x64_bf16 v[128:131], v[152:155], v[64:71], v156
    ds_read_b128 v[140:143], v157 offset:13312
    v_exp_f32 v80, v80
    v_smfmac_f32_32x32x32_bf16 v[96:111], v[148:151], v[72:79], v156
    v_exp_f32 v81, v81
    v_exp_f32 v82, v82
    v_exp_f32 v83, v83
    v_smfmac_f32_16x16x64_bf16 v[128:131], v[152:155], v[72:79], v156
    s_waitcnt lgkmcnt(0)
    v_exp_f32 v84, v84
    v_mfma_f32_32x32x16_bf16 v[64:79], v[136:139], v[48:51], 0
    v_exp_f32 v85, v85
    v_exp_f32 v86, v86
    v_exp_f32 v87, v87
    v_mfma_f32_32x32x16_bf16 v[64:79], v[140:143], v[52:55], v[64:79]
    v_exp_f32 v88, v88
    v_exp_f32 v89, v89
    v_exp_f32 v90, v90
    v_exp_f32 v91, v91
    v_smfmac_f32_32x32x32_bf16 v[112:127], v[144:147], v[80:87], v156
    ds_read_b128 v[144:147], v157 offset:14336
    v_exp_f32 v92, v92
    v_exp_f32 v93, v93
    v_exp_f32 v94, v94
    v_exp_f32 v95, v95
    v_smfmac_f32_16x16x64_bf16 v[132:135], v[152:155], v[80:87], v156
    s_lshr_b32 s52, s52, 4
    v_exp_f32 v64, v64
    v_smfmac_f32_32x32x32_bf16 v[112:127], v[148:151], v[88:95], v156
    ds_read_b128 v[148:151], v157 offset:15360
    v_exp_f32 v65, v65
    v_exp_f32 v66, v66
    v_exp_f32 v67, v67
    v_smfmac_f32_16x16x64_bf16 v[132:135], v[152:155], v[88:95], v156
    v_exp_f32 v68, v68
    v_mfma_f32_32x32x16_bf16 v[80:95], v[136:139], v[56:59], 0
    v_exp_f32 v69, v69
    v_exp_f32 v70, v70
    v_exp_f32 v71, v71
    v_mfma_f32_32x32x16_bf16 v[80:95], v[140:143], v[60:63], v[80:95]
    s_waitcnt lgkmcnt(0)
    v_exp_f32 v72, v72
    v_exp_f32 v73, v73
    v_exp_f32 v74, v74
    v_exp_f32 v75, v75
    v_smfmac_f32_32x32x32_bf16 v[96:111], v[144:147], v[64:71], v156
    ds_read_b128 v[136:139], v157 offset:16384
    v_exp_f32 v76, v76
    v_exp_f32 v77, v77
    v_exp_f32 v78, v78
    v_exp_f32 v79, v79
    v_smfmac_f32_16x16x64_bf16 v[128:131], v[152:155], v[64:71], v156
    ds_read_b128 v[140:143], v157 offset:17408
    v_exp_f32 v80, v80
    v_smfmac_f32_32x32x32_bf16 v[96:111], v[148:151], v[72:79], v156
    v_exp_f32 v81, v81
    v_exp_f32 v82, v82
    v_exp_f32 v83, v83
    v_smfmac_f32_16x16x64_bf16 v[128:131], v[152:155], v[72:79], v156
    s_waitcnt lgkmcnt(0)
    v_exp_f32 v84, v84
    v_mfma_f32_32x32x16_bf16 v[64:79], v[136:139], v[48:51], 0
    v_exp_f32 v85, v85
    v_exp_f32 v86, v86
    v_exp_f32 v87, v87
    v_mfma_f32_32x32x16_bf16 v[64:79], v[140:143], v[52:55], v[64:79]
    v_exp_f32 v88, v88
    v_exp_f32 v89, v89
    v_exp_f32 v90, v90
    v_exp_f32 v91, v91
    v_smfmac_f32_32x32x32_bf16 v[112:127], v[144:147], v[80:87], v156
    ds_read_b128 v[144:147], v157 offset:18432
    v_exp_f32 v92, v92
    v_exp_f32 v93, v93
    v_exp_f32 v94, v94
    v_exp_f32 v95, v95
    v_smfmac_f32_16x16x64_bf16 v[132:135], v[152:155], v[80:87], v156
    s_sub_u32 s63, s63, 1
    v_exp_f32 v64, v64
    v_smfmac_f32_32x32x32_bf16 v[112:127], v[148:151], v[88:95], v156
    ds_read_b128 v[148:151], v157 offset:19456
    v_exp_f32 v65, v65
    v_exp_f32 v66, v66
    v_exp_f32 v67, v67
    v_smfmac_f32_16x16x64_bf16 v[132:135], v[152:155], v[88:95], v156
    v_exp_f32 v68, v68
    v_mfma_f32_32x32x16_bf16 v[80:95], v[136:139], v[56:59], 0
    v_exp_f32 v69, v69
    v_exp_f32 v70, v70
    v_exp_f32 v71, v71
    v_mfma_f32_32x32x16_bf16 v[80:95], v[140:143], v[60:63], v[80:95]
    s_waitcnt lgkmcnt(0)
    v_exp_f32 v72, v72
    v_exp_f32 v73, v73
    v_exp_f32 v74, v74
    v_exp_f32 v75, v75
    v_smfmac_f32_32x32x32_bf16 v[96:111], v[144:147], v[64:71], v156
    ds_read_b128 v[136:139], v157 offset:20480
    v_exp_f32 v76, v76
    v_exp_f32 v77, v77
    v_exp_f32 v78, v78
    v_exp_f32 v79, v79
    v_smfmac_f32_16x16x64_bf16 v[128:131], v[152:155], v[64:71], v156
    ds_read_b128 v[140:143], v157 offset:21504
    v_exp_f32 v80, v80
    v_smfmac_f32_32x32x32_bf16 v[96:111], v[148:151], v[72:79], v156
    v_exp_f32 v81, v81
    v_exp_f32 v82, v82
    v_exp_f32 v83, v83
    v_smfmac_f32_16x16x64_bf16 v[128:131], v[152:155], v[72:79], v156
    s_waitcnt lgkmcnt(0)
    v_exp_f32 v84, v84
    v_mfma_f32_32x32x16_bf16 v[64:79], v[136:139], v[48:51], 0
    v_exp_f32 v85, v85
    v_exp_f32 v86, v86
    v_exp_f32 v87, v87
    v_mfma_f32_32x32x16_bf16 v[64:79], v[140:143], v[52:55], v[64:79]
    v_exp_f32 v88, v88
    v_exp_f32 v89, v89
    v_exp_f32 v90, v90
    v_exp_f32 v91, v91
    v_smfmac_f32_32x32x32_bf16 v[112:127], v[144:147], v[80:87], v156
    ds_read_b128 v[144:147], v157 offset:22528
    v_exp_f32 v92, v92
    v_exp_f32 v93, v93
    v_exp_f32 v94, v94
    v_exp_f32 v95, v95
    v_smfmac_f32_16x16x64_bf16 v[132:135], v[152:155], v[80:87], v156
    s_cmp_lg_u32 s63, 0
    v_exp_f32 v64, v64
    v_smfmac_f32_32x32x32_bf16 v[112:127], v[148:151], v[88:95], v156
    ds_read_b128 v[148:151], v157 offset:23552
    v_exp_f32 v65, v65
    v_exp_f32 v66, v66
    v_exp_f32 v67, v67
    v_smfmac_f32_16x16x64_bf16 v[132:135], v[152:155], v[88:95], v156
    v_exp_f32 v68, v68
    v_mfma_f32_32x32x16_bf16 v[80:95], v[136:139], v[56:59], 0
    v_exp_f32 v69, v69
    v_exp_f32 v70, v70
    v_exp_f32 v71, v71
    v_mfma_f32_32x32x16_bf16 v[80:95], v[140:143], v[60:63], v[80:95]
    s_waitcnt lgkmcnt(0)
    v_exp_f32 v72, v72
    v_exp_f32 v73, v73
    v_exp_f32 v74, v74
    v_exp_f32 v75, v75
    v_smfmac_f32_32x32x32_bf16 v[96:111], v[144:147], v[64:71], v156
    ds_read_b128 v[136:139], v157 offset:24576
    v_exp_f32 v76, v76
    v_exp_f32 v77, v77
    v_exp_f32 v78, v78
    v_exp_f32 v79, v79
    v_smfmac_f32_16x16x64_bf16 v[128:131], v[152:155], v[64:71], v156
    ds_read_b128 v[140:143], v157 offset:25600
    v_exp_f32 v80, v80
    v_smfmac_f32_32x32x32_bf16 v[96:111], v[148:151], v[72:79], v156
    v_exp_f32 v81, v81
    v_exp_f32 v82, v82
    v_exp_f32 v83, v83
    v_smfmac_f32_16x16x64_bf16 v[128:131], v[152:155], v[72:79], v156
    s_waitcnt lgkmcnt(0)
    v_exp_f32 v84, v84
    v_mfma_f32_32x32x16_bf16 v[64:79], v[136:139], v[48:51], 0
    v_exp_f32 v85, v85
    v_exp_f32 v86, v86
    v_exp_f32 v87, v87
    v_mfma_f32_32x32x16_bf16 v[64:79], v[140:143], v[52:55], v[64:79]
    v_exp_f32 v88, v88
    v_exp_f32 v89, v89
    v_exp_f32 v90, v90
    v_exp_f32 v91, v91
    v_smfmac_f32_32x32x32_bf16 v[112:127], v[144:147], v[80:87], v156
    ds_read_b128 v[144:147], v157 offset:26624
    v_exp_f32 v92, v92
    v_exp_f32 v93, v93
    v_exp_f32 v94, v94
    v_exp_f32 v95, v95
    v_smfmac_f32_16x16x64_bf16 v[132:135], v[152:155], v[80:87], v156
    s_nop 0
    v_exp_f32 v64, v64
    v_smfmac_f32_32x32x32_bf16 v[112:127], v[148:151], v[88:95], v156
    ds_read_b128 v[148:151], v157 offset:27648
    v_exp_f32 v65, v65
    v_exp_f32 v66, v66
    v_exp_f32 v67, v67
    v_smfmac_f32_16x16x64_bf16 v[132:135], v[152:155], v[88:95], v156
    v_exp_f32 v68, v68
    v_mfma_f32_32x32x16_bf16 v[80:95], v[136:139], v[56:59], 0
    v_exp_f32 v69, v69
    v_exp_f32 v70, v70
    v_exp_f32 v71, v71
    v_mfma_f32_32x32x16_bf16 v[80:95], v[140:143], v[60:63], v[80:95]
    s_waitcnt lgkmcnt(0)
    v_exp_f32 v72, v72
    v_exp_f32 v73, v73
    v_exp_f32 v74, v74
    v_exp_f32 v75, v75
    v_smfmac_f32_32x32x32_bf16 v[96:111], v[144:147], v[64:71], v156
    ds_read_b128 v[136:139], v157 offset:28672
    v_exp_f32 v76, v76
    v_exp_f32 v77, v77
    v_exp_f32 v78, v78
    v_exp_f32 v79, v79
    v_smfmac_f32_16x16x64_bf16 v[128:131], v[152:155], v[64:71], v156
    ds_read_b128 v[140:143], v157 offset:29696
    v_exp_f32 v80, v80
    v_smfmac_f32_32x32x32_bf16 v[96:111], v[148:151], v[72:79], v156
    v_exp_f32 v81, v81
    v_exp_f32 v82, v82
    v_exp_f32 v83, v83
    v_smfmac_f32_16x16x64_bf16 v[128:131], v[152:155], v[72:79], v156
    s_waitcnt lgkmcnt(0)
    v_exp_f32 v84, v84
    v_mfma_f32_32x32x16_bf16 v[64:79], v[136:139], v[48:51], 0
    v_exp_f32 v85, v85
    v_exp_f32 v86, v86
    v_exp_f32 v87, v87
    v_mfma_f32_32x32x16_bf16 v[64:79], v[140:143], v[52:55], v[64:79]
    v_exp_f32 v88, v88
    v_exp_f32 v89, v89
    v_exp_f32 v90, v90
    v_exp_f32 v91, v91
    v_smfmac_f32_32x32x32_bf16 v[112:127], v[144:147], v[80:87], v156
    ds_read_b128 v[144:147], v157 offset:30720
    v_exp_f32 v92, v92
    v_exp_f32 v93, v93
    v_exp_f32 v94, v94
    v_exp_f32 v95, v95
    v_smfmac_f32_16x16x64_bf16 v[132:135], v[152:155], v[80:87], v156
    s_nop 0
    v_exp_f32 v64, v64
    v_smfmac_f32_32x32x32_bf16 v[112:127], v[148:151], v[88:95], v156
    ds_read_b128 v[148:151], v157 offset:31744
    v_exp_f32 v65, v65
    v_exp_f32 v66, v66
    v_exp_f32 v67, v67
    v_smfmac_f32_16x16x64_bf16 v[132:135], v[152:155], v[88:95], v156
    s_barrier
    v_exp_f32 v68, v68
    v_mfma_f32_32x32x16_bf16 v[80:95], v[136:139], v[56:59], 0
    v_exp_f32 v69, v69
    v_exp_f32 v70, v70
    v_exp_f32 v71, v71
    v_mfma_f32_32x32x16_bf16 v[80:95], v[140:143], v[60:63], v[80:95]
    s_waitcnt lgkmcnt(0)
    v_add_u32 v157, s53, v3
    v_exp_f32 v72, v72
    v_exp_f32 v73, v73
    v_exp_f32 v74, v74
    v_exp_f32 v75, v75
    v_smfmac_f32_32x32x32_bf16 v[96:111], v[144:147], v[64:71], v156
    ds_read_b128 v[136:139], v157 offset:0
    v_exp_f32 v76, v76
    v_exp_f32 v77, v77
    v_exp_f32 v78, v78
    v_exp_f32 v79, v79
    v_smfmac_f32_16x16x64_bf16 v[128:131], v[152:155], v[64:71], v156
    ds_read_b128 v[140:143], v157 offset:1024
    v_exp_f32 v80, v80
    v_smfmac_f32_32x32x32_bf16 v[96:111], v[148:151], v[72:79], v156
    v_exp_f32 v81, v81
    v_exp_f32 v82, v82
    v_exp_f32 v83, v83
    v_smfmac_f32_16x16x64_bf16 v[128:131], v[152:155], v[72:79], v156
    s_waitcnt lgkmcnt(0)
    v_exp_f32 v84, v84
    v_mfma_f32_32x32x16_bf16 v[64:79], v[136:139], v[48:51], 0
    v_exp_f32 v85, v85
    v_exp_f32 v86, v86
    v_exp_f32 v87, v87
    v_mfma_f32_32x32x16_bf16 v[64:79], v[140:143], v[52:55], v[64:79]
    v_exp_f32 v88, v88
    v_exp_f32 v89, v89
    v_exp_f32 v90, v90
    v_exp_f32 v91, v91
    v_smfmac_f32_32x32x32_bf16 v[112:127], v[144:147], v[80:87], v156
    ds_read_b128 v[144:147], v157 offset:2048
    v_exp_f32 v92, v92
    v_exp_f32 v93, v93
    v_exp_f32 v94, v94
    v_exp_f32 v95, v95
    v_smfmac_f32_16x16x64_bf16 v[132:135], v[152:155], v[80:87], v156
    s_cbranch_scc1 adaLN_cond__grouped_kv_mqa__mixer_gmlp__prompt_kernel_aloop
    s_nop 1
    v_smfmac_f32_32x32x32_bf16 v[112:127], v[148:151], v[88:95], v156
    v_smfmac_f32_16x16x64_bf16 v[132:135], v[152:155], v[88:95], v156
    s_waitcnt lgkmcnt(0)
adaLN_cond__grouped_kv_mqa__mixer_gmlp__prompt_kernel_norm:
    v_rcp_f32 v8, v128
    s_lshl_b32 s50, s44, 16
    s_lshl_b32 s51, s41, 12
    s_add_u32 s50, s50, s51
    s_add_u32 s50, s50, 6291456
    v_pk_mul_f32 v[96:97], v[96:97], v[8:9] op_sel_hi:[1,0]
    v_pk_mul_f32 v[98:99], v[98:99], v[8:9] op_sel_hi:[1,0]
    v_pk_mul_f32 v[100:101], v[100:101], v[8:9] op_sel_hi:[1,0]
    v_pk_mul_f32 v[102:103], v[102:103], v[8:9] op_sel_hi:[1,0]
    v_cvt_pk_bf16_f32 v64, v96, v97
    v_cvt_pk_bf16_f32 v65, v98, v99
    v_cvt_pk_bf16_f32 v66, v100, v101
    v_cvt_pk_bf16_f32 v67, v102, v103
    buffer_store_dwordx4 v[64:67], v3, s[4:7], s50 offen offset:0 sc1
    v_pk_mul_f32 v[104:105], v[104:105], v[8:9] op_sel_hi:[1,0]
    v_pk_mul_f32 v[106:107], v[106:107], v[8:9] op_sel_hi:[1,0]
    v_pk_mul_f32 v[108:109], v[108:109], v[8:9] op_sel_hi:[1,0]
    v_pk_mul_f32 v[110:111], v[110:111], v[8:9] op_sel_hi:[1,0]
    v_cvt_pk_bf16_f32 v68, v104, v105
    v_cvt_pk_bf16_f32 v69, v106, v107
    v_cvt_pk_bf16_f32 v70, v108, v109
    v_cvt_pk_bf16_f32 v71, v110, v111
    buffer_store_dwordx4 v[68:71], v3, s[4:7], s50 offen offset:1024 sc1
    v_rcp_f32 v10, v132
    s_nop 0
    v_pk_mul_f32 v[112:113], v[112:113], v[10:11] op_sel_hi:[1,0]
    v_pk_mul_f32 v[114:115], v[114:115], v[10:11] op_sel_hi:[1,0]
    v_pk_mul_f32 v[116:117], v[116:117], v[10:11] op_sel_hi:[1,0]
    v_pk_mul_f32 v[118:119], v[118:119], v[10:11] op_sel_hi:[1,0]
    v_cvt_pk_bf16_f32 v80, v112, v113
    v_cvt_pk_bf16_f32 v81, v114, v115
    v_cvt_pk_bf16_f32 v82, v116, v117
    v_cvt_pk_bf16_f32 v83, v118, v119
    buffer_store_dwordx4 v[80:83], v3, s[4:7], s50 offen offset:2048 sc1
    v_pk_mul_f32 v[120:121], v[120:121], v[10:11] op_sel_hi:[1,0]
    v_pk_mul_f32 v[122:123], v[122:123], v[10:11] op_sel_hi:[1,0]
    v_pk_mul_f32 v[124:125], v[124:125], v[10:11] op_sel_hi:[1,0]
    v_pk_mul_f32 v[126:127], v[126:127], v[10:11] op_sel_hi:[1,0]
    v_cvt_pk_bf16_f32 v84, v120, v121
    v_cvt_pk_bf16_f32 v85, v122, v123
    v_cvt_pk_bf16_f32 v86, v124, v125
    v_cvt_pk_bf16_f32 v87, v126, v127
    buffer_store_dwordx4 v[84:87], v3, s[4:7], s50 offen offset:3072 sc1
    v_mov_b32 v14, 0x35800000
    v_mov_b32 v15, 0x6c800000
    v_pk_mul_f32 v[12:13], v[96:97], 0 op_sel_hi:[1,0]
    v_pk_fma_f32 v[12:13], v[98:99], 0, v[12:13] op_sel_hi:[1,0,1]
    v_pk_fma_f32 v[12:13], v[100:101], 0, v[12:13] op_sel_hi:[1,0,1]
    v_pk_fma_f32 v[12:13], v[102:103], 0, v[12:13] op_sel_hi:[1,0,1]
    v_pk_fma_f32 v[12:13], v[104:105], 0, v[12:13] op_sel_hi:[1,0,1]
    v_pk_fma_f32 v[12:13], v[106:107], 0, v[12:13] op_sel_hi:[1,0,1]
    v_pk_fma_f32 v[12:13], v[108:109], 0, v[12:13] op_sel_hi:[1,0,1]
    v_pk_fma_f32 v[12:13], v[110:111], 0, v[12:13] op_sel_hi:[1,0,1]
    v_cmp_nge_f32 s[54:55], v128, v14
    v_cmp_nle_f32 s[56:57], v128, v15
    s_or_b64 s[54:55], s[54:55], s[56:57]
    s_nop 1
    v_pk_fma_f32 v[12:13], v[112:113], 0, v[12:13] op_sel_hi:[1,0,1]
    v_pk_fma_f32 v[12:13], v[114:115], 0, v[12:13] op_sel_hi:[1,0,1]
    v_pk_fma_f32 v[12:13], v[116:117], 0, v[12:13] op_sel_hi:[1,0,1]
    v_pk_fma_f32 v[12:13], v[118:119], 0, v[12:13] op_sel_hi:[1,0,1]
    v_pk_fma_f32 v[12:13], v[120:121], 0, v[12:13] op_sel_hi:[1,0,1]
    v_pk_fma_f32 v[12:13], v[122:123], 0, v[12:13] op_sel_hi:[1,0,1]
    v_pk_fma_f32 v[12:13], v[124:125], 0, v[12:13] op_sel_hi:[1,0,1]
    v_pk_fma_f32 v[12:13], v[126:127], 0, v[12:13] op_sel_hi:[1,0,1]
    v_cmp_nge_f32 s[56:57], v132, v14
    s_or_b64 s[54:55], s[54:55], s[56:57]
    v_cmp_nle_f32 s[56:57], v132, v15
    s_or_b64 s[54:55], s[54:55], s[56:57]
    v_cmp_u_f32 s[56:57], v12, v13
    s_or_b64 s[54:55], s[54:55], s[56:57]
    s_cselect_b32 s54, 1, 0
    s_andn2_b32 s54, s54, s58
    s_cbranch_scc1 adaLN_cond__grouped_kv_mqa__mixer_gmlp__prompt_kernel_slow
    v_pk_mul_f32 v[16:17], 0, 0
    v_pk_mul_f32 v[18:19], 0, 0
    v_pk_mul_f32 v[20:21], 0, 0
    v_pk_mul_f32 v[22:23], 0, 0
    v_pk_mul_f32 v[24:25], 0, 0
    v_pk_mul_f32 v[26:27], 0, 0
    v_pk_mul_f32 v[28:29], 0, 0
    v_pk_mul_f32 v[30:31], 0, 0
    v_pk_mul_f32 v[32:33], 0, 0
    v_pk_mul_f32 v[34:35], 0, 0
    v_pk_mul_f32 v[36:37], 0, 0
    v_pk_mul_f32 v[38:39], 0, 0
    v_pk_mul_f32 v[40:41], 0, 0
    v_pk_mul_f32 v[42:43], 0, 0
    v_pk_mul_f32 v[44:45], 0, 0
    v_pk_mul_f32 v[46:47], 0, 0
    s_mul_i32 s45, s44, 65536
    s_add_u32 s45, s45, 6291456
    s_add_u32 s96, s92, s45
    s_addc_u32 s97, s93, 0
    s_mov_b32 s98, 65536
    s_mov_b32 s50, 0
    s_mov_b32 s51, 0
    v_mov_b32 v240, v248
    v_mov_b32 v241, v249
    v_mov_b32 v242, v250
    v_mov_b32 v243, v251
    s_mov_b32 s63, 3
    s_mov_b32 s62, 1
    s_lshl_b32 s46, s44, 7
    s_add_u32 s46, s46, 1572864
    v_mov_b32 v2, 1
    s_mov_b64 exec, 1
    s_waitcnt vmcnt(0)
    buffer_atomic_add v2, off, s[4:7], s46 sc1
    s_mov_b64 exec, -1
    s_barrier
    s_barrier
    ds_read_b128 v[80:83], v7 offset:0
    ds_read_b128 v[84:87], v7 offset:16
    ds_read_b128 v[160:163], v7 offset:256
    ds_read_b128 v[164:167], v7 offset:272
    ds_read_b128 v[88:91], v7 offset:64
    ds_read_b128 v[92:95], v7 offset:80
    ds_read_b128 v[168:171], v7 offset:320
    ds_read_b128 v[172:175], v7 offset:336
    ds_read_b128 v[96:99], v7 offset:128
    ds_read_b128 v[100:103], v7 offset:144
    ds_read_b128 v[176:179], v7 offset:384
    ds_read_b128 v[180:183], v7 offset:400
    ds_read_b128 v[104:107], v7 offset:192
    ds_read_b128 v[108:111], v7 offset:208
    ds_read_b128 v[184:187], v7 offset:448
    ds_read_b128 v[188:191], v7 offset:464
    v_lshlrev_b32 v112, 16, v224
    v_and_b32 v113, 0xffff0000, v224
    v_lshlrev_b32 v114, 16, v225
    v_and_b32 v115, 0xffff0000, v225
    v_lshlrev_b32 v116, 16, v226
    v_and_b32 v117, 0xffff0000, v226
    v_lshlrev_b32 v118, 16, v227
    v_and_b32 v119, 0xffff0000, v227
    v_lshlrev_b32 v120, 16, v228
    v_and_b32 v121, 0xffff0000, v228
    v_lshlrev_b32 v122, 16, v229
    v_and_b32 v123, 0xffff0000, v229
    v_lshlrev_b32 v124, 16, v230
    v_and_b32 v125, 0xffff0000, v230
    v_lshlrev_b32 v126, 16, v231
    v_and_b32 v127, 0xffff0000, v231
    v_lshlrev_b32 v128, 16, v232
    v_and_b32 v129, 0xffff0000, v232
    v_lshlrev_b32 v130, 16, v233
    v_and_b32 v131, 0xffff0000, v233
    v_lshlrev_b32 v132, 16, v234
    v_and_b32 v133, 0xffff0000, v234
    v_lshlrev_b32 v134, 16, v235
    v_and_b32 v135, 0xffff0000, v235
    v_lshlrev_b32 v136, 16, v236
    v_and_b32 v137, 0xffff0000, v236
    v_lshlrev_b32 v138, 16, v237
    v_and_b32 v139, 0xffff0000, v237
    v_lshlrev_b32 v140, 16, v238
    v_and_b32 v141, 0xffff0000, v238
    v_lshlrev_b32 v142, 16, v239
    v_and_b32 v143, 0xffff0000, v239
    v_lshlrev_b32 v8, 16, v244
    v_and_b32 v9, 0xffff0000, v244
    v_lshlrev_b32 v10, 16, v245
    v_and_b32 v11, 0xffff0000, v245
    v_lshlrev_b32 v12, 16, v246
    v_and_b32 v13, 0xffff0000, v246
    v_lshlrev_b32 v14, 16, v247
    v_and_b32 v15, 0xffff0000, v247
    v_pk_add_f32 v[8:9], v[8:9], v[10:11]
    v_pk_add_f32 v[12:13], v[12:13], v[14:15]
    v_pk_add_f32 v[8:9], v[8:9], v[12:13]
    v_add_f32 v8, v8, v9
    v_mul_f32 v244, 0xbe000000, v8
    v_pk_add_f32 v[112:113], v[112:113], v[244:245] op_sel_hi:[1,0]
    v_pk_add_f32 v[114:115], v[114:115], v[244:245] op_sel_hi:[1,0]
    v_pk_add_f32 v[116:117], v[116:117], v[244:245] op_sel_hi:[1,0]
    v_pk_add_f32 v[118:119], v[118:119], v[244:245] op_sel_hi:[1,0]
    v_pk_add_f32 v[120:121], v[120:121], v[244:245] op_sel_hi:[1,0]
    v_pk_add_f32 v[122:123], v[122:123], v[244:245] op_sel_hi:[1,0]
    v_pk_add_f32 v[124:125], v[124:125], v[244:245] op_sel_hi:[1,0]
    v_pk_add_f32 v[126:127], v[126:127], v[244:245] op_sel_hi:[1,0]
    v_pk_add_f32 v[128:129], v[128:129], v[244:245] op_sel_hi:[1,0]
    v_pk_add_f32 v[130:131], v[130:131], v[244:245] op_sel_hi:[1,0]
    v_pk_add_f32 v[132:133], v[132:133], v[244:245] op_sel_hi:[1,0]
    v_pk_add_f32 v[134:135], v[134:135], v[244:245] op_sel_hi:[1,0]
    v_pk_add_f32 v[136:137], v[136:137], v[244:245] op_sel_hi:[1,0]
    v_pk_add_f32 v[138:139], v[138:139], v[244:245] op_sel_hi:[1,0]
    v_pk_add_f32 v[140:141], v[140:141], v[244:245] op_sel_hi:[1,0]
    v_pk_add_f32 v[142:143], v[142:143], v[244:245] op_sel_hi:[1,0]
    s_waitcnt lgkmcnt(0)
    ds_read_b64_tr_b16 v[48:49], v240 offset:0
    ds_read_b64_tr_b16 v[50:51], v240 offset:512
    ds_read_b64_tr_b16 v[52:53], v240 offset:4096
    ds_read_b64_tr_b16 v[54:55], v240 offset:4608
    ds_read_b64_tr_b16 v[56:57], v241 offset:0
    ds_read_b64_tr_b16 v[58:59], v241 offset:512
    ds_read_b64_tr_b16 v[60:61], v241 offset:4096
    ds_read_b64_tr_b16 v[62:63], v241 offset:4608
    ds_read_b64_tr_b16 v[64:65], v242 offset:0
    ds_read_b64_tr_b16 v[66:67], v242 offset:512
    ds_read_b64_tr_b16 v[68:69], v242 offset:4096
    ds_read_b64_tr_b16 v[70:71], v242 offset:4608
    v_mov_b32 v1, 0
    s_mov_b64 exec, 1
    buffer_atomic_add v1, off, s[4:7], s46 sc0 sc1
    s_mov_b64 exec, -1
    v_pk_mul_f32 v[80:81], v[80:81], v[160:161]
    v_pk_mul_f32 v[112:113], v[112:113], v[160:161]
    v_pk_mul_f32 v[82:83], v[82:83], v[162:163]
    v_pk_mul_f32 v[114:115], v[114:115], v[162:163]
    v_pk_mul_f32 v[84:85], v[84:85], v[164:165]
    v_pk_mul_f32 v[116:117], v[116:117], v[164:165]
    v_pk_mul_f32 v[86:87], v[86:87], v[166:167]
    v_pk_mul_f32 v[118:119], v[118:119], v[166:167]
    v_pk_mul_f32 v[88:89], v[88:89], v[168:169]
    v_pk_mul_f32 v[120:121], v[120:121], v[168:169]
    v_pk_mul_f32 v[90:91], v[90:91], v[170:171]
    v_pk_mul_f32 v[122:123], v[122:123], v[170:171]
    v_pk_mul_f32 v[92:93], v[92:93], v[172:173]
    v_pk_mul_f32 v[124:125], v[124:125], v[172:173]
    v_pk_mul_f32 v[94:95], v[94:95], v[174:175]
    v_pk_mul_f32 v[126:127], v[126:127], v[174:175]
    v_pk_mul_f32 v[96:97], v[96:97], v[176:177]
    v_pk_mul_f32 v[128:129], v[128:129], v[176:177]
    v_pk_mul_f32 v[98:99], v[98:99], v[178:179]
    v_pk_mul_f32 v[130:131], v[130:131], v[178:179]
    v_pk_mul_f32 v[100:101], v[100:101], v[180:181]
    v_pk_mul_f32 v[132:133], v[132:133], v[180:181]
    v_pk_mul_f32 v[102:103], v[102:103], v[182:183]
    v_pk_mul_f32 v[134:135], v[134:135], v[182:183]
    v_pk_mul_f32 v[104:105], v[104:105], v[184:185]
    v_pk_mul_f32 v[136:137], v[136:137], v[184:185]
    v_pk_mul_f32 v[106:107], v[106:107], v[186:187]
    v_pk_mul_f32 v[138:139], v[138:139], v[186:187]
    v_pk_mul_f32 v[108:109], v[108:109], v[188:189]
    v_pk_mul_f32 v[140:141], v[140:141], v[188:189]
    v_pk_mul_f32 v[110:111], v[110:111], v[190:191]
    v_pk_mul_f32 v[142:143], v[142:143], v[190:191]
    s_waitcnt vmcnt(0)
    v_readfirstlane_b32 s47, v1
    s_cmp_ge_u32 s47, 16
    s_cbranch_scc1 adaLN_cond__grouped_kv_mqa__mixer_gmlp__prompt_kernel_po_y
    s_mov_b32 s47, 262144
    s_mov_b64 exec, 1
adaLN_cond__grouped_kv_mqa__mixer_gmlp__prompt_kernel_po:
    v_mov_b32 v1, 0
    buffer_atomic_add v1, off, s[4:7], s46 sc0 sc1
    s_sub_u32 s47, s47, 1
    s_waitcnt vmcnt(0)
    v_cmp_gt_u32 vcc, 16, v1
    s_cmp_eq_u32 s47, 0
    s_cbranch_scc1 adaLN_cond__grouped_kv_mqa__mixer_gmlp__prompt_kernel_po_x
    s_cbranch_vccnz adaLN_cond__grouped_kv_mqa__mixer_gmlp__prompt_kernel_po
adaLN_cond__grouped_kv_mqa__mixer_gmlp__prompt_kernel_po_x:
    s_mov_b64 exec, -1
adaLN_cond__grouped_kv_mqa__mixer_gmlp__prompt_kernel_po_y:
    s_branch adaLN_cond__grouped_kv_mqa__mixer_gmlp__prompt_kernel_small
adaLN_cond__grouped_kv_mqa__mixer_gmlp__prompt_kernel_after_wo:
    s_lshl_b32 s52, s44, 16
    s_lshl_b32 s53, s41, 12
    s_add_u32 s52, s52, s53
    s_add_u32 s52, s52, 10485760
    v_permlane16_swap_b32 v16, v20
    v_permlane16_swap_b32 v17, v21
    v_permlane16_swap_b32 v18, v22
    v_permlane16_swap_b32 v19, v23
    v_pk_fma_f32 v[112:113], v[16:17], v[80:81], v[112:113]
    v_pk_fma_f32 v[114:115], v[18:19], v[82:83], v[114:115]
    v_pk_fma_f32 v[116:117], v[20:21], v[84:85], v[116:117]
    v_pk_fma_f32 v[118:119], v[22:23], v[86:87], v[118:119]
    v_cvt_pk_bf16_f32 v144, v112, v113
    v_cvt_pk_bf16_f32 v145, v114, v115
    v_cvt_pk_bf16_f32 v146, v116, v117
    v_cvt_pk_bf16_f32 v147, v118, v119
    buffer_store_dwordx4 v[144:147], v3, s[4:7], s52 offen offset:0 sc1
    v_permlane16_swap_b32 v24, v28
    v_permlane16_swap_b32 v25, v29
    v_permlane16_swap_b32 v26, v30
    v_permlane16_swap_b32 v27, v31
    v_pk_fma_f32 v[120:121], v[24:25], v[88:89], v[120:121]
    v_pk_fma_f32 v[122:123], v[26:27], v[90:91], v[122:123]
    v_pk_fma_f32 v[124:125], v[28:29], v[92:93], v[124:125]
    v_pk_fma_f32 v[126:127], v[30:31], v[94:95], v[126:127]
    v_cvt_pk_bf16_f32 v148, v120, v121
    v_cvt_pk_bf16_f32 v149, v122, v123
    v_cvt_pk_bf16_f32 v150, v124, v125
    v_cvt_pk_bf16_f32 v151, v126, v127
    buffer_store_dwordx4 v[148:151], v3, s[4:7], s52 offen offset:1024 sc1
    v_permlane16_swap_b32 v32, v36
    v_permlane16_swap_b32 v33, v37
    v_permlane16_swap_b32 v34, v38
    v_permlane16_swap_b32 v35, v39
    v_pk_fma_f32 v[128:129], v[32:33], v[96:97], v[128:129]
    v_pk_fma_f32 v[130:131], v[34:35], v[98:99], v[130:131]
    v_pk_fma_f32 v[132:133], v[36:37], v[100:101], v[132:133]
    v_pk_fma_f32 v[134:135], v[38:39], v[102:103], v[134:135]
    v_cvt_pk_bf16_f32 v152, v128, v129
    v_cvt_pk_bf16_f32 v153, v130, v131
    v_cvt_pk_bf16_f32 v154, v132, v133
    v_cvt_pk_bf16_f32 v155, v134, v135
    buffer_store_dwordx4 v[152:155], v3, s[4:7], s52 offen offset:2048 sc1
    v_permlane16_swap_b32 v40, v44
    v_permlane16_swap_b32 v41, v45
    v_permlane16_swap_b32 v42, v46
    v_permlane16_swap_b32 v43, v47
    v_pk_fma_f32 v[136:137], v[40:41], v[104:105], v[136:137]
    v_pk_fma_f32 v[138:139], v[42:43], v[106:107], v[138:139]
    v_pk_fma_f32 v[140:141], v[44:45], v[108:109], v[140:141]
    v_pk_fma_f32 v[142:143], v[46:47], v[110:111], v[142:143]
    v_cvt_pk_bf16_f32 v156, v136, v137
    v_cvt_pk_bf16_f32 v157, v138, v139
    v_cvt_pk_bf16_f32 v158, v140, v141
    v_cvt_pk_bf16_f32 v159, v142, v143
    buffer_store_dwordx4 v[156:159], v3, s[4:7], s52 offen offset:3072 sc1
    ds_read_b128 v[80:83], v7 offset:0
    ds_read_b128 v[84:87], v7 offset:16
    ds_read_b128 v[88:91], v7 offset:64
    ds_read_b128 v[92:95], v7 offset:80
    ds_read_b128 v[96:99], v7 offset:128
    ds_read_b128 v[100:103], v7 offset:144
    ds_read_b128 v[104:107], v7 offset:192
    ds_read_b128 v[108:111], v7 offset:208
    v_lshlrev_b32 v48, 16, v224
    v_and_b32 v49, 0xffff0000, v224
    v_lshlrev_b32 v50, 16, v225
    v_and_b32 v51, 0xffff0000, v225
    v_lshlrev_b32 v52, 16, v226
    v_and_b32 v53, 0xffff0000, v226
    v_lshlrev_b32 v54, 16, v227
    v_and_b32 v55, 0xffff0000, v227
    v_lshlrev_b32 v56, 16, v228
    v_and_b32 v57, 0xffff0000, v228
    v_lshlrev_b32 v58, 16, v229
    v_and_b32 v59, 0xffff0000, v229
    v_lshlrev_b32 v60, 16, v230
    v_and_b32 v61, 0xffff0000, v230
    v_lshlrev_b32 v62, 16, v231
    v_and_b32 v63, 0xffff0000, v231
    v_lshlrev_b32 v64, 16, v232
    v_and_b32 v65, 0xffff0000, v232
    v_lshlrev_b32 v66, 16, v233
    v_and_b32 v67, 0xffff0000, v233
    v_lshlrev_b32 v68, 16, v234
    v_and_b32 v69, 0xffff0000, v234
    v_lshlrev_b32 v70, 16, v235
    v_and_b32 v71, 0xffff0000, v235
    v_lshlrev_b32 v72, 16, v236
    v_and_b32 v73, 0xffff0000, v236
    v_lshlrev_b32 v74, 16, v237
    v_and_b32 v75, 0xffff0000, v237
    v_lshlrev_b32 v76, 16, v238
    v_and_b32 v77, 0xffff0000, v238
    v_lshlrev_b32 v78, 16, v239
    v_and_b32 v79, 0xffff0000, v239
    s_waitcnt lgkmcnt(0)
    v_pk_fma_f32 v[16:17], v[16:17], v[80:81], v[48:49]
    v_pk_fma_f32 v[18:19], v[18:19], v[82:83], v[50:51]
    v_pk_fma_f32 v[20:21], v[20:21], v[84:85], v[52:53]
    v_pk_fma_f32 v[22:23], v[22:23], v[86:87], v[54:55]
    v_pk_fma_f32 v[24:25], v[24:25], v[88:89], v[56:57]
    v_pk_fma_f32 v[26:27], v[26:27], v[90:91], v[58:59]
    v_pk_fma_f32 v[28:29], v[28:29], v[92:93], v[60:61]
    v_pk_fma_f32 v[30:31], v[30:31], v[94:95], v[62:63]
    v_pk_fma_f32 v[32:33], v[32:33], v[96:97], v[64:65]
    v_pk_fma_f32 v[34:35], v[34:35], v[98:99], v[66:67]
    v_pk_fma_f32 v[36:37], v[36:37], v[100:101], v[68:69]
    v_pk_fma_f32 v[38:39], v[38:39], v[102:103], v[70:71]
    v_pk_fma_f32 v[40:41], v[40:41], v[104:105], v[72:73]
    v_pk_fma_f32 v[42:43], v[42:43], v[106:107], v[74:75]
    v_pk_fma_f32 v[44:45], v[44:45], v[108:109], v[76:77]
    v_pk_fma_f32 v[46:47], v[46:47], v[110:111], v[78:79]
    s_lshl_b32 s53, s43, 12
    s_add_u32 s53, s53, 147456
    v_add_u32 v12, s53, v3
    v_add_u32 v13, s53, v4
    ds_write_b128 v12, v[144:147] offset:0
    ds_write_b128 v12, v[148:151] offset:1024
    ds_write_b128 v12, v[152:155] offset:2048
    ds_write_b128 v12, v[156:159] offset:3072
    v_cvt_pk_bf16_f32 v224, v16, v17
    v_cvt_pk_bf16_f32 v225, v18, v19
    v_cvt_pk_bf16_f32 v226, v20, v21
    v_cvt_pk_bf16_f32 v227, v22, v23
    v_cvt_pk_bf16_f32 v228, v24, v25
    v_cvt_pk_bf16_f32 v229, v26, v27
    v_cvt_pk_bf16_f32 v230, v28, v29
    v_cvt_pk_bf16_f32 v231, v30, v31
    v_cvt_pk_bf16_f32 v232, v32, v33
    v_cvt_pk_bf16_f32 v233, v34, v35
    v_cvt_pk_bf16_f32 v234, v36, v37
    v_cvt_pk_bf16_f32 v235, v38, v39
    v_cvt_pk_bf16_f32 v236, v40, v41
    v_cvt_pk_bf16_f32 v237, v42, v43
    v_cvt_pk_bf16_f32 v238, v44, v45
    v_cvt_pk_bf16_f32 v239, v46, v47
    s_waitcnt lgkmcnt(0)
    ds_read_b128 v[160:163], v13 offset:0
    ds_read_b128 v[164:167], v13 offset:2048
    ds_read_b128 v[168:171], v13 offset:256
    ds_read_b128 v[172:175], v13 offset:2304
    v_pk_add_f32 v[16:17], v[16:17], v[244:245] op_sel_hi:[1,0]
    v_pk_add_f32 v[18:19], v[18:19], v[244:245] op_sel_hi:[1,0]
    v_pk_add_f32 v[20:21], v[20:21], v[244:245] op_sel_hi:[1,0]
    v_pk_add_f32 v[22:23], v[22:23], v[244:245] op_sel_hi:[1,0]
    v_pk_add_f32 v[24:25], v[24:25], v[244:245] op_sel_hi:[1,0]
    v_pk_add_f32 v[26:27], v[26:27], v[244:245] op_sel_hi:[1,0]
    v_pk_add_f32 v[28:29], v[28:29], v[244:245] op_sel_hi:[1,0]
    v_pk_add_f32 v[30:31], v[30:31], v[244:245] op_sel_hi:[1,0]
    v_pk_add_f32 v[32:33], v[32:33], v[244:245] op_sel_hi:[1,0]
    v_pk_add_f32 v[34:35], v[34:35], v[244:245] op_sel_hi:[1,0]
    v_pk_add_f32 v[36:37], v[36:37], v[244:245] op_sel_hi:[1,0]
    v_pk_add_f32 v[38:39], v[38:39], v[244:245] op_sel_hi:[1,0]
    v_pk_add_f32 v[40:41], v[40:41], v[244:245] op_sel_hi:[1,0]
    v_pk_add_f32 v[42:43], v[42:43], v[244:245] op_sel_hi:[1,0]
    v_pk_add_f32 v[44:45], v[44:45], v[244:245] op_sel_hi:[1,0]
    v_pk_add_f32 v[46:47], v[46:47], v[244:245] op_sel_hi:[1,0]
    v_pk_add_f32 v[8:9], v[16:17], v[18:19]
    v_pk_mul_f32 v[10:11], v[16:17], v[16:17]
    v_pk_fma_f32 v[10:11], v[18:19], v[18:19], v[10:11]
    v_pk_add_f32 v[8:9], v[8:9], v[20:21]
    v_pk_fma_f32 v[10:11], v[20:21], v[20:21], v[10:11]
    v_pk_add_f32 v[8:9], v[8:9], v[22:23]
    v_pk_fma_f32 v[10:11], v[22:23], v[22:23], v[10:11]
    v_pk_add_f32 v[8:9], v[8:9], v[24:25]
    v_pk_fma_f32 v[10:11], v[24:25], v[24:25], v[10:11]
    v_pk_add_f32 v[8:9], v[8:9], v[26:27]
    v_pk_fma_f32 v[10:11], v[26:27], v[26:27], v[10:11]
    v_pk_add_f32 v[8:9], v[8:9], v[28:29]
    v_pk_fma_f32 v[10:11], v[28:29], v[28:29], v[10:11]
    v_pk_add_f32 v[8:9], v[8:9], v[30:31]
    v_pk_fma_f32 v[10:11], v[30:31], v[30:31], v[10:11]
    v_pk_add_f32 v[8:9], v[8:9], v[32:33]
    v_pk_fma_f32 v[10:11], v[32:33], v[32:33], v[10:11]
    v_pk_add_f32 v[8:9], v[8:9], v[34:35]
    v_pk_fma_f32 v[10:11], v[34:35], v[34:35], v[10:11]
    v_pk_add_f32 v[8:9], v[8:9], v[36:37]
    v_pk_fma_f32 v[10:11], v[36:37], v[36:37], v[10:11]
    v_pk_add_f32 v[8:9], v[8:9], v[38:39]
    v_pk_fma_f32 v[10:11], v[38:39], v[38:39], v[10:11]
    v_pk_add_f32 v[8:9], v[8:9], v[40:41]
    v_pk_fma_f32 v[10:11], v[40:41], v[40:41], v[10:11]
    v_pk_add_f32 v[8:9], v[8:9], v[42:43]
    v_pk_fma_f32 v[10:11], v[42:43], v[42:43], v[10:11]
    v_pk_add_f32 v[8:9], v[8:9], v[44:45]
    v_pk_fma_f32 v[10:11], v[44:45], v[44:45], v[10:11]
    v_pk_add_f32 v[8:9], v[8:9], v[46:47]
    v_pk_fma_f32 v[10:11], v[46:47], v[46:47], v[10:11]
    v_add_f32 v8, v8, v9
    v_add_f32 v9, v10, v11
    v_mov_b32 v10, v8
    s_nop 1
    v_permlane32_swap_b32 v8, v10
    v_add_f32 v8, v8, v10
    v_mov_b32 v10, v9
    s_nop 1
    v_permlane32_swap_b32 v9, v10
    v_add_f32 v9, v9, v10
    v_and_b32 v10, 31, v0
    v_lshlrev_b32 v10, 3, v10
    s_lshl_b32 s52, s44, 12
    s_lshl_b32 s53, s41, 8
    s_add_u32 s52, s52, s53
    s_add_u32 s52, s52, 1048576
    s_add_u32 s53, s41, 1
    s_and_b32 s53, s53, 15
    s_lshl_b32 s53, s53, 12
    s_mul_i32 s45, s44, 65536
    s_add_u32 s45, s45, 10485760
    s_add_u32 s96, s92, s45
    s_addc_u32 s97, s93, 0
    s_mov_b32 s98, 65536
    s_mov_b32 s50, s53
    s_mov_b32 s63, 4
    s_lshl_b32 s46, s44, 7
    s_add_u32 s46, s46, 1581056
    v_mov_b32 v2, 1
    s_mov_b64 exec, 1
    s_waitcnt vmcnt(0)
    buffer_atomic_add v2, off, s[4:7], s46 sc1
    s_mov_b64 exec, -1
    buffer_store_dwordx2 v[8:9], v10, s[4:7], s52 offen sc1
    s_barrier
    ds_read_b128 v[128:131], v3 offset:0
    ds_read_b128 v[132:135], v3 offset:14336
    ds_read_b128 v[136:139], v3 offset:1024
    ds_read_b128 v[140:143], v3 offset:15360
    ds_read_b128 v[144:147], v3 offset:2048
    ds_read_b128 v[148:151], v3 offset:16384
    v_mov_b32 v12, 536870912
    v_mov_b32 v1, 0
    v_writelane_b32 v12, 0, 0
    s_waitcnt lgkmcnt(4)
    v_mfma_f32_16x16x32_bf16 v[16:19], v[128:131], v[160:163], 0
    ds_read_b128 v[152:155], v3 offset:3072
    v_mfma_f32_16x16x32_bf16 v[16:19], v[132:135], v[164:167], v[16:19]
    v_mfma_f32_16x16x32_bf16 v[20:23], v[132:135], v[172:175], 0
    ds_read_b128 v[156:159], v3 offset:17408
    v_mfma_f32_16x16x32_bf16 v[20:23], v[128:131], v[168:171], v[20:23]
    s_waitcnt lgkmcnt(4)
    v_mfma_f32_16x16x32_bf16 v[28:31], v[136:139], v[168:171], 0
    ds_read_b128 v[128:131], v3 offset:4096
    v_mfma_f32_16x16x32_bf16 v[28:31], v[140:143], v[172:175], v[28:31]
    v_mfma_f32_16x16x32_bf16 v[24:27], v[140:143], v[164:167], 0
    ds_read_b128 v[132:135], v3 offset:18432
    v_mfma_f32_16x16x32_bf16 v[24:27], v[136:139], v[160:163], v[24:27]
    s_waitcnt lgkmcnt(4)
    v_mfma_f32_16x16x32_bf16 v[32:35], v[144:147], v[160:163], 0
    ds_read_b128 v[136:139], v3 offset:5120
    v_mfma_f32_16x16x32_bf16 v[32:35], v[148:151], v[164:167], v[32:35]
    v_mfma_f32_16x16x32_bf16 v[36:39], v[148:151], v[172:175], 0
    ds_read_b128 v[140:143], v3 offset:19456
    v_mfma_f32_16x16x32_bf16 v[36:39], v[144:147], v[168:171], v[36:39]
    s_waitcnt lgkmcnt(4)
    v_mfma_f32_16x16x32_bf16 v[44:47], v[152:155], v[168:171], 0
    ds_read_b128 v[144:147], v3 offset:6144
    v_mfma_f32_16x16x32_bf16 v[44:47], v[156:159], v[172:175], v[44:47]
    v_mfma_f32_16x16x32_bf16 v[40:43], v[156:159], v[164:167], 0
    ds_read_b128 v[148:151], v3 offset:20480
    v_mfma_f32_16x16x32_bf16 v[40:43], v[152:155], v[160:163], v[40:43]
    s_waitcnt lgkmcnt(4)
    v_mfma_f32_16x16x32_bf16 v[48:51], v[128:131], v[160:163], 0
    ds_read_b128 v[152:155], v3 offset:7168
    v_mfma_f32_16x16x32_bf16 v[48:51], v[132:135], v[164:167], v[48:51]
    v_mfma_f32_16x16x32_bf16 v[52:55], v[132:135], v[172:175], 0
    ds_read_b128 v[156:159], v3 offset:21504
    v_mfma_f32_16x16x32_bf16 v[52:55], v[128:131], v[168:171], v[52:55]
    s_waitcnt lgkmcnt(4)
    v_mfma_f32_16x16x32_bf16 v[60:63], v[136:139], v[168:171], 0
    ds_read_b128 v[128:131], v3 offset:8192
    v_mfma_f32_16x16x32_bf16 v[60:63], v[140:143], v[172:175], v[60:63]
    v_mfma_f32_16x16x32_bf16 v[56:59], v[140:143], v[164:167], 0
    ds_read_b128 v[132:135], v3 offset:22528
    v_mfma_f32_16x16x32_bf16 v[56:59], v[136:139], v[160:163], v[56:59]
    s_waitcnt lgkmcnt(4)
    v_mfma_f32_16x16x32_bf16 v[64:67], v[144:147], v[160:163], 0
    ds_read_b128 v[136:139], v3 offset:9216
    v_mfma_f32_16x16x32_bf16 v[64:67], v[148:151], v[164:167], v[64:67]
    v_mfma_f32_16x16x32_bf16 v[68:71], v[148:151], v[172:175], 0
    ds_read_b128 v[140:143], v3 offset:23552
    v_mfma_f32_16x16x32_bf16 v[68:71], v[144:147], v[168:171], v[68:71]
    s_waitcnt lgkmcnt(4)
    v_mfma_f32_16x16x32_bf16 v[76:79], v[168:171], v[152:155], 0
    ds_read_b128 v[144:147], v3 offset:10240
    v_mfma_f32_16x16x32_bf16 v[76:79], v[172:175], v[156:159], v[76:79]
    v_mfma_f32_16x16x32_bf16 v[72:75], v[164:167], v[156:159], 0
    ds_read_b128 v[148:151], v3 offset:24576
    v_mfma_f32_16x16x32_bf16 v[72:75], v[160:163], v[152:155], v[72:75]
    s_waitcnt lgkmcnt(4)
    v_mfma_f32_16x16x32_bf16 v[80:83], v[160:163], v[128:131], 0
    ds_read_b128 v[152:155], v3 offset:11264
    v_mfma_f32_16x16x32_bf16 v[80:83], v[164:167], v[132:135], v[80:83]
    buffer_atomic_add v1, v12, s[4:7], s46 offen sc0 sc1
    v_mfma_f32_16x16x32_bf16 v[84:87], v[172:175], v[132:135], 0
    ds_read_b128 v[156:159], v3 offset:25600
    v_mfma_f32_16x16x32_bf16 v[84:87], v[168:171], v[128:131], v[84:87]
    s_waitcnt lgkmcnt(4)
    v_mfma_f32_16x16x32_bf16 v[92:95], v[168:171], v[136:139], 0
    ds_read_b128 v[128:131], v3 offset:12288
    v_mfma_f32_16x16x32_bf16 v[92:95], v[172:175], v[140:143], v[92:95]
    v_mfma_f32_16x16x32_bf16 v[88:91], v[164:167], v[140:143], 0
    ds_read_b128 v[132:135], v3 offset:26624
    v_mfma_f32_16x16x32_bf16 v[88:91], v[160:163], v[136:139], v[88:91]
    s_waitcnt lgkmcnt(4)
    v_mfma_f32_16x16x32_bf16 v[96:99], v[160:163], v[144:147], 0
    ds_read_b128 v[136:139], v3 offset:13312
    v_mfma_f32_16x16x32_bf16 v[96:99], v[164:167], v[148:151], v[96:99]
    v_mfma_f32_16x16x32_bf16 v[100:103], v[172:175], v[148:151], 0
    ds_read_b128 v[140:143], v3 offset:27648
    v_mfma_f32_16x16x32_bf16 v[100:103], v[168:171], v[144:147], v[100:103]
    s_barrier
    s_waitcnt lgkmcnt(4)
    v_mfma_f32_16x16x32_bf16 v[108:111], v[168:171], v[152:155], 0
    ds_read_b128 v[144:147], v3 offset:28672
    v_mfma_f32_16x16x32_bf16 v[108:111], v[172:175], v[156:159], v[108:111]
    v_mfma_f32_16x16x32_bf16 v[104:107], v[164:167], v[156:159], 0
    ds_read_b128 v[148:151], v3 offset:43008
    v_mfma_f32_16x16x32_bf16 v[104:107], v[160:163], v[152:155], v[104:107]
    s_waitcnt lgkmcnt(4)
    v_mfma_f32_16x16x32_bf16 v[112:115], v[160:163], v[128:131], 0
    ds_read_b128 v[152:155], v3 offset:29696
    v_mfma_f32_16x16x32_bf16 v[112:115], v[164:167], v[132:135], v[112:115]
    v_mfma_f32_16x16x32_bf16 v[116:119], v[172:175], v[132:135], 0
    ds_read_b128 v[156:159], v3 offset:44032
    v_mfma_f32_16x16x32_bf16 v[116:119], v[168:171], v[128:131], v[116:119]
    s_waitcnt lgkmcnt(4)
    v_mfma_f32_16x16x32_bf16 v[124:127], v[168:171], v[136:139], 0
    ds_read_b128 v[128:131], v3 offset:30720
    v_mfma_f32_16x16x32_bf16 v[124:127], v[172:175], v[140:143], v[124:127]
    v_mfma_f32_16x16x32_bf16 v[120:123], v[164:167], v[140:143], 0
    ds_read_b128 v[132:135], v3 offset:45056
    v_mfma_f32_16x16x32_bf16 v[120:123], v[160:163], v[136:139], v[120:123]
    s_waitcnt vmcnt(0)
    v_readfirstlane_b32 s47, v1
    s_cmp_ge_u32 s47, 16
    s_cbranch_scc1 adaLN_cond__grouped_kv_mqa__mixer_gmlp__prompt_kernel_px_y
    s_mov_b32 s47, 262144
    s_mov_b64 exec, 1
adaLN_cond__grouped_kv_mqa__mixer_gmlp__prompt_kernel_px:
    v_mov_b32 v1, 0
    buffer_atomic_add v1, off, s[4:7], s46 sc0 sc1
    s_sub_u32 s47, s47, 1
    s_waitcnt vmcnt(0)
    v_cmp_gt_u32 vcc, 16, v1
    s_cmp_eq_u32 s47, 0
    s_cbranch_scc1 adaLN_cond__grouped_kv_mqa__mixer_gmlp__prompt_kernel_px_x
    s_cbranch_vccnz adaLN_cond__grouped_kv_mqa__mixer_gmlp__prompt_kernel_px
adaLN_cond__grouped_kv_mqa__mixer_gmlp__prompt_kernel_px_x:
    s_mov_b64 exec, -1
adaLN_cond__grouped_kv_mqa__mixer_gmlp__prompt_kernel_px_y:
    buffer_load_dwordx4 v[176:179], v4, s[96:99], s50 offen offset:0 sc1
    buffer_load_dwordx4 v[180:183], v4, s[96:99], s50 offen offset:2048 sc1
    buffer_load_dwordx4 v[184:187], v4, s[96:99], s50 offen offset:256 sc1
    buffer_load_dwordx4 v[188:191], v4, s[96:99], s50 offen offset:2304 sc1
    s_add_u32 s50, s50, 4096
    s_and_b32 s50, s50, 0xffff
    buffer_load_dwordx4 v[192:195], v4, s[96:99], s50 offen offset:0 sc1
    buffer_load_dwordx4 v[196:199], v4, s[96:99], s50 offen offset:2048 sc1
    buffer_load_dwordx4 v[200:203], v4, s[96:99], s50 offen offset:256 sc1
    buffer_load_dwordx4 v[204:207], v4, s[96:99], s50 offen offset:2304 sc1
    s_add_u32 s50, s50, 4096
    s_and_b32 s50, s50, 0xffff
    buffer_load_dwordx4 v[208:211], v4, s[96:99], s50 offen offset:0 sc1
    buffer_load_dwordx4 v[212:215], v4, s[96:99], s50 offen offset:2048 sc1
    buffer_load_dwordx4 v[216:219], v4, s[96:99], s50 offen offset:256 sc1
    buffer_load_dwordx4 v[220:223], v4, s[96:99], s50 offen offset:2304 sc1
    s_add_u32 s50, s50, 4096
    s_and_b32 s50, s50, 0xffff
    s_branch adaLN_cond__grouped_kv_mqa__mixer_gmlp__prompt_kernel_l5_u1
.p2align 6
adaLN_cond__grouped_kv_mqa__mixer_gmlp__prompt_kernel_l5:
    s_waitcnt vmcnt(8) lgkmcnt(4)
    v_mfma_f32_16x16x32_bf16 v[16:19], v[128:131], v[160:163], v[16:19]
    ds_read_b128 v[152:155], v3 offset:3072
    v_mfma_f32_16x16x32_bf16 v[16:19], v[132:135], v[164:167], v[16:19]
    v_mfma_f32_16x16x32_bf16 v[20:23], v[132:135], v[172:175], v[20:23]
    ds_read_b128 v[156:159], v3 offset:17408
    v_mfma_f32_16x16x32_bf16 v[20:23], v[128:131], v[168:171], v[20:23]
    s_waitcnt lgkmcnt(4)
    v_mfma_f32_16x16x32_bf16 v[28:31], v[136:139], v[168:171], v[28:31]
    ds_read_b128 v[128:131], v3 offset:4096
    v_mfma_f32_16x16x32_bf16 v[28:31], v[140:143], v[172:175], v[28:31]
    v_mfma_f32_16x16x32_bf16 v[24:27], v[140:143], v[164:167], v[24:27]
    ds_read_b128 v[132:135], v3 offset:18432
    v_mfma_f32_16x16x32_bf16 v[24:27], v[136:139], v[160:163], v[24:27]
    s_waitcnt lgkmcnt(4)
    v_mfma_f32_16x16x32_bf16 v[32:35], v[144:147], v[160:163], v[32:35]
    ds_read_b128 v[136:139], v3 offset:5120
    v_mfma_f32_16x16x32_bf16 v[32:35], v[148:151], v[164:167], v[32:35]
    v_mfma_f32_16x16x32_bf16 v[36:39], v[148:151], v[172:175], v[36:39]
    ds_read_b128 v[140:143], v3 offset:19456
    v_mfma_f32_16x16x32_bf16 v[36:39], v[144:147], v[168:171], v[36:39]
    s_waitcnt lgkmcnt(4)
    v_mfma_f32_16x16x32_bf16 v[44:47], v[152:155], v[168:171], v[44:47]
    ds_read_b128 v[144:147], v3 offset:6144
    v_mfma_f32_16x16x32_bf16 v[44:47], v[156:159], v[172:175], v[44:47]
    v_mfma_f32_16x16x32_bf16 v[40:43], v[156:159], v[164:167], v[40:43]
    ds_read_b128 v[148:151], v3 offset:20480
    v_mfma_f32_16x16x32_bf16 v[40:43], v[152:155], v[160:163], v[40:43]
    s_waitcnt lgkmcnt(4)
    v_mfma_f32_16x16x32_bf16 v[48:51], v[128:131], v[160:163], v[48:51]
    ds_read_b128 v[152:155], v3 offset:7168
    v_mfma_f32_16x16x32_bf16 v[48:51], v[132:135], v[164:167], v[48:51]
    v_mfma_f32_16x16x32_bf16 v[52:55], v[132:135], v[172:175], v[52:55]
    ds_read_b128 v[156:159], v3 offset:21504
    v_mfma_f32_16x16x32_bf16 v[52:55], v[128:131], v[168:171], v[52:55]
    s_waitcnt lgkmcnt(4)
    v_mfma_f32_16x16x32_bf16 v[60:63], v[136:139], v[168:171], v[60:63]
    ds_read_b128 v[128:131], v3 offset:8192
    v_mfma_f32_16x16x32_bf16 v[60:63], v[140:143], v[172:175], v[60:63]
    buffer_load_dwordx4 v[208:211], v4, s[96:99], s50 offen offset:0 sc1
    v_mfma_f32_16x16x32_bf16 v[56:59], v[140:143], v[164:167], v[56:59]
    ds_read_b128 v[132:135], v3 offset:22528
    v_mfma_f32_16x16x32_bf16 v[56:59], v[136:139], v[160:163], v[56:59]
    s_waitcnt lgkmcnt(4)
    v_mfma_f32_16x16x32_bf16 v[64:67], v[144:147], v[160:163], v[64:67]
    ds_read_b128 v[136:139], v3 offset:9216
    v_mfma_f32_16x16x32_bf16 v[64:67], v[148:151], v[164:167], v[64:67]
    buffer_load_dwordx4 v[212:215], v4, s[96:99], s50 offen offset:2048 sc1
    v_mfma_f32_16x16x32_bf16 v[68:71], v[148:151], v[172:175], v[68:71]
    ds_read_b128 v[140:143], v3 offset:23552
    v_mfma_f32_16x16x32_bf16 v[68:71], v[144:147], v[168:171], v[68:71]
    s_waitcnt lgkmcnt(4)
    v_mfma_f32_16x16x32_bf16 v[76:79], v[168:171], v[152:155], v[76:79]
    ds_read_b128 v[144:147], v3 offset:10240
    v_mfma_f32_16x16x32_bf16 v[76:79], v[172:175], v[156:159], v[76:79]
    buffer_load_dwordx4 v[216:219], v4, s[96:99], s50 offen offset:256 sc1
    v_mfma_f32_16x16x32_bf16 v[72:75], v[164:167], v[156:159], v[72:75]
    ds_read_b128 v[148:151], v3 offset:24576
    v_mfma_f32_16x16x32_bf16 v[72:75], v[160:163], v[152:155], v[72:75]
    s_waitcnt lgkmcnt(4)
    v_mfma_f32_16x16x32_bf16 v[80:83], v[160:163], v[128:131], v[80:83]
    ds_read_b128 v[152:155], v3 offset:11264
    v_mfma_f32_16x16x32_bf16 v[80:83], v[164:167], v[132:135], v[80:83]
    buffer_load_dwordx4 v[220:223], v4, s[96:99], s50 offen offset:2304 sc1
    v_mfma_f32_16x16x32_bf16 v[84:87], v[172:175], v[132:135], v[84:87]
    ds_read_b128 v[156:159], v3 offset:25600
    s_add_u32 s50, s50, 4096
    s_and_b32 s50, s50, 0xffff
    v_mfma_f32_16x16x32_bf16 v[84:87], v[168:171], v[128:131], v[84:87]
    s_waitcnt lgkmcnt(4)
    v_mfma_f32_16x16x32_bf16 v[92:95], v[168:171], v[136:139], v[92:95]
    ds_read_b128 v[128:131], v3 offset:12288
    v_mfma_f32_16x16x32_bf16 v[92:95], v[172:175], v[140:143], v[92:95]
    v_mfma_f32_16x16x32_bf16 v[88:91], v[164:167], v[140:143], v[88:91]
    ds_read_b128 v[132:135], v3 offset:26624
    v_mfma_f32_16x16x32_bf16 v[88:91], v[160:163], v[136:139], v[88:91]
    s_waitcnt lgkmcnt(4)
    v_mfma_f32_16x16x32_bf16 v[96:99], v[160:163], v[144:147], v[96:99]
    ds_read_b128 v[136:139], v3 offset:13312
    v_mfma_f32_16x16x32_bf16 v[96:99], v[164:167], v[148:151], v[96:99]
    v_mfma_f32_16x16x32_bf16 v[100:103], v[172:175], v[148:151], v[100:103]
    ds_read_b128 v[140:143], v3 offset:27648
    v_mfma_f32_16x16x32_bf16 v[100:103], v[168:171], v[144:147], v[100:103]
    s_barrier
    s_waitcnt lgkmcnt(4)
    v_mfma_f32_16x16x32_bf16 v[108:111], v[168:171], v[152:155], v[108:111]
    ds_read_b128 v[144:147], v3 offset:28672
    v_mfma_f32_16x16x32_bf16 v[108:111], v[172:175], v[156:159], v[108:111]
    v_mfma_f32_16x16x32_bf16 v[104:107], v[164:167], v[156:159], v[104:107]
    ds_read_b128 v[148:151], v3 offset:43008
    v_mfma_f32_16x16x32_bf16 v[104:107], v[160:163], v[152:155], v[104:107]
    s_waitcnt lgkmcnt(4)
    v_mfma_f32_16x16x32_bf16 v[112:115], v[160:163], v[128:131], v[112:115]
    ds_read_b128 v[152:155], v3 offset:29696
    v_mfma_f32_16x16x32_bf16 v[112:115], v[164:167], v[132:135], v[112:115]
    v_mfma_f32_16x16x32_bf16 v[116:119], v[172:175], v[132:135], v[116:119]
    ds_read_b128 v[156:159], v3 offset:44032
    v_mfma_f32_16x16x32_bf16 v[116:119], v[168:171], v[128:131], v[116:119]
    s_waitcnt lgkmcnt(4)
    v_mfma_f32_16x16x32_bf16 v[124:127], v[168:171], v[136:139], v[124:127]
    ds_read_b128 v[128:131], v3 offset:30720
    v_mfma_f32_16x16x32_bf16 v[124:127], v[172:175], v[140:143], v[124:127]
    v_mfma_f32_16x16x32_bf16 v[120:123], v[164:167], v[140:143], v[120:123]
    ds_read_b128 v[132:135], v3 offset:45056
    v_mfma_f32_16x16x32_bf16 v[120:123], v[160:163], v[136:139], v[120:123]
adaLN_cond__grouped_kv_mqa__mixer_gmlp__prompt_kernel_l5_u1:
    s_waitcnt vmcnt(8) lgkmcnt(4)
    v_mfma_f32_16x16x32_bf16 v[16:19], v[144:147], v[176:179], v[16:19]
    ds_read_b128 v[136:139], v3 offset:31744
    v_mfma_f32_16x16x32_bf16 v[16:19], v[148:151], v[180:183], v[16:19]
    v_mfma_f32_16x16x32_bf16 v[20:23], v[148:151], v[188:191], v[20:23]
    ds_read_b128 v[140:143], v3 offset:46080
    v_mfma_f32_16x16x32_bf16 v[20:23], v[144:147], v[184:187], v[20:23]
    s_waitcnt lgkmcnt(4)
    v_mfma_f32_16x16x32_bf16 v[28:31], v[152:155], v[184:187], v[28:31]
    ds_read_b128 v[144:147], v3 offset:32768
    v_mfma_f32_16x16x32_bf16 v[28:31], v[156:159], v[188:191], v[28:31]
    v_mfma_f32_16x16x32_bf16 v[24:27], v[156:159], v[180:183], v[24:27]
    ds_read_b128 v[148:151], v3 offset:47104
    v_mfma_f32_16x16x32_bf16 v[24:27], v[152:155], v[176:179], v[24:27]
    s_waitcnt lgkmcnt(4)
    v_mfma_f32_16x16x32_bf16 v[32:35], v[128:131], v[176:179], v[32:35]
    ds_read_b128 v[152:155], v3 offset:33792
    v_mfma_f32_16x16x32_bf16 v[32:35], v[132:135], v[180:183], v[32:35]
    v_mfma_f32_16x16x32_bf16 v[36:39], v[132:135], v[188:191], v[36:39]
    ds_read_b128 v[156:159], v3 offset:48128
    v_mfma_f32_16x16x32_bf16 v[36:39], v[128:131], v[184:187], v[36:39]
    s_waitcnt lgkmcnt(4)
    v_mfma_f32_16x16x32_bf16 v[44:47], v[136:139], v[184:187], v[44:47]
    ds_read_b128 v[128:131], v3 offset:34816
    v_mfma_f32_16x16x32_bf16 v[44:47], v[140:143], v[188:191], v[44:47]
    v_mfma_f32_16x16x32_bf16 v[40:43], v[140:143], v[180:183], v[40:43]
    ds_read_b128 v[132:135], v3 offset:49152
    v_mfma_f32_16x16x32_bf16 v[40:43], v[136:139], v[176:179], v[40:43]
    s_waitcnt lgkmcnt(4)
    v_mfma_f32_16x16x32_bf16 v[48:51], v[144:147], v[176:179], v[48:51]
    ds_read_b128 v[136:139], v3 offset:35840
    v_mfma_f32_16x16x32_bf16 v[48:51], v[148:151], v[180:183], v[48:51]
    v_mfma_f32_16x16x32_bf16 v[52:55], v[148:151], v[188:191], v[52:55]
    ds_read_b128 v[140:143], v3 offset:50176
    v_mfma_f32_16x16x32_bf16 v[52:55], v[144:147], v[184:187], v[52:55]
    s_waitcnt lgkmcnt(4)
    v_mfma_f32_16x16x32_bf16 v[60:63], v[152:155], v[184:187], v[60:63]
    ds_read_b128 v[144:147], v3 offset:36864
    s_cmp_eq_u32 s63, 1
    s_cselect_b32 s98, 0, s98
    v_mfma_f32_16x16x32_bf16 v[60:63], v[156:159], v[188:191], v[60:63]
    buffer_load_dwordx4 v[160:163], v4, s[96:99], s50 offen offset:0 sc1
    v_mfma_f32_16x16x32_bf16 v[56:59], v[156:159], v[180:183], v[56:59]
    ds_read_b128 v[148:151], v3 offset:51200
    v_mfma_f32_16x16x32_bf16 v[56:59], v[152:155], v[176:179], v[56:59]
    s_waitcnt lgkmcnt(4)
    v_mfma_f32_16x16x32_bf16 v[64:67], v[128:131], v[176:179], v[64:67]
    ds_read_b128 v[152:155], v3 offset:37888
    v_mfma_f32_16x16x32_bf16 v[64:67], v[132:135], v[180:183], v[64:67]
    buffer_load_dwordx4 v[164:167], v4, s[96:99], s50 offen offset:2048 sc1
    v_mfma_f32_16x16x32_bf16 v[68:71], v[132:135], v[188:191], v[68:71]
    ds_read_b128 v[156:159], v3 offset:52224
    v_mfma_f32_16x16x32_bf16 v[68:71], v[128:131], v[184:187], v[68:71]
    s_waitcnt lgkmcnt(4)
    v_mfma_f32_16x16x32_bf16 v[76:79], v[184:187], v[136:139], v[76:79]
    ds_read_b128 v[128:131], v3 offset:38912
    v_mfma_f32_16x16x32_bf16 v[76:79], v[188:191], v[140:143], v[76:79]
    buffer_load_dwordx4 v[168:171], v4, s[96:99], s50 offen offset:256 sc1
    v_mfma_f32_16x16x32_bf16 v[72:75], v[180:183], v[140:143], v[72:75]
    ds_read_b128 v[132:135], v3 offset:53248
    v_mfma_f32_16x16x32_bf16 v[72:75], v[176:179], v[136:139], v[72:75]
    s_waitcnt lgkmcnt(4)
    v_mfma_f32_16x16x32_bf16 v[80:83], v[176:179], v[144:147], v[80:83]
    ds_read_b128 v[136:139], v3 offset:39936
    v_mfma_f32_16x16x32_bf16 v[80:83], v[180:183], v[148:151], v[80:83]
    buffer_load_dwordx4 v[172:175], v4, s[96:99], s50 offen offset:2304 sc1
    v_mfma_f32_16x16x32_bf16 v[84:87], v[188:191], v[148:151], v[84:87]
    ds_read_b128 v[140:143], v3 offset:54272
    s_add_u32 s50, s50, 4096
    s_and_b32 s50, s50, 0xffff
    v_mfma_f32_16x16x32_bf16 v[84:87], v[184:187], v[144:147], v[84:87]
    s_waitcnt lgkmcnt(4)
    v_mfma_f32_16x16x32_bf16 v[92:95], v[184:187], v[152:155], v[92:95]
    ds_read_b128 v[144:147], v3 offset:40960
    v_mfma_f32_16x16x32_bf16 v[92:95], v[188:191], v[156:159], v[92:95]
    v_mfma_f32_16x16x32_bf16 v[88:91], v[180:183], v[156:159], v[88:91]
    ds_read_b128 v[148:151], v3 offset:55296
    v_mfma_f32_16x16x32_bf16 v[88:91], v[176:179], v[152:155], v[88:91]
    s_waitcnt lgkmcnt(4)
    v_mfma_f32_16x16x32_bf16 v[96:99], v[176:179], v[128:131], v[96:99]
    ds_read_b128 v[152:155], v3 offset:41984
    v_mfma_f32_16x16x32_bf16 v[96:99], v[180:183], v[132:135], v[96:99]
    v_mfma_f32_16x16x32_bf16 v[100:103], v[188:191], v[132:135], v[100:103]
    ds_read_b128 v[156:159], v3 offset:56320
    v_mfma_f32_16x16x32_bf16 v[100:103], v[184:187], v[128:131], v[100:103]
    s_barrier
    s_waitcnt lgkmcnt(4)
    v_mfma_f32_16x16x32_bf16 v[108:111], v[184:187], v[136:139], v[108:111]
    ds_read_b128 v[128:131], v3 offset:57344
    v_mfma_f32_16x16x32_bf16 v[108:111], v[188:191], v[140:143], v[108:111]
    v_mfma_f32_16x16x32_bf16 v[104:107], v[180:183], v[140:143], v[104:107]
    ds_read_b128 v[132:135], v5 offset:6144
    v_mfma_f32_16x16x32_bf16 v[104:107], v[176:179], v[136:139], v[104:107]
    s_waitcnt lgkmcnt(4)
    v_mfma_f32_16x16x32_bf16 v[112:115], v[176:179], v[144:147], v[112:115]
    ds_read_b128 v[136:139], v3 offset:58368
    v_mfma_f32_16x16x32_bf16 v[112:115], v[180:183], v[148:151], v[112:115]
    v_mfma_f32_16x16x32_bf16 v[116:119], v[188:191], v[148:151], v[116:119]
    ds_read_b128 v[140:143], v5 offset:7168
    v_mfma_f32_16x16x32_bf16 v[116:119], v[184:187], v[144:147], v[116:119]
    s_waitcnt lgkmcnt(4)
    v_mfma_f32_16x16x32_bf16 v[124:127], v[184:187], v[152:155], v[124:127]
    ds_read_b128 v[144:147], v3 offset:59392
    v_mfma_f32_16x16x32_bf16 v[124:127], v[188:191], v[156:159], v[124:127]
    v_mfma_f32_16x16x32_bf16 v[120:123], v[180:183], v[156:159], v[120:123]
    ds_read_b128 v[148:151], v5 offset:8192
    v_mfma_f32_16x16x32_bf16 v[120:123], v[176:179], v[152:155], v[120:123]
    s_waitcnt vmcnt(8) lgkmcnt(4)
    v_mfma_f32_16x16x32_bf16 v[16:19], v[128:131], v[192:195], v[16:19]
    ds_read_b128 v[152:155], v3 offset:60416
    v_mfma_f32_16x16x32_bf16 v[16:19], v[132:135], v[196:199], v[16:19]
    v_mfma_f32_16x16x32_bf16 v[20:23], v[132:135], v[204:207], v[20:23]
    ds_read_b128 v[156:159], v5 offset:9216
    v_mfma_f32_16x16x32_bf16 v[20:23], v[128:131], v[200:203], v[20:23]
    s_waitcnt lgkmcnt(4)
    v_mfma_f32_16x16x32_bf16 v[28:31], v[136:139], v[200:203], v[28:31]
    ds_read_b128 v[128:131], v3 offset:61440
    v_mfma_f32_16x16x32_bf16 v[28:31], v[140:143], v[204:207], v[28:31]
    v_mfma_f32_16x16x32_bf16 v[24:27], v[140:143], v[196:199], v[24:27]
    ds_read_b128 v[132:135], v5 offset:10240
    v_mfma_f32_16x16x32_bf16 v[24:27], v[136:139], v[192:195], v[24:27]
    s_waitcnt lgkmcnt(4)
    v_mfma_f32_16x16x32_bf16 v[32:35], v[144:147], v[192:195], v[32:35]
    ds_read_b128 v[136:139], v3 offset:62464
    v_mfma_f32_16x16x32_bf16 v[32:35], v[148:151], v[196:199], v[32:35]
    v_mfma_f32_16x16x32_bf16 v[36:39], v[148:151], v[204:207], v[36:39]
    ds_read_b128 v[140:143], v5 offset:11264
    v_mfma_f32_16x16x32_bf16 v[36:39], v[144:147], v[200:203], v[36:39]
    s_waitcnt lgkmcnt(4)
    v_mfma_f32_16x16x32_bf16 v[44:47], v[152:155], v[200:203], v[44:47]
    ds_read_b128 v[144:147], v3 offset:63488
    v_mfma_f32_16x16x32_bf16 v[44:47], v[156:159], v[204:207], v[44:47]
    v_mfma_f32_16x16x32_bf16 v[40:43], v[156:159], v[196:199], v[40:43]
    ds_read_b128 v[148:151], v5 offset:12288
    v_mfma_f32_16x16x32_bf16 v[40:43], v[152:155], v[192:195], v[40:43]
    s_waitcnt lgkmcnt(4)
    v_mfma_f32_16x16x32_bf16 v[48:51], v[128:131], v[192:195], v[48:51]
    ds_read_b128 v[152:155], v3 offset:64512
    v_mfma_f32_16x16x32_bf16 v[48:51], v[132:135], v[196:199], v[48:51]
    v_mfma_f32_16x16x32_bf16 v[52:55], v[132:135], v[204:207], v[52:55]
    ds_read_b128 v[156:159], v5 offset:13312
    v_mfma_f32_16x16x32_bf16 v[52:55], v[128:131], v[200:203], v[52:55]
    s_waitcnt lgkmcnt(4)
    v_mfma_f32_16x16x32_bf16 v[60:63], v[136:139], v[200:203], v[60:63]
    ds_read_b128 v[128:131], v5 offset:0
    v_mfma_f32_16x16x32_bf16 v[60:63], v[140:143], v[204:207], v[60:63]
    buffer_load_dwordx4 v[176:179], v4, s[96:99], s50 offen offset:0 sc1
    v_mfma_f32_16x16x32_bf16 v[56:59], v[140:143], v[196:199], v[56:59]
    ds_read_b128 v[132:135], v5 offset:14336
    v_mfma_f32_16x16x32_bf16 v[56:59], v[136:139], v[192:195], v[56:59]
    s_waitcnt lgkmcnt(4)
    v_mfma_f32_16x16x32_bf16 v[64:67], v[144:147], v[192:195], v[64:67]
    ds_read_b128 v[136:139], v5 offset:1024
    v_mfma_f32_16x16x32_bf16 v[64:67], v[148:151], v[196:199], v[64:67]
    buffer_load_dwordx4 v[180:183], v4, s[96:99], s50 offen offset:2048 sc1
    v_mfma_f32_16x16x32_bf16 v[68:71], v[148:151], v[204:207], v[68:71]
    ds_read_b128 v[140:143], v5 offset:15360
    v_mfma_f32_16x16x32_bf16 v[68:71], v[144:147], v[200:203], v[68:71]
    s_waitcnt lgkmcnt(4)
    v_mfma_f32_16x16x32_bf16 v[76:79], v[200:203], v[152:155], v[76:79]
    ds_read_b128 v[144:147], v5 offset:2048
    v_mfma_f32_16x16x32_bf16 v[76:79], v[204:207], v[156:159], v[76:79]
    buffer_load_dwordx4 v[184:187], v4, s[96:99], s50 offen offset:256 sc1
    v_mfma_f32_16x16x32_bf16 v[72:75], v[196:199], v[156:159], v[72:75]
    ds_read_b128 v[148:151], v5 offset:16384
    v_mfma_f32_16x16x32_bf16 v[72:75], v[192:195], v[152:155], v[72:75]
    s_waitcnt lgkmcnt(4)
    v_mfma_f32_16x16x32_bf16 v[80:83], v[192:195], v[128:131], v[80:83]
    ds_read_b128 v[152:155], v5 offset:3072
    v_mfma_f32_16x16x32_bf16 v[80:83], v[196:199], v[132:135], v[80:83]
    buffer_load_dwordx4 v[188:191], v4, s[96:99], s50 offen offset:2304 sc1
    v_mfma_f32_16x16x32_bf16 v[84:87], v[204:207], v[132:135], v[84:87]
    ds_read_b128 v[156:159], v5 offset:17408
    s_add_u32 s50, s50, 4096
    s_and_b32 s50, s50, 0xffff
    v_mfma_f32_16x16x32_bf16 v[84:87], v[200:203], v[128:131], v[84:87]
    s_waitcnt lgkmcnt(4)
    v_mfma_f32_16x16x32_bf16 v[92:95], v[200:203], v[136:139], v[92:95]
    ds_read_b128 v[128:131], v5 offset:4096
    v_mfma_f32_16x16x32_bf16 v[92:95], v[204:207], v[140:143], v[92:95]
    v_mfma_f32_16x16x32_bf16 v[88:91], v[196:199], v[140:143], v[88:91]
    ds_read_b128 v[132:135], v5 offset:18432
    v_mfma_f32_16x16x32_bf16 v[88:91], v[192:195], v[136:139], v[88:91]
    s_waitcnt lgkmcnt(4)
    v_mfma_f32_16x16x32_bf16 v[96:99], v[192:195], v[144:147], v[96:99]
    ds_read_b128 v[136:139], v5 offset:5120
    v_mfma_f32_16x16x32_bf16 v[96:99], v[196:199], v[148:151], v[96:99]
    v_mfma_f32_16x16x32_bf16 v[100:103], v[204:207], v[148:151], v[100:103]
    ds_read_b128 v[140:143], v5 offset:19456
    v_mfma_f32_16x16x32_bf16 v[100:103], v[200:203], v[144:147], v[100:103]
    s_barrier
    s_waitcnt lgkmcnt(4)
    v_mfma_f32_16x16x32_bf16 v[108:111], v[200:203], v[152:155], v[108:111]
    ds_read_b128 v[144:147], v5 offset:20480
    v_mfma_f32_16x16x32_bf16 v[108:111], v[204:207], v[156:159], v[108:111]
    v_mfma_f32_16x16x32_bf16 v[104:107], v[196:199], v[156:159], v[104:107]
    ds_read_b128 v[148:151], v5 offset:34816
    v_mfma_f32_16x16x32_bf16 v[104:107], v[192:195], v[152:155], v[104:107]
    s_waitcnt lgkmcnt(4)
    v_mfma_f32_16x16x32_bf16 v[112:115], v[192:195], v[128:131], v[112:115]
    ds_read_b128 v[152:155], v5 offset:21504
    v_mfma_f32_16x16x32_bf16 v[112:115], v[196:199], v[132:135], v[112:115]
    v_mfma_f32_16x16x32_bf16 v[116:119], v[204:207], v[132:135], v[116:119]
    ds_read_b128 v[156:159], v5 offset:35840
    v_mfma_f32_16x16x32_bf16 v[116:119], v[200:203], v[128:131], v[116:119]
    s_waitcnt lgkmcnt(4)
    v_mfma_f32_16x16x32_bf16 v[124:127], v[200:203], v[136:139], v[124:127]
    ds_read_b128 v[128:131], v5 offset:22528
    v_mfma_f32_16x16x32_bf16 v[124:127], v[204:207], v[140:143], v[124:127]
    v_mfma_f32_16x16x32_bf16 v[120:123], v[196:199], v[140:143], v[120:123]
    ds_read_b128 v[132:135], v5 offset:36864
    v_mfma_f32_16x16x32_bf16 v[120:123], v[192:195], v[136:139], v[120:123]
    s_waitcnt vmcnt(8) lgkmcnt(4)
    v_mfma_f32_16x16x32_bf16 v[16:19], v[144:147], v[208:211], v[16:19]
    ds_read_b128 v[136:139], v5 offset:23552
    v_mfma_f32_16x16x32_bf16 v[16:19], v[148:151], v[212:215], v[16:19]
    v_mfma_f32_16x16x32_bf16 v[20:23], v[148:151], v[220:223], v[20:23]
    ds_read_b128 v[140:143], v5 offset:37888
    v_mfma_f32_16x16x32_bf16 v[20:23], v[144:147], v[216:219], v[20:23]
    s_waitcnt lgkmcnt(4)
    v_mfma_f32_16x16x32_bf16 v[28:31], v[152:155], v[216:219], v[28:31]
    ds_read_b128 v[144:147], v5 offset:24576
    v_mfma_f32_16x16x32_bf16 v[28:31], v[156:159], v[220:223], v[28:31]
    v_mfma_f32_16x16x32_bf16 v[24:27], v[156:159], v[212:215], v[24:27]
    ds_read_b128 v[148:151], v5 offset:38912
    v_mfma_f32_16x16x32_bf16 v[24:27], v[152:155], v[208:211], v[24:27]
    s_waitcnt lgkmcnt(4)
    v_mfma_f32_16x16x32_bf16 v[32:35], v[128:131], v[208:211], v[32:35]
    ds_read_b128 v[152:155], v5 offset:25600
    v_mfma_f32_16x16x32_bf16 v[32:35], v[132:135], v[212:215], v[32:35]
    v_mfma_f32_16x16x32_bf16 v[36:39], v[132:135], v[220:223], v[36:39]
    ds_read_b128 v[156:159], v5 offset:39936
    v_mfma_f32_16x16x32_bf16 v[36:39], v[128:131], v[216:219], v[36:39]
    s_waitcnt lgkmcnt(4)
    v_mfma_f32_16x16x32_bf16 v[44:47], v[136:139], v[216:219], v[44:47]
    ds_read_b128 v[128:131], v5 offset:26624
    v_mfma_f32_16x16x32_bf16 v[44:47], v[140:143], v[220:223], v[44:47]
    v_mfma_f32_16x16x32_bf16 v[40:43], v[140:143], v[212:215], v[40:43]
    ds_read_b128 v[132:135], v5 offset:40960
    v_mfma_f32_16x16x32_bf16 v[40:43], v[136:139], v[208:211], v[40:43]
    s_waitcnt lgkmcnt(4)
    v_mfma_f32_16x16x32_bf16 v[48:51], v[144:147], v[208:211], v[48:51]
    ds_read_b128 v[136:139], v5 offset:27648
    v_mfma_f32_16x16x32_bf16 v[48:51], v[148:151], v[212:215], v[48:51]
    v_mfma_f32_16x16x32_bf16 v[52:55], v[148:151], v[220:223], v[52:55]
    ds_read_b128 v[140:143], v5 offset:41984
    v_mfma_f32_16x16x32_bf16 v[52:55], v[144:147], v[216:219], v[52:55]
    s_waitcnt lgkmcnt(4)
    v_mfma_f32_16x16x32_bf16 v[60:63], v[152:155], v[216:219], v[60:63]
    ds_read_b128 v[144:147], v5 offset:28672
    v_mfma_f32_16x16x32_bf16 v[60:63], v[156:159], v[220:223], v[60:63]
    buffer_load_dwordx4 v[192:195], v4, s[96:99], s50 offen offset:0 sc1
    v_mfma_f32_16x16x32_bf16 v[56:59], v[156:159], v[212:215], v[56:59]
    ds_read_b128 v[148:151], v5 offset:43008
    v_mfma_f32_16x16x32_bf16 v[56:59], v[152:155], v[208:211], v[56:59]
    s_waitcnt lgkmcnt(4)
    v_mfma_f32_16x16x32_bf16 v[64:67], v[128:131], v[208:211], v[64:67]
    ds_read_b128 v[152:155], v5 offset:29696
    v_mfma_f32_16x16x32_bf16 v[64:67], v[132:135], v[212:215], v[64:67]
    buffer_load_dwordx4 v[196:199], v4, s[96:99], s50 offen offset:2048 sc1
    v_mfma_f32_16x16x32_bf16 v[68:71], v[132:135], v[220:223], v[68:71]
    ds_read_b128 v[156:159], v5 offset:44032
    v_mfma_f32_16x16x32_bf16 v[68:71], v[128:131], v[216:219], v[68:71]
    s_waitcnt lgkmcnt(4)
    v_mfma_f32_16x16x32_bf16 v[76:79], v[216:219], v[136:139], v[76:79]
    ds_read_b128 v[128:131], v5 offset:30720
    v_mfma_f32_16x16x32_bf16 v[76:79], v[220:223], v[140:143], v[76:79]
    buffer_load_dwordx4 v[200:203], v4, s[96:99], s50 offen offset:256 sc1
    v_mfma_f32_16x16x32_bf16 v[72:75], v[212:215], v[140:143], v[72:75]
    ds_read_b128 v[132:135], v5 offset:45056
    v_mfma_f32_16x16x32_bf16 v[72:75], v[208:211], v[136:139], v[72:75]
    s_waitcnt lgkmcnt(4)
    v_mfma_f32_16x16x32_bf16 v[80:83], v[208:211], v[144:147], v[80:83]
    ds_read_b128 v[136:139], v5 offset:31744
    v_mfma_f32_16x16x32_bf16 v[80:83], v[212:215], v[148:151], v[80:83]
    buffer_load_dwordx4 v[204:207], v4, s[96:99], s50 offen offset:2304 sc1
    v_mfma_f32_16x16x32_bf16 v[84:87], v[220:223], v[148:151], v[84:87]
    ds_read_b128 v[140:143], v5 offset:46080
    s_add_u32 s50, s50, 4096
    s_and_b32 s50, s50, 0xffff
    v_mfma_f32_16x16x32_bf16 v[84:87], v[216:219], v[144:147], v[84:87]
    s_waitcnt lgkmcnt(4)
    v_mfma_f32_16x16x32_bf16 v[92:95], v[216:219], v[152:155], v[92:95]
    ds_read_b128 v[144:147], v5 offset:32768
    v_mfma_f32_16x16x32_bf16 v[92:95], v[220:223], v[156:159], v[92:95]
    v_mfma_f32_16x16x32_bf16 v[88:91], v[212:215], v[156:159], v[88:91]
    ds_read_b128 v[148:151], v5 offset:47104
    v_mfma_f32_16x16x32_bf16 v[88:91], v[208:211], v[152:155], v[88:91]
    s_waitcnt lgkmcnt(4)
    v_mfma_f32_16x16x32_bf16 v[96:99], v[208:211], v[128:131], v[96:99]
    ds_read_b128 v[152:155], v5 offset:33792
    v_mfma_f32_16x16x32_bf16 v[96:99], v[212:215], v[132:135], v[96:99]
    v_mfma_f32_16x16x32_bf16 v[100:103], v[220:223], v[132:135], v[100:103]
    ds_read_b128 v[156:159], v5 offset:48128
    v_mfma_f32_16x16x32_bf16 v[100:103], v[216:219], v[128:131], v[100:103]
    s_barrier
    s_waitcnt lgkmcnt(4)
    v_mfma_f32_16x16x32_bf16 v[108:111], v[216:219], v[136:139], v[108:111]
    ds_read_b128 v[128:131], v3 offset:0
    v_mfma_f32_16x16x32_bf16 v[108:111], v[220:223], v[140:143], v[108:111]
    v_mfma_f32_16x16x32_bf16 v[104:107], v[212:215], v[140:143], v[104:107]
    ds_read_b128 v[132:135], v3 offset:14336
    v_mfma_f32_16x16x32_bf16 v[104:107], v[208:211], v[136:139], v[104:107]
    s_waitcnt lgkmcnt(4)
    v_mfma_f32_16x16x32_bf16 v[112:115], v[208:211], v[144:147], v[112:115]
    ds_read_b128 v[136:139], v3 offset:1024
    v_mfma_f32_16x16x32_bf16 v[112:115], v[212:215], v[148:151], v[112:115]
    v_mfma_f32_16x16x32_bf16 v[116:119], v[220:223], v[148:151], v[116:119]
    ds_read_b128 v[140:143], v3 offset:15360
    v_mfma_f32_16x16x32_bf16 v[116:119], v[216:219], v[144:147], v[116:119]
    s_waitcnt lgkmcnt(4)
    v_mfma_f32_16x16x32_bf16 v[124:127], v[216:219], v[152:155], v[124:127]
    ds_read_b128 v[144:147], v3 offset:2048
    v_mfma_f32_16x16x32_bf16 v[124:127], v[220:223], v[156:159], v[124:127]
    v_mfma_f32_16x16x32_bf16 v[120:123], v[212:215], v[156:159], v[120:123]
    ds_read_b128 v[148:151], v3 offset:16384
    s_sub_u32 s63, s63, 1
    s_cmp_lg_u32 s63, 0
    v_mfma_f32_16x16x32_bf16 v[120:123], v[208:211], v[152:155], v[120:123]
    s_cbranch_scc1 adaLN_cond__grouped_kv_mqa__mixer_gmlp__prompt_kernel_l5
    s_waitcnt vmcnt(0) lgkmcnt(0)
    v_and_b32 v1, 15, v0
    v_lshrrev_b32 v2, 4, v0
    s_lshl_b32 s54, s43, 8
    s_add_u32 s54, s54, 133120
    v_lshlrev_b32 v8, 4, v2
    v_add_u32 v9, s54, v8
    v_add_u32 v8, 131072, v8
    v_lshlrev_b32 v10, 2, v1
    v_add_u32 v11, s54, v10
    v_add_u32 v10, 131520, v10
    ds_read_b128 v[128:131], v9 offset:0
    ds_read_b128 v[136:139], v9 offset:128
    ds_read_b128 v[132:135], v9 offset:64
    ds_read_b128 v[140:143], v9 offset:192
    ds_read_b32 v144, v10 offset:0
    ds_read_b32 v145, v10 offset:896
    ds_read_b32 v146, v10 offset:64
    ds_read_b32 v147, v10 offset:960
    ds_read_b32 v148, v10 offset:128
    ds_read_b32 v149, v10 offset:1024
    ds_read_b32 v150, v10 offset:192
    ds_read_b32 v151, v10 offset:1088
    ds_read_b32 v152, v10 offset:256
    ds_read_b32 v153, v10 offset:1152
    ds_read_b32 v154, v10 offset:320
    ds_read_b32 v155, v10 offset:1216
    ds_read_b32 v156, v10 offset:384
    ds_read_b32 v157, v10 offset:1280
    v_mov_b32 v14, 0xc0135761
    v_mov_b32 v15, 0xc0135761
    s_mov_b32 s56, 0xbdd2d3e8
    s_mov_b32 s57, 0xbdd2d3e8
    s_waitcnt lgkmcnt(12)
    v_pk_fma_f32 v[208:209], v[136:137], v[144:145], v[144:145] op_sel:[0,0,1] op_sel_hi:[1,0,1]
    v_pk_fma_f32 v[210:211], v[138:139], v[144:145], v[144:145] op_sel:[0,0,1] op_sel_hi:[1,0,1]
    v_pk_fma_f32 v[212:213], v[140:141], v[144:145], v[144:145] op_sel:[0,0,1] op_sel_hi:[1,0,1]
    v_pk_fma_f32 v[214:215], v[142:143], v[144:145], v[144:145] op_sel:[0,0,1] op_sel_hi:[1,0,1]
    v_pk_fma_f32 v[72:73], v[72:73], v[128:129], v[208:209]
    v_pk_fma_f32 v[74:75], v[74:75], v[130:131], v[210:211]
    v_pk_fma_f32 v[76:77], v[76:77], v[132:133], v[212:213]
    v_pk_fma_f32 v[78:79], v[78:79], v[134:135], v[214:215]
    v_pk_mul_f32 v[208:209], v[72:73], v[72:73]
    v_pk_mul_f32 v[210:211], v[74:75], v[74:75]
    v_pk_mul_f32 v[212:213], v[76:77], v[76:77]
    v_pk_mul_f32 v[214:215], v[78:79], v[78:79]
    v_pk_fma_f32 v[208:209], v[208:209], s[56:57], v[14:15]
    v_pk_fma_f32 v[210:211], v[210:211], s[56:57], v[14:15]
    v_pk_fma_f32 v[212:213], v[212:213], s[56:57], v[14:15]
    v_pk_fma_f32 v[214:215], v[214:215], s[56:57], v[14:15]
    v_pk_mul_f32 v[208:209], v[208:209], v[72:73]
    v_pk_mul_f32 v[210:211], v[210:211], v[74:75]
    v_pk_mul_f32 v[212:213], v[212:213], v[76:77]
    v_pk_mul_f32 v[214:215], v[214:215], v[78:79]
    v_exp_f32 v208, v208
    v_exp_f32 v209, v209
    v_exp_f32 v210, v210
    v_exp_f32 v211, v211
    v_exp_f32 v212, v212
    v_exp_f32 v213, v213
    v_exp_f32 v214, v214
    v_exp_f32 v215, v215
    v_pk_add_f32 v[208:209], v[208:209], 1.0 op_sel_hi:[1,0]
    v_pk_add_f32 v[210:211], v[210:211], 1.0 op_sel_hi:[1,0]
    v_pk_add_f32 v[212:213], v[212:213], 1.0 op_sel_hi:[1,0]
    v_pk_add_f32 v[214:215], v[214:215], 1.0 op_sel_hi:[1,0]
    v_rcp_f32 v208, v208
    v_rcp_f32 v209, v209
    v_rcp_f32 v210, v210
    v_rcp_f32 v211, v211
    v_rcp_f32 v212, v212
    v_rcp_f32 v213, v213
    v_rcp_f32 v214, v214
    v_rcp_f32 v215, v215
    v_pk_mul_f32 v[72:73], v[72:73], v[208:209]
    v_pk_mul_f32 v[74:75], v[74:75], v[210:211]
    v_pk_mul_f32 v[76:77], v[76:77], v[212:213]
    v_pk_mul_f32 v[78:79], v[78:79], v[214:215]
    v_pk_mul_f32 v[168:169], v[72:73], v[72:73]
    v_pk_mul_f32 v[170:171], v[74:75], v[74:75]
    v_pk_mul_f32 v[172:173], v[76:77], v[76:77]
    v_pk_mul_f32 v[174:175], v[78:79], v[78:79]
    s_waitcnt lgkmcnt(10)
    v_pk_fma_f32 v[208:209], v[136:137], v[146:147], v[146:147] op_sel:[0,0,1] op_sel_hi:[1,0,1]
    v_pk_fma_f32 v[210:211], v[138:139], v[146:147], v[146:147] op_sel:[0,0,1] op_sel_hi:[1,0,1]
    v_pk_fma_f32 v[212:213], v[140:141], v[146:147], v[146:147] op_sel:[0,0,1] op_sel_hi:[1,0,1]
    v_pk_fma_f32 v[214:215], v[142:143], v[146:147], v[146:147] op_sel:[0,0,1] op_sel_hi:[1,0,1]
    v_pk_fma_f32 v[80:81], v[80:81], v[128:129], v[208:209]
    v_pk_fma_f32 v[82:83], v[82:83], v[130:131], v[210:211]
    v_pk_fma_f32 v[84:85], v[84:85], v[132:133], v[212:213]
    v_pk_fma_f32 v[86:87], v[86:87], v[134:135], v[214:215]
    v_pk_mul_f32 v[208:209], v[80:81], v[80:81]
    v_pk_mul_f32 v[210:211], v[82:83], v[82:83]
    v_pk_mul_f32 v[212:213], v[84:85], v[84:85]
    v_pk_mul_f32 v[214:215], v[86:87], v[86:87]
    v_pk_fma_f32 v[208:209], v[208:209], s[56:57], v[14:15]
    v_pk_fma_f32 v[210:211], v[210:211], s[56:57], v[14:15]
    v_pk_fma_f32 v[212:213], v[212:213], s[56:57], v[14:15]
    v_pk_fma_f32 v[214:215], v[214:215], s[56:57], v[14:15]
    v_pk_mul_f32 v[208:209], v[208:209], v[80:81]
    v_pk_mul_f32 v[210:211], v[210:211], v[82:83]
    v_pk_mul_f32 v[212:213], v[212:213], v[84:85]
    v_pk_mul_f32 v[214:215], v[214:215], v[86:87]
    v_exp_f32 v208, v208
    v_exp_f32 v209, v209
    v_exp_f32 v210, v210
    v_exp_f32 v211, v211
    v_exp_f32 v212, v212
    v_exp_f32 v213, v213
    v_exp_f32 v214, v214
    v_exp_f32 v215, v215
    v_pk_add_f32 v[208:209], v[208:209], 1.0 op_sel_hi:[1,0]
    v_pk_add_f32 v[210:211], v[210:211], 1.0 op_sel_hi:[1,0]
    v_pk_add_f32 v[212:213], v[212:213], 1.0 op_sel_hi:[1,0]
    v_pk_add_f32 v[214:215], v[214:215], 1.0 op_sel_hi:[1,0]
    v_rcp_f32 v208, v208
    v_rcp_f32 v209, v209
    v_rcp_f32 v210, v210
    v_rcp_f32 v211, v211
    v_rcp_f32 v212, v212
    v_rcp_f32 v213, v213
    v_rcp_f32 v214, v214
    v_rcp_f32 v215, v215
    v_pk_mul_f32 v[80:81], v[80:81], v[208:209]
    v_pk_mul_f32 v[82:83], v[82:83], v[210:211]
    v_pk_mul_f32 v[84:85], v[84:85], v[212:213]
    v_pk_mul_f32 v[86:87], v[86:87], v[214:215]
    v_pk_fma_f32 v[168:169], v[80:81], v[80:81], v[168:169]
    v_pk_add_f32 v[160:161], v[72:73], v[80:81]
    v_pk_fma_f32 v[170:171], v[82:83], v[82:83], v[170:171]
    v_pk_add_f32 v[162:163], v[74:75], v[82:83]
    v_pk_fma_f32 v[172:173], v[84:85], v[84:85], v[172:173]
    v_pk_add_f32 v[164:165], v[76:77], v[84:85]
    v_pk_fma_f32 v[174:175], v[86:87], v[86:87], v[174:175]
    v_pk_add_f32 v[166:167], v[78:79], v[86:87]
    s_waitcnt lgkmcnt(8)
    v_pk_fma_f32 v[208:209], v[136:137], v[148:149], v[148:149] op_sel:[0,0,1] op_sel_hi:[1,0,1]
    v_pk_fma_f32 v[210:211], v[138:139], v[148:149], v[148:149] op_sel:[0,0,1] op_sel_hi:[1,0,1]
    v_pk_fma_f32 v[212:213], v[140:141], v[148:149], v[148:149] op_sel:[0,0,1] op_sel_hi:[1,0,1]
    v_pk_fma_f32 v[214:215], v[142:143], v[148:149], v[148:149] op_sel:[0,0,1] op_sel_hi:[1,0,1]
    v_pk_fma_f32 v[88:89], v[88:89], v[128:129], v[208:209]
    v_pk_fma_f32 v[90:91], v[90:91], v[130:131], v[210:211]
    v_pk_fma_f32 v[92:93], v[92:93], v[132:133], v[212:213]
    v_pk_fma_f32 v[94:95], v[94:95], v[134:135], v[214:215]
    v_pk_mul_f32 v[208:209], v[88:89], v[88:89]
    v_pk_mul_f32 v[210:211], v[90:91], v[90:91]
    v_pk_mul_f32 v[212:213], v[92:93], v[92:93]
    v_pk_mul_f32 v[214:215], v[94:95], v[94:95]
    v_pk_fma_f32 v[208:209], v[208:209], s[56:57], v[14:15]
    v_pk_fma_f32 v[210:211], v[210:211], s[56:57], v[14:15]
    v_pk_fma_f32 v[212:213], v[212:213], s[56:57], v[14:15]
    v_pk_fma_f32 v[214:215], v[214:215], s[56:57], v[14:15]
    v_pk_mul_f32 v[208:209], v[208:209], v[88:89]
    v_pk_mul_f32 v[210:211], v[210:211], v[90:91]
    v_pk_mul_f32 v[212:213], v[212:213], v[92:93]
    v_pk_mul_f32 v[214:215], v[214:215], v[94:95]
    v_exp_f32 v208, v208
    v_exp_f32 v209, v209
    v_exp_f32 v210, v210
    v_exp_f32 v211, v211
    v_exp_f32 v212, v212
    v_exp_f32 v213, v213
    v_exp_f32 v214, v214
    v_exp_f32 v215, v215
    v_pk_add_f32 v[208:209], v[208:209], 1.0 op_sel_hi:[1,0]
    v_pk_add_f32 v[210:211], v[210:211], 1.0 op_sel_hi:[1,0]
    v_pk_add_f32 v[212:213], v[212:213], 1.0 op_sel_hi:[1,0]
    v_pk_add_f32 v[214:215], v[214:215], 1.0 op_sel_hi:[1,0]
    v_rcp_f32 v208, v208
    v_rcp_f32 v209, v209
    v_rcp_f32 v210, v210
    v_rcp_f32 v211, v211
    v_rcp_f32 v212, v212
    v_rcp_f32 v213, v213
    v_rcp_f32 v214, v214
    v_rcp_f32 v215, v215
    v_pk_mul_f32 v[88:89], v[88:89], v[208:209]
    v_pk_mul_f32 v[90:91], v[90:91], v[210:211]
    v_pk_mul_f32 v[92:93], v[92:93], v[212:213]
    v_pk_mul_f32 v[94:95], v[94:95], v[214:215]
    v_pk_fma_f32 v[168:169], v[88:89], v[88:89], v[168:169]
    v_pk_add_f32 v[160:161], v[160:161], v[88:89]
    v_pk_fma_f32 v[170:171], v[90:91], v[90:91], v[170:171]
    v_pk_add_f32 v[162:163], v[162:163], v[90:91]
    v_pk_fma_f32 v[172:173], v[92:93], v[92:93], v[172:173]
    v_pk_add_f32 v[164:165], v[164:165], v[92:93]
    v_pk_fma_f32 v[174:175], v[94:95], v[94:95], v[174:175]
    v_pk_add_f32 v[166:167], v[166:167], v[94:95]
    s_waitcnt lgkmcnt(6)
    v_pk_fma_f32 v[208:209], v[136:137], v[150:151], v[150:151] op_sel:[0,0,1] op_sel_hi:[1,0,1]
    v_pk_fma_f32 v[210:211], v[138:139], v[150:151], v[150:151] op_sel:[0,0,1] op_sel_hi:[1,0,1]
    v_pk_fma_f32 v[212:213], v[140:141], v[150:151], v[150:151] op_sel:[0,0,1] op_sel_hi:[1,0,1]
    v_pk_fma_f32 v[214:215], v[142:143], v[150:151], v[150:151] op_sel:[0,0,1] op_sel_hi:[1,0,1]
    v_pk_fma_f32 v[96:97], v[96:97], v[128:129], v[208:209]
    v_pk_fma_f32 v[98:99], v[98:99], v[130:131], v[210:211]
    v_pk_fma_f32 v[100:101], v[100:101], v[132:133], v[212:213]
    v_pk_fma_f32 v[102:103], v[102:103], v[134:135], v[214:215]
    v_pk_mul_f32 v[208:209], v[96:97], v[96:97]
    v_pk_mul_f32 v[210:211], v[98:99], v[98:99]
    v_pk_mul_f32 v[212:213], v[100:101], v[100:101]
    v_pk_mul_f32 v[214:215], v[102:103], v[102:103]
    v_pk_fma_f32 v[208:209], v[208:209], s[56:57], v[14:15]
    v_pk_fma_f32 v[210:211], v[210:211], s[56:57], v[14:15]
    v_pk_fma_f32 v[212:213], v[212:213], s[56:57], v[14:15]
    v_pk_fma_f32 v[214:215], v[214:215], s[56:57], v[14:15]
    v_pk_mul_f32 v[208:209], v[208:209], v[96:97]
    v_pk_mul_f32 v[210:211], v[210:211], v[98:99]
    v_pk_mul_f32 v[212:213], v[212:213], v[100:101]
    v_pk_mul_f32 v[214:215], v[214:215], v[102:103]
    v_exp_f32 v208, v208
    v_exp_f32 v209, v209
    v_exp_f32 v210, v210
    v_exp_f32 v211, v211
    v_exp_f32 v212, v212
    v_exp_f32 v213, v213
    v_exp_f32 v214, v214
    v_exp_f32 v215, v215
    v_pk_add_f32 v[208:209], v[208:209], 1.0 op_sel_hi:[1,0]
    v_pk_add_f32 v[210:211], v[210:211], 1.0 op_sel_hi:[1,0]
    v_pk_add_f32 v[212:213], v[212:213], 1.0 op_sel_hi:[1,0]
    v_pk_add_f32 v[214:215], v[214:215], 1.0 op_sel_hi:[1,0]
    v_rcp_f32 v208, v208
    v_rcp_f32 v209, v209
    v_rcp_f32 v210, v210
    v_rcp_f32 v211, v211
    v_rcp_f32 v212, v212
    v_rcp_f32 v213, v213
    v_rcp_f32 v214, v214
    v_rcp_f32 v215, v215
    v_pk_mul_f32 v[96:97], v[96:97], v[208:209]
    v_pk_mul_f32 v[98:99], v[98:99], v[210:211]
    v_pk_mul_f32 v[100:101], v[100:101], v[212:213]
    v_pk_mul_f32 v[102:103], v[102:103], v[214:215]
    v_pk_fma_f32 v[168:169], v[96:97], v[96:97], v[168:169]
    v_pk_add_f32 v[160:161], v[160:161], v[96:97]
    v_pk_fma_f32 v[170:171], v[98:99], v[98:99], v[170:171]
    v_pk_add_f32 v[162:163], v[162:163], v[98:99]
    v_pk_fma_f32 v[172:173], v[100:101], v[100:101], v[172:173]
    v_pk_add_f32 v[164:165], v[164:165], v[100:101]
    v_pk_fma_f32 v[174:175], v[102:103], v[102:103], v[174:175]
    v_pk_add_f32 v[166:167], v[166:167], v[102:103]
    s_waitcnt lgkmcnt(4)
    v_pk_fma_f32 v[208:209], v[136:137], v[152:153], v[152:153] op_sel:[0,0,1] op_sel_hi:[1,0,1]
    v_pk_fma_f32 v[210:211], v[138:139], v[152:153], v[152:153] op_sel:[0,0,1] op_sel_hi:[1,0,1]
    v_pk_fma_f32 v[212:213], v[140:141], v[152:153], v[152:153] op_sel:[0,0,1] op_sel_hi:[1,0,1]
    v_pk_fma_f32 v[214:215], v[142:143], v[152:153], v[152:153] op_sel:[0,0,1] op_sel_hi:[1,0,1]
    v_pk_fma_f32 v[104:105], v[104:105], v[128:129], v[208:209]
    v_pk_fma_f32 v[106:107], v[106:107], v[130:131], v[210:211]
    v_pk_fma_f32 v[108:109], v[108:109], v[132:133], v[212:213]
    v_pk_fma_f32 v[110:111], v[110:111], v[134:135], v[214:215]
    v_pk_mul_f32 v[208:209], v[104:105], v[104:105]
    v_pk_mul_f32 v[210:211], v[106:107], v[106:107]
    v_pk_mul_f32 v[212:213], v[108:109], v[108:109]
    v_pk_mul_f32 v[214:215], v[110:111], v[110:111]
    v_pk_fma_f32 v[208:209], v[208:209], s[56:57], v[14:15]
    v_pk_fma_f32 v[210:211], v[210:211], s[56:57], v[14:15]
    v_pk_fma_f32 v[212:213], v[212:213], s[56:57], v[14:15]
    v_pk_fma_f32 v[214:215], v[214:215], s[56:57], v[14:15]
    v_pk_mul_f32 v[208:209], v[208:209], v[104:105]
    v_pk_mul_f32 v[210:211], v[210:211], v[106:107]
    v_pk_mul_f32 v[212:213], v[212:213], v[108:109]
    v_pk_mul_f32 v[214:215], v[214:215], v[110:111]
    v_exp_f32 v208, v208
    v_exp_f32 v209, v209
    v_exp_f32 v210, v210
    v_exp_f32 v211, v211
    v_exp_f32 v212, v212
    v_exp_f32 v213, v213
    v_exp_f32 v214, v214
    v_exp_f32 v215, v215
    v_pk_add_f32 v[208:209], v[208:209], 1.0 op_sel_hi:[1,0]
    v_pk_add_f32 v[210:211], v[210:211], 1.0 op_sel_hi:[1,0]
    v_pk_add_f32 v[212:213], v[212:213], 1.0 op_sel_hi:[1,0]
    v_pk_add_f32 v[214:215], v[214:215], 1.0 op_sel_hi:[1,0]
    v_rcp_f32 v208, v208
    v_rcp_f32 v209, v209
    v_rcp_f32 v210, v210
    v_rcp_f32 v211, v211
    v_rcp_f32 v212, v212
    v_rcp_f32 v213, v213
    v_rcp_f32 v214, v214
    v_rcp_f32 v215, v215
    v_pk_mul_f32 v[104:105], v[104:105], v[208:209]
    v_pk_mul_f32 v[106:107], v[106:107], v[210:211]
    v_pk_mul_f32 v[108:109], v[108:109], v[212:213]
    v_pk_mul_f32 v[110:111], v[110:111], v[214:215]
    v_pk_fma_f32 v[168:169], v[104:105], v[104:105], v[168:169]
    v_pk_add_f32 v[160:161], v[160:161], v[104:105]
    v_pk_fma_f32 v[170:171], v[106:107], v[106:107], v[170:171]
    v_pk_add_f32 v[162:163], v[162:163], v[106:107]
    v_pk_fma_f32 v[172:173], v[108:109], v[108:109], v[172:173]
    v_pk_add_f32 v[164:165], v[164:165], v[108:109]
    v_pk_fma_f32 v[174:175], v[110:111], v[110:111], v[174:175]
    v_pk_add_f32 v[166:167], v[166:167], v[110:111]
    s_waitcnt lgkmcnt(2)
    v_pk_fma_f32 v[208:209], v[136:137], v[154:155], v[154:155] op_sel:[0,0,1] op_sel_hi:[1,0,1]
    v_pk_fma_f32 v[210:211], v[138:139], v[154:155], v[154:155] op_sel:[0,0,1] op_sel_hi:[1,0,1]
    v_pk_fma_f32 v[212:213], v[140:141], v[154:155], v[154:155] op_sel:[0,0,1] op_sel_hi:[1,0,1]
    v_pk_fma_f32 v[214:215], v[142:143], v[154:155], v[154:155] op_sel:[0,0,1] op_sel_hi:[1,0,1]
    v_pk_fma_f32 v[112:113], v[112:113], v[128:129], v[208:209]
    v_pk_fma_f32 v[114:115], v[114:115], v[130:131], v[210:211]
    v_pk_fma_f32 v[116:117], v[116:117], v[132:133], v[212:213]
    v_pk_fma_f32 v[118:119], v[118:119], v[134:135], v[214:215]
    v_pk_mul_f32 v[208:209], v[112:113], v[112:113]
    v_pk_mul_f32 v[210:211], v[114:115], v[114:115]
    v_pk_mul_f32 v[212:213], v[116:117], v[116:117]
    v_pk_mul_f32 v[214:215], v[118:119], v[118:119]
    v_pk_fma_f32 v[208:209], v[208:209], s[56:57], v[14:15]
    v_pk_fma_f32 v[210:211], v[210:211], s[56:57], v[14:15]
    v_pk_fma_f32 v[212:213], v[212:213], s[56:57], v[14:15]
    v_pk_fma_f32 v[214:215], v[214:215], s[56:57], v[14:15]
    v_pk_mul_f32 v[208:209], v[208:209], v[112:113]
    v_pk_mul_f32 v[210:211], v[210:211], v[114:115]
    v_pk_mul_f32 v[212:213], v[212:213], v[116:117]
    v_pk_mul_f32 v[214:215], v[214:215], v[118:119]
    v_exp_f32 v208, v208
    v_exp_f32 v209, v209
    v_exp_f32 v210, v210
    v_exp_f32 v211, v211
    v_exp_f32 v212, v212
    v_exp_f32 v213, v213
    v_exp_f32 v214, v214
    v_exp_f32 v215, v215
    v_pk_add_f32 v[208:209], v[208:209], 1.0 op_sel_hi:[1,0]
    v_pk_add_f32 v[210:211], v[210:211], 1.0 op_sel_hi:[1,0]
    v_pk_add_f32 v[212:213], v[212:213], 1.0 op_sel_hi:[1,0]
    v_pk_add_f32 v[214:215], v[214:215], 1.0 op_sel_hi:[1,0]
    v_rcp_f32 v208, v208
    v_rcp_f32 v209, v209
    v_rcp_f32 v210, v210
    v_rcp_f32 v211, v211
    v_rcp_f32 v212, v212
    v_rcp_f32 v213, v213
    v_rcp_f32 v214, v214
    v_rcp_f32 v215, v215
    v_pk_mul_f32 v[112:113], v[112:113], v[208:209]
    v_pk_mul_f32 v[114:115], v[114:115], v[210:211]
    v_pk_mul_f32 v[116:117], v[116:117], v[212:213]
    v_pk_mul_f32 v[118:119], v[118:119], v[214:215]
    v_pk_fma_f32 v[168:169], v[112:113], v[112:113], v[168:169]
    v_pk_add_f32 v[160:161], v[160:161], v[112:113]
    v_pk_fma_f32 v[170:171], v[114:115], v[114:115], v[170:171]
    v_pk_add_f32 v[162:163], v[162:163], v[114:115]
    v_pk_fma_f32 v[172:173], v[116:117], v[116:117], v[172:173]
    v_pk_add_f32 v[164:165], v[164:165], v[116:117]
    v_pk_fma_f32 v[174:175], v[118:119], v[118:119], v[174:175]
    v_pk_add_f32 v[166:167], v[166:167], v[118:119]
    s_waitcnt lgkmcnt(0)
    ds_read_b32 v244, v11 offset:0
    ds_read_b32 v245, v11 offset:128
    ds_read_b32 v246, v11 offset:64
    ds_read_b32 v247, v11 offset:192
    ds_read_b128 v[144:147], v8 offset:0
    ds_read_b128 v[148:151], v8 offset:896
    v_pk_fma_f32 v[208:209], v[136:137], v[156:157], v[156:157] op_sel:[0,0,1] op_sel_hi:[1,0,1]
    v_pk_fma_f32 v[210:211], v[138:139], v[156:157], v[156:157] op_sel:[0,0,1] op_sel_hi:[1,0,1]
    v_pk_fma_f32 v[212:213], v[140:141], v[156:157], v[156:157] op_sel:[0,0,1] op_sel_hi:[1,0,1]
    v_pk_fma_f32 v[214:215], v[142:143], v[156:157], v[156:157] op_sel:[0,0,1] op_sel_hi:[1,0,1]
    v_pk_fma_f32 v[120:121], v[120:121], v[128:129], v[208:209]
    v_pk_fma_f32 v[122:123], v[122:123], v[130:131], v[210:211]
    v_pk_fma_f32 v[124:125], v[124:125], v[132:133], v[212:213]
    v_pk_fma_f32 v[126:127], v[126:127], v[134:135], v[214:215]
    v_pk_mul_f32 v[208:209], v[120:121], v[120:121]
    v_pk_mul_f32 v[210:211], v[122:123], v[122:123]
    v_pk_mul_f32 v[212:213], v[124:125], v[124:125]
    v_pk_mul_f32 v[214:215], v[126:127], v[126:127]
    v_pk_fma_f32 v[208:209], v[208:209], s[56:57], v[14:15]
    v_pk_fma_f32 v[210:211], v[210:211], s[56:57], v[14:15]
    v_pk_fma_f32 v[212:213], v[212:213], s[56:57], v[14:15]
    v_pk_fma_f32 v[214:215], v[214:215], s[56:57], v[14:15]
    v_pk_mul_f32 v[208:209], v[208:209], v[120:121]
    v_pk_mul_f32 v[210:211], v[210:211], v[122:123]
    v_pk_mul_f32 v[212:213], v[212:213], v[124:125]
    v_pk_mul_f32 v[214:215], v[214:215], v[126:127]
    v_exp_f32 v208, v208
    v_exp_f32 v209, v209
    v_exp_f32 v210, v210
    v_exp_f32 v211, v211
    v_exp_f32 v212, v212
    v_exp_f32 v213, v213
    v_exp_f32 v214, v214
    v_exp_f32 v215, v215
    v_pk_add_f32 v[208:209], v[208:209], 1.0 op_sel_hi:[1,0]
    v_pk_add_f32 v[210:211], v[210:211], 1.0 op_sel_hi:[1,0]
    v_pk_add_f32 v[212:213], v[212:213], 1.0 op_sel_hi:[1,0]
    v_pk_add_f32 v[214:215], v[214:215], 1.0 op_sel_hi:[1,0]
    v_rcp_f32 v208, v208
    v_rcp_f32 v209, v209
    v_rcp_f32 v210, v210
    v_rcp_f32 v211, v211
    v_rcp_f32 v212, v212
    v_rcp_f32 v213, v213
    v_rcp_f32 v214, v214
    v_rcp_f32 v215, v215
    v_pk_mul_f32 v[120:121], v[120:121], v[208:209]
    v_pk_mul_f32 v[122:123], v[122:123], v[210:211]
    v_pk_mul_f32 v[124:125], v[124:125], v[212:213]
    v_pk_mul_f32 v[126:127], v[126:127], v[214:215]
    v_pk_fma_f32 v[168:169], v[120:121], v[120:121], v[168:169]
    v_pk_add_f32 v[160:161], v[160:161], v[120:121]
    v_pk_fma_f32 v[170:171], v[122:123], v[122:123], v[170:171]
    v_pk_add_f32 v[162:163], v[162:163], v[122:123]
    v_pk_fma_f32 v[172:173], v[124:125], v[124:125], v[172:173]
    v_pk_add_f32 v[164:165], v[164:165], v[124:125]
    v_pk_fma_f32 v[174:175], v[126:127], v[126:127], v[174:175]
    v_pk_add_f32 v[166:167], v[166:167], v[126:127]
    ds_read_b128 v[152:155], v8 offset:64
    ds_read_b128 v[156:159], v8 offset:960
    v_lshrrev_b32 v12, 2, v0
    v_lshlrev_b32 v12, 4, v12
    v_add_f32_dpp v208, v160, v160 row_ror:8 row_mask:0xf bank_mask:0xf
    v_add_f32_dpp v209, v168, v168 row_ror:8 row_mask:0xf bank_mask:0xf
    v_add_f32_dpp v210, v161, v161 row_ror:8 row_mask:0xf bank_mask:0xf
    v_add_f32_dpp v211, v169, v169 row_ror:8 row_mask:0xf bank_mask:0xf
    v_add_f32_dpp v212, v162, v162 row_ror:8 row_mask:0xf bank_mask:0xf
    v_add_f32_dpp v213, v170, v170 row_ror:8 row_mask:0xf bank_mask:0xf
    v_add_f32_dpp v214, v163, v163 row_ror:8 row_mask:0xf bank_mask:0xf
    v_add_f32_dpp v215, v171, v171 row_ror:8 row_mask:0xf bank_mask:0xf
    v_add_f32_dpp v208, v164, v164 row_ror:8 row_mask:0xf bank_mask:0xc
    v_add_f32_dpp v209, v172, v172 row_ror:8 row_mask:0xf bank_mask:0xc
    v_add_f32_dpp v210, v165, v165 row_ror:8 row_mask:0xf bank_mask:0xc
    v_add_f32_dpp v211, v173, v173 row_ror:8 row_mask:0xf bank_mask:0xc
    v_add_f32_dpp v212, v166, v166 row_ror:8 row_mask:0xf bank_mask:0xc
    v_add_f32_dpp v213, v174, v174 row_ror:8 row_mask:0xf bank_mask:0xc
    v_add_f32_dpp v214, v167, v167 row_ror:8 row_mask:0xf bank_mask:0xc
    v_add_f32_dpp v215, v175, v175 row_ror:8 row_mask:0xf bank_mask:0xc
    v_and_b32 v13, 3, v0
    v_cmp_eq_u32 vcc, 0, v13
    v_add_f32_dpp v216, v208, v208 row_half_mirror row_mask:0xf bank_mask:0xf
    v_add_f32_dpp v217, v209, v209 row_half_mirror row_mask:0xf bank_mask:0xf
    v_add_f32_dpp v218, v210, v210 row_half_mirror row_mask:0xf bank_mask:0xf
    v_add_f32_dpp v219, v211, v211 row_half_mirror row_mask:0xf bank_mask:0xf
    v_add_f32_dpp v216, v212, v212 row_half_mirror row_mask:0xf bank_mask:0xa
    v_add_f32_dpp v217, v213, v213 row_half_mirror row_mask:0xf bank_mask:0xa
    v_add_f32_dpp v218, v214, v214 row_half_mirror row_mask:0xf bank_mask:0xa
    v_add_f32_dpp v219, v215, v215 row_half_mirror row_mask:0xf bank_mask:0xa
    v_mov_b32 v13, 536870912
    v_cndmask_b32 v12, v13, v12, vcc
    v_add_f32_dpp v208, v216, v216 quad_perm:[1,0,3,2] row_mask:0xf bank_mask:0xf
    v_add_f32_dpp v209, v217, v217 quad_perm:[1,0,3,2] row_mask:0xf bank_mask:0xf
    v_add_f32_dpp v210, v218, v218 quad_perm:[1,0,3,2] row_mask:0xf bank_mask:0xf
    v_add_f32_dpp v211, v219, v219 quad_perm:[1,0,3,2] row_mask:0xf bank_mask:0xf
    s_lshl_b32 s52, s44, 12
    s_lshl_b32 s53, s41, 8
    s_add_u32 s53, s53, s52
    s_add_u32 s53, s53, 1310720
    v_add_f32_dpp v216, v208, v208 quad_perm:[2,3,0,1] row_mask:0xf bank_mask:0xf
    v_add_f32_dpp v217, v209, v209 quad_perm:[2,3,0,1] row_mask:0xf bank_mask:0xf
    v_add_f32_dpp v218, v210, v210 quad_perm:[2,3,0,1] row_mask:0xf bank_mask:0xf
    v_add_f32_dpp v219, v211, v211 quad_perm:[2,3,0,1] row_mask:0xf bank_mask:0xf
    buffer_store_dwordx4 v[216:219], v12, s[4:7], s53 offen sc1
    v_and_b32 v12, 12, v1
    v_lshlrev_b32 v12, 1, v12
    v_and_b32 v13, 16, v1
    v_lshrrev_b32 v13, 2, v13
    v_or_b32 v12, v12, v13
    v_and_b32 v13, 3, v1
    v_or_b32 v12, v12, v13
    v_lshlrev_b32 v12, 1, v12
    s_lshl_b32 s52, s44, 6
    buffer_load_ushort v10, v12, s[36:39], s52 offen offset:0
    buffer_load_ushort v11, v12, s[36:39], s52 offen offset:8
    s_lshl_b32 s53, s40, 13
    s_mul_i32 s45, s44, 131072
    s_add_u32 s45, s45, 39845888
    s_add_u32 s96, s92, s45
    s_addc_u32 s97, s93, 0
    s_mov_b32 s98, 131072
    s_mov_b32 s50, s53
    s_and_b32 s47, s41, 0
    s_mov_b32 s58, 0xc4d3e2f1
    s_mov_b32 s59, 0x897a6b5
    s_mul_i32 s48, s40, 0x01010101
    s_lshr_b32 s45, s58, 4
    s_and_b32 s45, s45, 0x0f0f0f0f
    s_add_u32 s45, s45, s48
    s_and_b32 s45, s45, 0x0f0f0f0f
    s_lshl_b32 s45, s45, 4
    s_and_b32 s58, s58, 0x0f0f0f0f
    s_add_u32 s58, s58, s48
    s_and_b32 s58, s58, 0x0f0f0f0f
    s_or_b32 s58, s58, s45
    s_lshr_b32 s45, s59, 4
    s_and_b32 s45, s45, 0x0f0f0f0f
    s_add_u32 s45, s45, s48
    s_and_b32 s45, s45, 0x0f0f0f0f
    s_lshl_b32 s45, s45, 4
    s_and_b32 s59, s59, 0x0f0f0f0f
    s_add_u32 s59, s59, s48
    s_and_b32 s59, s59, 0x0f0f0f0f
    s_or_b32 s59, s59, s45
    s_waitcnt lgkmcnt(2)
    v_pk_fma_f32 v[208:209], v[244:245], v[144:145], v[148:149] op_sel:[1,0,0] op_sel_hi:[1,1,1]
    v_pk_fma_f32 v[210:211], v[244:245], v[146:147], v[150:151] op_sel:[1,0,0] op_sel_hi:[1,1,1]
    v_pk_fma_f32 v[212:213], v[246:247], v[144:145], v[148:149] op_sel:[1,0,0] op_sel_hi:[1,1,1]
    v_pk_fma_f32 v[214:215], v[246:247], v[146:147], v[150:151] op_sel:[1,0,0] op_sel_hi:[1,1,1]
    ds_read_b128 v[144:147], v8 offset:128
    ds_read_b128 v[148:151], v8 offset:1024
    buffer_load_dwordx4 v[160:163], v4, s[96:99], s50 offen offset:0 sc1
    buffer_load_dwordx4 v[164:167], v4, s[96:99], s50 offen offset:2048 sc1
    buffer_load_dwordx4 v[168:171], v4, s[96:99], s50 offen offset:256 sc1
    buffer_load_dwordx4 v[172:175], v4, s[96:99], s50 offen offset:2304 sc1
    s_add_u32 s50, s50, 4096
    v_pk_fma_f32 v[16:17], v[16:17], v[244:245], v[208:209] op_sel_hi:[1,0,1]
    v_pk_fma_f32 v[18:19], v[18:19], v[244:245], v[210:211] op_sel_hi:[1,0,1]
    v_pk_fma_f32 v[20:21], v[20:21], v[246:247], v[212:213] op_sel_hi:[1,0,1]
    v_pk_fma_f32 v[22:23], v[22:23], v[246:247], v[214:215] op_sel_hi:[1,0,1]
    v_pk_mul_f32 v[208:209], v[16:17], v[16:17]
    v_pk_mul_f32 v[210:211], v[18:19], v[18:19]
    v_pk_mul_f32 v[212:213], v[20:21], v[20:21]
    v_pk_mul_f32 v[214:215], v[22:23], v[22:23]
    v_pk_fma_f32 v[208:209], v[208:209], s[56:57], v[14:15]
    v_pk_fma_f32 v[210:211], v[210:211], s[56:57], v[14:15]
    v_pk_fma_f32 v[212:213], v[212:213], s[56:57], v[14:15]
    v_pk_fma_f32 v[214:215], v[214:215], s[56:57], v[14:15]
    v_pk_mul_f32 v[208:209], v[208:209], v[16:17]
    v_pk_mul_f32 v[210:211], v[210:211], v[18:19]
    v_pk_mul_f32 v[212:213], v[212:213], v[20:21]
    v_pk_mul_f32 v[214:215], v[214:215], v[22:23]
    v_exp_f32 v208, v208
    v_exp_f32 v209, v209
    v_exp_f32 v210, v210
    v_exp_f32 v211, v211
    v_exp_f32 v212, v212
    v_exp_f32 v213, v213
    v_exp_f32 v214, v214
    v_exp_f32 v215, v215
    v_pk_add_f32 v[208:209], v[208:209], 1.0 op_sel_hi:[1,0]
    v_pk_add_f32 v[210:211], v[210:211], 1.0 op_sel_hi:[1,0]
    v_pk_add_f32 v[212:213], v[212:213], 1.0 op_sel_hi:[1,0]
    v_pk_add_f32 v[214:215], v[214:215], 1.0 op_sel_hi:[1,0]
    v_rcp_f32 v208, v208
    v_rcp_f32 v209, v209
    v_rcp_f32 v210, v210
    v_rcp_f32 v211, v211
    v_rcp_f32 v212, v212
    v_rcp_f32 v213, v213
    v_rcp_f32 v214, v214
    v_rcp_f32 v215, v215
    v_pk_mul_f32 v[16:17], v[16:17], v[208:209]
    v_pk_mul_f32 v[18:19], v[18:19], v[210:211]
    v_pk_mul_f32 v[20:21], v[20:21], v[212:213]
    v_pk_mul_f32 v[22:23], v[22:23], v[214:215]
    s_waitcnt lgkmcnt(2)
    v_pk_fma_f32 v[208:209], v[244:245], v[152:153], v[156:157] op_sel:[1,0,0] op_sel_hi:[1,1,1]
    v_pk_fma_f32 v[210:211], v[244:245], v[154:155], v[158:159] op_sel:[1,0,0] op_sel_hi:[1,1,1]
    v_pk_fma_f32 v[212:213], v[246:247], v[152:153], v[156:157] op_sel:[1,0,0] op_sel_hi:[1,1,1]
    v_pk_fma_f32 v[214:215], v[246:247], v[154:155], v[158:159] op_sel:[1,0,0] op_sel_hi:[1,1,1]
    ds_read_b128 v[152:155], v8 offset:192
    ds_read_b128 v[156:159], v8 offset:1088
    buffer_load_dwordx4 v[176:179], v4, s[96:99], s50 offen offset:0 sc1
    buffer_load_dwordx4 v[180:183], v4, s[96:99], s50 offen offset:2048 sc1
    buffer_load_dwordx4 v[184:187], v4, s[96:99], s50 offen offset:256 sc1
    buffer_load_dwordx4 v[188:191], v4, s[96:99], s50 offen offset:2304 sc1
    v_pk_fma_f32 v[24:25], v[24:25], v[244:245], v[208:209] op_sel_hi:[1,0,1]
    v_pk_fma_f32 v[26:27], v[26:27], v[244:245], v[210:211] op_sel_hi:[1,0,1]
    v_pk_fma_f32 v[28:29], v[28:29], v[246:247], v[212:213] op_sel_hi:[1,0,1]
    v_pk_fma_f32 v[30:31], v[30:31], v[246:247], v[214:215] op_sel_hi:[1,0,1]
    v_pk_mul_f32 v[208:209], v[24:25], v[24:25]
    v_pk_mul_f32 v[210:211], v[26:27], v[26:27]
    v_pk_mul_f32 v[212:213], v[28:29], v[28:29]
    v_pk_mul_f32 v[214:215], v[30:31], v[30:31]
    v_pk_fma_f32 v[208:209], v[208:209], s[56:57], v[14:15]
    v_pk_fma_f32 v[210:211], v[210:211], s[56:57], v[14:15]
    v_pk_fma_f32 v[212:213], v[212:213], s[56:57], v[14:15]
    v_pk_fma_f32 v[214:215], v[214:215], s[56:57], v[14:15]
    v_pk_mul_f32 v[208:209], v[208:209], v[24:25]
    v_pk_mul_f32 v[210:211], v[210:211], v[26:27]
    v_pk_mul_f32 v[212:213], v[212:213], v[28:29]
    v_pk_mul_f32 v[214:215], v[214:215], v[30:31]
    v_exp_f32 v208, v208
    v_exp_f32 v209, v209
    v_exp_f32 v210, v210
    v_exp_f32 v211, v211
    v_exp_f32 v212, v212
    v_exp_f32 v213, v213
    v_exp_f32 v214, v214
    v_exp_f32 v215, v215
    v_pk_add_f32 v[208:209], v[208:209], 1.0 op_sel_hi:[1,0]
    v_pk_add_f32 v[210:211], v[210:211], 1.0 op_sel_hi:[1,0]
    v_pk_add_f32 v[212:213], v[212:213], 1.0 op_sel_hi:[1,0]
    v_pk_add_f32 v[214:215], v[214:215], 1.0 op_sel_hi:[1,0]
    v_rcp_f32 v208, v208
    v_rcp_f32 v209, v209
    v_rcp_f32 v210, v210
    v_rcp_f32 v211, v211
    v_rcp_f32 v212, v212
    v_rcp_f32 v213, v213
    v_rcp_f32 v214, v214
    v_rcp_f32 v215, v215
    v_pk_mul_f32 v[24:25], v[24:25], v[208:209]
    v_pk_mul_f32 v[26:27], v[26:27], v[210:211]
    v_pk_mul_f32 v[28:29], v[28:29], v[212:213]
    v_pk_mul_f32 v[30:31], v[30:31], v[214:215]
    s_waitcnt lgkmcnt(2)
    v_pk_fma_f32 v[208:209], v[244:245], v[144:145], v[148:149] op_sel:[1,0,0] op_sel_hi:[1,1,1]
    v_pk_fma_f32 v[210:211], v[244:245], v[146:147], v[150:151] op_sel:[1,0,0] op_sel_hi:[1,1,1]
    v_pk_fma_f32 v[212:213], v[246:247], v[144:145], v[148:149] op_sel:[1,0,0] op_sel_hi:[1,1,1]
    v_pk_fma_f32 v[214:215], v[246:247], v[146:147], v[150:151] op_sel:[1,0,0] op_sel_hi:[1,1,1]
    ds_read_b128 v[144:147], v8 offset:256
    ds_read_b128 v[148:151], v8 offset:1152
    s_and_b32 s50, s58, 15
    s_lshl_b32 s50, s50, 13
    s_lshr_b64 s[58:59], s[58:59], 4
    buffer_load_dwordx4 v[192:195], v4, s[96:99], s50 offen offset:0 sc1
    buffer_load_dwordx4 v[196:199], v4, s[96:99], s50 offen offset:2048 sc1
    buffer_load_dwordx4 v[200:203], v4, s[96:99], s50 offen offset:256 sc1
    buffer_load_dwordx4 v[204:207], v4, s[96:99], s50 offen offset:2304 sc1
    s_add_u32 s50, s50, 4096
    v_pk_fma_f32 v[32:33], v[32:33], v[244:245], v[208:209] op_sel_hi:[1,0,1]
    v_pk_fma_f32 v[34:35], v[34:35], v[244:245], v[210:211] op_sel_hi:[1,0,1]
    v_pk_fma_f32 v[36:37], v[36:37], v[246:247], v[212:213] op_sel_hi:[1,0,1]
    v_pk_fma_f32 v[38:39], v[38:39], v[246:247], v[214:215] op_sel_hi:[1,0,1]
    v_pk_mul_f32 v[208:209], v[32:33], v[32:33]
    v_pk_mul_f32 v[210:211], v[34:35], v[34:35]
    v_pk_mul_f32 v[212:213], v[36:37], v[36:37]
    v_pk_mul_f32 v[214:215], v[38:39], v[38:39]
    v_pk_fma_f32 v[208:209], v[208:209], s[56:57], v[14:15]
    v_pk_fma_f32 v[210:211], v[210:211], s[56:57], v[14:15]
    v_pk_fma_f32 v[212:213], v[212:213], s[56:57], v[14:15]
    v_pk_fma_f32 v[214:215], v[214:215], s[56:57], v[14:15]
    v_pk_mul_f32 v[208:209], v[208:209], v[32:33]
    v_pk_mul_f32 v[210:211], v[210:211], v[34:35]
    v_pk_mul_f32 v[212:213], v[212:213], v[36:37]
    v_pk_mul_f32 v[214:215], v[214:215], v[38:39]
    v_exp_f32 v208, v208
    v_exp_f32 v209, v209
    v_exp_f32 v210, v210
    v_exp_f32 v211, v211
    v_exp_f32 v212, v212
    v_exp_f32 v213, v213
    v_exp_f32 v214, v214
    v_exp_f32 v215, v215
    v_pk_add_f32 v[208:209], v[208:209], 1.0 op_sel_hi:[1,0]
    v_pk_add_f32 v[210:211], v[210:211], 1.0 op_sel_hi:[1,0]
    v_pk_add_f32 v[212:213], v[212:213], 1.0 op_sel_hi:[1,0]
    v_pk_add_f32 v[214:215], v[214:215], 1.0 op_sel_hi:[1,0]
    v_rcp_f32 v208, v208
    v_rcp_f32 v209, v209
    v_rcp_f32 v210, v210
    v_rcp_f32 v211, v211
    v_rcp_f32 v212, v212
    v_rcp_f32 v213, v213
    v_rcp_f32 v214, v214
    v_rcp_f32 v215, v215
    v_pk_mul_f32 v[32:33], v[32:33], v[208:209]
    v_pk_mul_f32 v[34:35], v[34:35], v[210:211]
    v_pk_mul_f32 v[36:37], v[36:37], v[212:213]
    v_pk_mul_f32 v[38:39], v[38:39], v[214:215]
    v_lshrrev_b32 v12, 4, v0
    v_lshlrev_b32 v12, 10, v12
    v_and_b32 v13, 15, v0
    v_lshl_add_u32 v12, v13, 4, v12
    s_lshl_b32 s48, s44, 12
    s_add_u32 s48, s48, 1310720
    buffer_load_dwordx4 v[128:131], v12, s[4:7], s48 offen offset:0 sc1
    buffer_load_dwordx4 v[132:135], v12, s[4:7], s48 offen offset:256 sc1
    buffer_load_dwordx4 v[136:139], v12, s[4:7], s48 offen offset:512 sc1
    buffer_load_dwordx4 v[140:143], v12, s[4:7], s48 offen offset:768 sc1
    s_waitcnt lgkmcnt(2)
    v_pk_fma_f32 v[208:209], v[244:245], v[152:153], v[156:157] op_sel:[1,0,0] op_sel_hi:[1,1,1]
    v_pk_fma_f32 v[210:211], v[244:245], v[154:155], v[158:159] op_sel:[1,0,0] op_sel_hi:[1,1,1]
    v_pk_fma_f32 v[212:213], v[246:247], v[152:153], v[156:157] op_sel:[1,0,0] op_sel_hi:[1,1,1]
    v_pk_fma_f32 v[214:215], v[246:247], v[154:155], v[158:159] op_sel:[1,0,0] op_sel_hi:[1,1,1]
    ds_read_b128 v[152:155], v8 offset:320
    ds_read_b128 v[156:159], v8 offset:1216
    v_pk_fma_f32 v[40:41], v[40:41], v[244:245], v[208:209] op_sel_hi:[1,0,1]
    v_pk_fma_f32 v[42:43], v[42:43], v[244:245], v[210:211] op_sel_hi:[1,0,1]
    v_pk_fma_f32 v[44:45], v[44:45], v[246:247], v[212:213] op_sel_hi:[1,0,1]
    v_pk_fma_f32 v[46:47], v[46:47], v[246:247], v[214:215] op_sel_hi:[1,0,1]
    v_pk_mul_f32 v[208:209], v[40:41], v[40:41]
    v_pk_mul_f32 v[210:211], v[42:43], v[42:43]
    v_pk_mul_f32 v[212:213], v[44:45], v[44:45]
    v_pk_mul_f32 v[214:215], v[46:47], v[46:47]
    v_pk_fma_f32 v[208:209], v[208:209], s[56:57], v[14:15]
    v_pk_fma_f32 v[210:211], v[210:211], s[56:57], v[14:15]
    v_pk_fma_f32 v[212:213], v[212:213], s[56:57], v[14:15]
    v_pk_fma_f32 v[214:215], v[214:215], s[56:57], v[14:15]
    v_pk_mul_f32 v[208:209], v[208:209], v[40:41]
    v_pk_mul_f32 v[210:211], v[210:211], v[42:43]
    v_pk_mul_f32 v[212:213], v[212:213], v[44:45]
    v_pk_mul_f32 v[214:215], v[214:215], v[46:47]
    v_exp_f32 v208, v208
    v_exp_f32 v209, v209
    v_exp_f32 v210, v210
    v_exp_f32 v211, v211
    v_exp_f32 v212, v212
    v_exp_f32 v213, v213
    v_exp_f32 v214, v214
    v_exp_f32 v215, v215
    v_pk_add_f32 v[208:209], v[208:209], 1.0 op_sel_hi:[1,0]
    v_pk_add_f32 v[210:211], v[210:211], 1.0 op_sel_hi:[1,0]
    v_pk_add_f32 v[212:213], v[212:213], 1.0 op_sel_hi:[1,0]
    v_pk_add_f32 v[214:215], v[214:215], 1.0 op_sel_hi:[1,0]
    v_rcp_f32 v208, v208
    v_rcp_f32 v209, v209
    v_rcp_f32 v210, v210
    v_rcp_f32 v211, v211
    v_rcp_f32 v212, v212
    v_rcp_f32 v213, v213
    v_rcp_f32 v214, v214
    v_rcp_f32 v215, v215
    v_pk_mul_f32 v[40:41], v[40:41], v[208:209]
    v_pk_mul_f32 v[42:43], v[42:43], v[210:211]
    v_pk_mul_f32 v[44:45], v[44:45], v[212:213]
    v_pk_mul_f32 v[46:47], v[46:47], v[214:215]
    s_waitcnt lgkmcnt(2)
    v_pk_fma_f32 v[208:209], v[244:245], v[144:145], v[148:149] op_sel:[1,0,0] op_sel_hi:[1,1,1]
    v_pk_fma_f32 v[210:211], v[244:245], v[146:147], v[150:151] op_sel:[1,0,0] op_sel_hi:[1,1,1]
    v_pk_fma_f32 v[212:213], v[246:247], v[144:145], v[148:149] op_sel:[1,0,0] op_sel_hi:[1,1,1]
    v_pk_fma_f32 v[214:215], v[246:247], v[146:147], v[150:151] op_sel:[1,0,0] op_sel_hi:[1,1,1]
    ds_read_b128 v[144:147], v8 offset:384
    ds_read_b128 v[148:151], v8 offset:1280
    v_pk_fma_f32 v[48:49], v[48:49], v[244:245], v[208:209] op_sel_hi:[1,0,1]
    v_pk_fma_f32 v[50:51], v[50:51], v[244:245], v[210:211] op_sel_hi:[1,0,1]
    v_pk_fma_f32 v[52:53], v[52:53], v[246:247], v[212:213] op_sel_hi:[1,0,1]
    v_pk_fma_f32 v[54:55], v[54:55], v[246:247], v[214:215] op_sel_hi:[1,0,1]
    v_pk_mul_f32 v[208:209], v[48:49], v[48:49]
    v_pk_mul_f32 v[210:211], v[50:51], v[50:51]
    v_pk_mul_f32 v[212:213], v[52:53], v[52:53]
    v_pk_mul_f32 v[214:215], v[54:55], v[54:55]
    v_pk_fma_f32 v[208:209], v[208:209], s[56:57], v[14:15]
    v_pk_fma_f32 v[210:211], v[210:211], s[56:57], v[14:15]
    v_pk_fma_f32 v[212:213], v[212:213], s[56:57], v[14:15]
    v_pk_fma_f32 v[214:215], v[214:215], s[56:57], v[14:15]
    v_pk_mul_f32 v[208:209], v[208:209], v[48:49]
    v_pk_mul_f32 v[210:211], v[210:211], v[50:51]
    v_pk_mul_f32 v[212:213], v[212:213], v[52:53]
    v_pk_mul_f32 v[214:215], v[214:215], v[54:55]
    v_exp_f32 v208, v208
    v_exp_f32 v209, v209
    v_exp_f32 v210, v210
    v_exp_f32 v211, v211
    v_exp_f32 v212, v212
    v_exp_f32 v213, v213
    v_exp_f32 v214, v214
    v_exp_f32 v215, v215
    v_pk_add_f32 v[208:209], v[208:209], 1.0 op_sel_hi:[1,0]
    v_pk_add_f32 v[210:211], v[210:211], 1.0 op_sel_hi:[1,0]
    v_pk_add_f32 v[212:213], v[212:213], 1.0 op_sel_hi:[1,0]
    v_pk_add_f32 v[214:215], v[214:215], 1.0 op_sel_hi:[1,0]
    v_rcp_f32 v208, v208
    v_rcp_f32 v209, v209
    v_rcp_f32 v210, v210
    v_rcp_f32 v211, v211
    v_rcp_f32 v212, v212
    v_rcp_f32 v213, v213
    v_rcp_f32 v214, v214
    v_rcp_f32 v215, v215
    v_pk_mul_f32 v[48:49], v[48:49], v[208:209]
    v_pk_mul_f32 v[50:51], v[50:51], v[210:211]
    v_pk_mul_f32 v[52:53], v[52:53], v[212:213]
    v_pk_mul_f32 v[54:55], v[54:55], v[214:215]
    s_mov_b32 s47, 262144
    s_waitcnt vmcnt(0)
adaLN_cond__grouped_kv_mqa__mixer_gmlp__prompt_kernel_s2:
    v_max3_u32 v13, v128, v129, v130
    v_max3_u32 v13, v13, v131, v132
    v_max3_u32 v13, v13, v133, v134
    v_max3_u32 v13, v13, v135, v136
    v_max3_u32 v13, v13, v137, v138
    v_max3_u32 v13, v13, v139, v140
    v_max3_u32 v13, v13, v141, v142
    v_max_u32 v13, v13, v143
    v_cmp_eq_u32 vcc, -1, v13
    s_sub_u32 s47, s47, 1
    s_cbranch_vccz adaLN_cond__grouped_kv_mqa__mixer_gmlp__prompt_kernel_s2_x
    s_cmp_eq_u32 s47, 0
    s_cbranch_scc1 adaLN_cond__grouped_kv_mqa__mixer_gmlp__prompt_kernel_s2_x
    buffer_load_dwordx4 v[128:131], v12, s[4:7], s48 offen offset:0 sc1
    buffer_load_dwordx4 v[132:135], v12, s[4:7], s48 offen offset:256 sc1
    buffer_load_dwordx4 v[136:139], v12, s[4:7], s48 offen offset:512 sc1
    buffer_load_dwordx4 v[140:143], v12, s[4:7], s48 offen offset:768 sc1
    s_waitcnt vmcnt(0)
    s_branch adaLN_cond__grouped_kv_mqa__mixer_gmlp__prompt_kernel_s2
adaLN_cond__grouped_kv_mqa__mixer_gmlp__prompt_kernel_s2_x:
    v_pk_add_f32 v[128:129], v[128:129], v[132:133]
    v_pk_add_f32 v[130:131], v[130:131], v[134:135]
    v_pk_add_f32 v[128:129], v[128:129], v[136:137]
    v_pk_add_f32 v[130:131], v[130:131], v[138:139]
    v_pk_add_f32 v[128:129], v[128:129], v[140:141]
    v_pk_add_f32 v[130:131], v[130:131], v[142:143]
    v_mov_b32 v132, v128
    v_mov_b32 v133, v129
    v_mov_b32 v134, v130
    v_mov_b32 v135, v131
    s_nop 0
    v_permlane16_swap_b32 v128, v132
    v_permlane16_swap_b32 v129, v133
    v_permlane16_swap_b32 v130, v134
    v_permlane16_swap_b32 v131, v135
    v_add_f32 v128, v128, v132
    v_add_f32 v129, v129, v133
    v_add_f32 v130, v130, v134
    v_add_f32 v131, v131, v135
    v_mov_b32 v132, v128
    v_mov_b32 v133, v129
    v_mov_b32 v134, v130
    v_mov_b32 v135, v131
    s_nop 0
    v_permlane32_swap_b32 v128, v132
    v_permlane32_swap_b32 v129, v133
    v_permlane32_swap_b32 v130, v134
    v_permlane32_swap_b32 v131, v135
    v_add_f32 v128, v128, v132
    v_add_f32 v129, v129, v133
    v_add_f32 v130, v130, v134
    v_add_f32 v131, v131, v135
    v_mul_f32 v128, 0x3a124925, v128
    v_mul_f32 v129, 0x3a124925, v129
    v_mul_f32 v130, 0x3a124925, v130
    v_mul_f32 v131, 0x3a124925, v131
    v_fma_f32 v129, -v128, v128, v129
    v_max_f32 v129, 0, v129
    v_add_f32 v129, 0x3727c5ac, v129
    v_fma_f32 v131, -v130, v130, v131
    v_max_f32 v131, 0, v131
    v_add_f32 v131, 0x3727c5ac, v131
    v_rsq_f32 v132, v129
    v_rsq_f32 v133, v131
    s_nop 0
    v_mul_f32 v134, v128, v132
    v_sub_f32 v134, 0, v134
    v_mul_f32 v135, v130, v133
    v_sub_f32 v135, 0, v135
    v_and_b32 v13, 15, v0
    v_lshlrev_b32 v13, 3, v13
    s_lshl_b32 s54, s43, 8
    s_add_u32 s54, s54, 134144
    v_add_u32 v13, s54, v13
    ds_write_b64 v13, v[132:133]
    ds_write_b64 v13, v[134:135] offset:128
    v_lshlrev_b32 v9, 5, v2
    v_add_u32 v9, s54, v9
    s_waitcnt lgkmcnt(0)
    ds_read_b128 v[128:131], v9 offset:0
    ds_read_b128 v[136:139], v9 offset:128
    ds_read_b128 v[132:135], v9 offset:16
    ds_read_b128 v[140:143], v9 offset:144
    s_mul_i32 s53, s43, 7168
    v_add_u32 v9, s53, v3
    s_lshl_b32 s52, s41, 6
    s_add_u32 s52, s52, s44
    s_mul_i32 s52, s52, 7168
    s_add_u32 s52, s52, 23068672
    s_add_u32 s53, s52, 4096
    s_mov_b32 s63, 4
    s_waitcnt lgkmcnt(0)
    v_pk_fma_f32 v[72:73], v[72:73], v[128:129], v[136:137]
    v_pk_fma_f32 v[74:75], v[74:75], v[130:131], v[138:139]
    v_pk_fma_f32 v[76:77], v[76:77], v[132:133], v[140:141]
    v_pk_fma_f32 v[78:79], v[78:79], v[134:135], v[142:143]
    v_cvt_pk_bf16_f32 v72, v72, v73
    v_cvt_pk_bf16_f32 v73, v74, v75
    v_cvt_pk_bf16_f32 v74, v76, v77
    v_cvt_pk_bf16_f32 v75, v78, v79
    buffer_store_dwordx4 v[72:75], v3, s[4:7], s52 offen offset:0 sc1
    v_pk_fma_f32 v[80:81], v[80:81], v[128:129], v[136:137]
    v_pk_fma_f32 v[82:83], v[82:83], v[130:131], v[138:139]
    v_pk_fma_f32 v[84:85], v[84:85], v[132:133], v[140:141]
    v_pk_fma_f32 v[86:87], v[86:87], v[134:135], v[142:143]
    v_cvt_pk_bf16_f32 v80, v80, v81
    v_cvt_pk_bf16_f32 v81, v82, v83
    v_cvt_pk_bf16_f32 v82, v84, v85
    v_cvt_pk_bf16_f32 v83, v86, v87
    buffer_store_dwordx4 v[80:83], v3, s[4:7], s52 offen offset:1024 sc1
    v_pk_fma_f32 v[88:89], v[88:89], v[128:129], v[136:137]
    v_pk_fma_f32 v[90:91], v[90:91], v[130:131], v[138:139]
    v_pk_fma_f32 v[92:93], v[92:93], v[132:133], v[140:141]
    v_pk_fma_f32 v[94:95], v[94:95], v[134:135], v[142:143]
    v_cvt_pk_bf16_f32 v88, v88, v89
    v_cvt_pk_bf16_f32 v89, v90, v91
    v_cvt_pk_bf16_f32 v90, v92, v93
    v_cvt_pk_bf16_f32 v91, v94, v95
    buffer_store_dwordx4 v[88:91], v3, s[4:7], s52 offen offset:2048 sc1
    v_pk_fma_f32 v[96:97], v[96:97], v[128:129], v[136:137]
    v_pk_fma_f32 v[98:99], v[98:99], v[130:131], v[138:139]
    v_pk_fma_f32 v[100:101], v[100:101], v[132:133], v[140:141]
    v_pk_fma_f32 v[102:103], v[102:103], v[134:135], v[142:143]
    v_cvt_pk_bf16_f32 v96, v96, v97
    v_cvt_pk_bf16_f32 v97, v98, v99
    v_cvt_pk_bf16_f32 v98, v100, v101
    v_cvt_pk_bf16_f32 v99, v102, v103
    buffer_store_dwordx4 v[96:99], v3, s[4:7], s52 offen offset:3072 sc1
    v_pk_fma_f32 v[104:105], v[104:105], v[128:129], v[136:137]
    v_pk_fma_f32 v[106:107], v[106:107], v[130:131], v[138:139]
    v_pk_fma_f32 v[108:109], v[108:109], v[132:133], v[140:141]
    v_pk_fma_f32 v[110:111], v[110:111], v[134:135], v[142:143]
    v_cvt_pk_bf16_f32 v104, v104, v105
    v_cvt_pk_bf16_f32 v105, v106, v107
    v_cvt_pk_bf16_f32 v106, v108, v109
    v_cvt_pk_bf16_f32 v107, v110, v111
    buffer_store_dwordx4 v[104:107], v3, s[4:7], s53 offen offset:0 sc1
    v_pk_fma_f32 v[112:113], v[112:113], v[128:129], v[136:137]
    v_pk_fma_f32 v[114:115], v[114:115], v[130:131], v[138:139]
    v_pk_fma_f32 v[116:117], v[116:117], v[132:133], v[140:141]
    v_pk_fma_f32 v[118:119], v[118:119], v[134:135], v[142:143]
    v_cvt_pk_bf16_f32 v112, v112, v113
    v_cvt_pk_bf16_f32 v113, v114, v115
    v_cvt_pk_bf16_f32 v114, v116, v117
    v_cvt_pk_bf16_f32 v115, v118, v119
    buffer_store_dwordx4 v[112:115], v3, s[4:7], s53 offen offset:1024 sc1
    v_pk_fma_f32 v[120:121], v[120:121], v[128:129], v[136:137]
    v_pk_fma_f32 v[122:123], v[122:123], v[130:131], v[138:139]
    v_pk_fma_f32 v[124:125], v[124:125], v[132:133], v[140:141]
    v_pk_fma_f32 v[126:127], v[126:127], v[134:135], v[142:143]
    v_cvt_pk_bf16_f32 v120, v120, v121
    v_cvt_pk_bf16_f32 v121, v122, v123
    v_cvt_pk_bf16_f32 v122, v124, v125
    v_cvt_pk_bf16_f32 v123, v126, v127
    buffer_store_dwordx4 v[120:123], v3, s[4:7], s53 offen offset:2048 sc1
    ds_write_b128 v9, v[72:75] offset:0
    ds_write_b128 v9, v[80:83] offset:1024
    ds_write_b128 v9, v[88:91] offset:2048
    ds_write_b128 v9, v[96:99] offset:3072
    ds_write_b128 v9, v[104:107] offset:4096
    ds_write_b128 v9, v[112:115] offset:5120
    ds_write_b128 v9, v[120:123] offset:6144
    v_pk_fma_f32 v[208:209], v[244:245], v[152:153], v[156:157] op_sel:[1,0,0] op_sel_hi:[1,1,1]
    v_pk_fma_f32 v[210:211], v[244:245], v[154:155], v[158:159] op_sel:[1,0,0] op_sel_hi:[1,1,1]
    v_pk_fma_f32 v[212:213], v[246:247], v[152:153], v[156:157] op_sel:[1,0,0] op_sel_hi:[1,1,1]
    v_pk_fma_f32 v[214:215], v[246:247], v[154:155], v[158:159] op_sel:[1,0,0] op_sel_hi:[1,1,1]
    v_pk_fma_f32 v[56:57], v[56:57], v[244:245], v[208:209] op_sel_hi:[1,0,1]
    v_pk_fma_f32 v[58:59], v[58:59], v[244:245], v[210:211] op_sel_hi:[1,0,1]
    v_pk_fma_f32 v[60:61], v[60:61], v[246:247], v[212:213] op_sel_hi:[1,0,1]
    v_pk_fma_f32 v[62:63], v[62:63], v[246:247], v[214:215] op_sel_hi:[1,0,1]
    v_pk_mul_f32 v[208:209], v[56:57], v[56:57]
    v_pk_mul_f32 v[210:211], v[58:59], v[58:59]
    v_pk_mul_f32 v[212:213], v[60:61], v[60:61]
    v_pk_mul_f32 v[214:215], v[62:63], v[62:63]
    v_pk_fma_f32 v[208:209], v[208:209], s[56:57], v[14:15]
    v_pk_fma_f32 v[210:211], v[210:211], s[56:57], v[14:15]
    v_pk_fma_f32 v[212:213], v[212:213], s[56:57], v[14:15]
    v_pk_fma_f32 v[214:215], v[214:215], s[56:57], v[14:15]
    v_pk_mul_f32 v[208:209], v[208:209], v[56:57]
    v_pk_mul_f32 v[210:211], v[210:211], v[58:59]
    v_pk_mul_f32 v[212:213], v[212:213], v[60:61]
    v_pk_mul_f32 v[214:215], v[214:215], v[62:63]
    v_exp_f32 v208, v208
    v_exp_f32 v209, v209
    v_exp_f32 v210, v210
    v_exp_f32 v211, v211
    v_exp_f32 v212, v212
    v_exp_f32 v213, v213
    v_exp_f32 v214, v214
    v_exp_f32 v215, v215
    v_pk_add_f32 v[208:209], v[208:209], 1.0 op_sel_hi:[1,0]
    v_pk_add_f32 v[210:211], v[210:211], 1.0 op_sel_hi:[1,0]
    v_pk_add_f32 v[212:213], v[212:213], 1.0 op_sel_hi:[1,0]
    v_pk_add_f32 v[214:215], v[214:215], 1.0 op_sel_hi:[1,0]
    v_rcp_f32 v208, v208
    v_rcp_f32 v209, v209
    v_rcp_f32 v210, v210
    v_rcp_f32 v211, v211
    v_rcp_f32 v212, v212
    v_rcp_f32 v213, v213
    v_rcp_f32 v214, v214
    v_rcp_f32 v215, v215
    v_pk_mul_f32 v[56:57], v[56:57], v[208:209]
    v_pk_mul_f32 v[58:59], v[58:59], v[210:211]
    v_pk_mul_f32 v[60:61], v[60:61], v[212:213]
    v_pk_mul_f32 v[62:63], v[62:63], v[214:215]
    v_pk_fma_f32 v[208:209], v[244:245], v[144:145], v[148:149] op_sel:[1,0,0] op_sel_hi:[1,1,1]
    v_pk_fma_f32 v[210:211], v[244:245], v[146:147], v[150:151] op_sel:[1,0,0] op_sel_hi:[1,1,1]
    v_pk_fma_f32 v[212:213], v[246:247], v[144:145], v[148:149] op_sel:[1,0,0] op_sel_hi:[1,1,1]
    v_pk_fma_f32 v[214:215], v[246:247], v[146:147], v[150:151] op_sel:[1,0,0] op_sel_hi:[1,1,1]
    v_pk_fma_f32 v[64:65], v[64:65], v[244:245], v[208:209] op_sel_hi:[1,0,1]
    v_pk_fma_f32 v[66:67], v[66:67], v[244:245], v[210:211] op_sel_hi:[1,0,1]
    v_pk_fma_f32 v[68:69], v[68:69], v[246:247], v[212:213] op_sel_hi:[1,0,1]
    v_pk_fma_f32 v[70:71], v[70:71], v[246:247], v[214:215] op_sel_hi:[1,0,1]
    v_pk_mul_f32 v[208:209], v[64:65], v[64:65]
    v_pk_mul_f32 v[210:211], v[66:67], v[66:67]
    v_pk_mul_f32 v[212:213], v[68:69], v[68:69]
    v_pk_mul_f32 v[214:215], v[70:71], v[70:71]
    v_pk_fma_f32 v[208:209], v[208:209], s[56:57], v[14:15]
    v_pk_fma_f32 v[210:211], v[210:211], s[56:57], v[14:15]
    v_pk_fma_f32 v[212:213], v[212:213], s[56:57], v[14:15]
    v_pk_fma_f32 v[214:215], v[214:215], s[56:57], v[14:15]
    v_pk_mul_f32 v[208:209], v[208:209], v[64:65]
    v_pk_mul_f32 v[210:211], v[210:211], v[66:67]
    v_pk_mul_f32 v[212:213], v[212:213], v[68:69]
    v_pk_mul_f32 v[214:215], v[214:215], v[70:71]
    v_exp_f32 v208, v208
    v_exp_f32 v209, v209
    v_exp_f32 v210, v210
    v_exp_f32 v211, v211
    v_exp_f32 v212, v212
    v_exp_f32 v213, v213
    v_exp_f32 v214, v214
    v_exp_f32 v215, v215
    v_pk_add_f32 v[208:209], v[208:209], 1.0 op_sel_hi:[1,0]
    v_pk_add_f32 v[210:211], v[210:211], 1.0 op_sel_hi:[1,0]
    v_pk_add_f32 v[212:213], v[212:213], 1.0 op_sel_hi:[1,0]
    v_pk_add_f32 v[214:215], v[214:215], 1.0 op_sel_hi:[1,0]
    v_rcp_f32 v208, v208
    v_rcp_f32 v209, v209
    v_rcp_f32 v210, v210
    v_rcp_f32 v211, v211
    v_rcp_f32 v212, v212
    v_rcp_f32 v213, v213
    v_rcp_f32 v214, v214
    v_rcp_f32 v215, v215
    v_pk_mul_f32 v[64:65], v[64:65], v[208:209]
    v_pk_mul_f32 v[66:67], v[66:67], v[210:211]
    v_pk_mul_f32 v[68:69], v[68:69], v[212:213]
    v_pk_mul_f32 v[70:71], v[70:71], v[214:215]
    s_lshl_b32 s52, s41, 2
    s_add_u32 s52, s52, s43
    s_lshl_b32 s53, 1, s40
    v_mov_b32 v12, 140040
    v_mov_b32 v13, 1
    s_mov_b64 exec, 1
    s_waitcnt lgkmcnt(0)
    ds_add_u32 v12, v13
    s_mov_b64 exec, -1
    s_lshl_b32 s46, s52, 7
    s_add_u32 s46, s46, 1597440
    v_mov_b32 v2, s53
    s_mov_b64 exec, 1
    s_waitcnt vmcnt(0)
    buffer_atomic_add v2, off, s[4:7], s46 sc1
    s_mov_b64 exec, -1
    v_lshlrev_b32 v10, 16, v10
    v_lshlrev_b32 v11, 16, v11
    v_pk_mul_f32 v[72:73], v[10:11], 1.0 op_sel:[0,0] op_sel_hi:[0,0]
    v_pk_mul_f32 v[74:75], v[10:11], 1.0 op_sel:[0,0] op_sel_hi:[0,0]
    v_pk_mul_f32 v[76:77], v[10:11], 1.0 op_sel:[1,0] op_sel_hi:[1,0]
    v_pk_mul_f32 v[78:79], v[10:11], 1.0 op_sel:[1,0] op_sel_hi:[1,0]
    v_pk_mul_f32 v[80:81], v[10:11], 1.0 op_sel:[0,0] op_sel_hi:[0,0]
    v_pk_mul_f32 v[82:83], v[10:11], 1.0 op_sel:[0,0] op_sel_hi:[0,0]
    v_pk_mul_f32 v[84:85], v[10:11], 1.0 op_sel:[1,0] op_sel_hi:[1,0]
    v_pk_mul_f32 v[86:87], v[10:11], 1.0 op_sel:[1,0] op_sel_hi:[1,0]
    v_pk_mul_f32 v[88:89], v[10:11], 1.0 op_sel:[0,0] op_sel_hi:[0,0]
    v_pk_mul_f32 v[90:91], v[10:11], 1.0 op_sel:[0,0] op_sel_hi:[0,0]
    v_pk_mul_f32 v[92:93], v[10:11], 1.0 op_sel:[1,0] op_sel_hi:[1,0]
    v_pk_mul_f32 v[94:95], v[10:11], 1.0 op_sel:[1,0] op_sel_hi:[1,0]
    v_pk_mul_f32 v[96:97], v[10:11], 1.0 op_sel:[0,0] op_sel_hi:[0,0]
    v_pk_mul_f32 v[98:99], v[10:11], 1.0 op_sel:[0,0] op_sel_hi:[0,0]
    v_pk_mul_f32 v[100:101], v[10:11], 1.0 op_sel:[1,0] op_sel_hi:[1,0]
    v_pk_mul_f32 v[102:103], v[10:11], 1.0 op_sel:[1,0] op_sel_hi:[1,0]
    v_pk_mul_f32 v[104:105], v[10:11], 1.0 op_sel:[0,0] op_sel_hi:[0,0]
    v_pk_mul_f32 v[106:107], v[10:11], 1.0 op_sel:[0,0] op_sel_hi:[0,0]
    v_pk_mul_f32 v[108:109], v[10:11], 1.0 op_sel:[1,0] op_sel_hi:[1,0]
    v_pk_mul_f32 v[110:111], v[10:11], 1.0 op_sel:[1,0] op_sel_hi:[1,0]
    v_pk_mul_f32 v[112:113], v[10:11], 1.0 op_sel:[0,0] op_sel_hi:[0,0]
    v_pk_mul_f32 v[114:115], v[10:11], 1.0 op_sel:[0,0] op_sel_hi:[0,0]
    v_pk_mul_f32 v[116:117], v[10:11], 1.0 op_sel:[1,0] op_sel_hi:[1,0]
    v_pk_mul_f32 v[118:119], v[10:11], 1.0 op_sel:[1,0] op_sel_hi:[1,0]
    v_pk_mul_f32 v[120:121], v[10:11], 1.0 op_sel:[0,0] op_sel_hi:[0,0]
    v_pk_mul_f32 v[122:123], v[10:11], 1.0 op_sel:[0,0] op_sel_hi:[0,0]
    v_pk_mul_f32 v[124:125], v[10:11], 1.0 op_sel:[1,0] op_sel_hi:[1,0]
    v_pk_mul_f32 v[126:127], v[10:11], 1.0 op_sel:[1,0] op_sel_hi:[1,0]
    v_mov_b32 v12, 140040
    s_mov_b32 s47, 2097152
adaLN_cond__grouped_kv_mqa__mixer_gmlp__prompt_kernel_lsz:
    ds_read_b32 v13, v12
    s_sub_u32 s47, s47, 1
    s_waitcnt lgkmcnt(0)
    v_cmp_gt_u32 vcc, 4, v13
    s_cmp_eq_u32 s47, 0
    s_cbranch_scc1 adaLN_cond__grouped_kv_mqa__mixer_gmlp__prompt_kernel_lsz_x
    s_cbranch_vccnz adaLN_cond__grouped_kv_mqa__mixer_gmlp__prompt_kernel_lsz
adaLN_cond__grouped_kv_mqa__mixer_gmlp__prompt_kernel_lsz_x:
    ds_read_b128 v[128:131], v3 offset:0
    ds_read_b128 v[132:135], v3 offset:7168
    ds_read_b128 v[136:139], v3 offset:1024
    ds_read_b128 v[140:143], v3 offset:8192
    ds_read_b128 v[144:147], v3 offset:2048
    ds_read_b128 v[148:151], v3 offset:9216
.p2align 6
adaLN_cond__grouped_kv_mqa__mixer_gmlp__prompt_kernel_l6:
    s_waitcnt vmcnt(8) lgkmcnt(4)
    v_mfma_f32_16x16x32_bf16 v[72:75], v[128:131], v[160:163], v[72:75]
    ds_read_b128 v[152:155], v3 offset:3072
    v_mfma_f32_16x16x32_bf16 v[72:75], v[132:135], v[164:167], v[72:75]
    buffer_load_dwordx4 v[208:211], v4, s[96:99], s50 offen offset:0 sc1
    v_mfma_f32_16x16x32_bf16 v[76:79], v[132:135], v[172:175], v[76:79]
    ds_read_b128 v[156:159], v3 offset:10240
    v_mfma_f32_16x16x32_bf16 v[76:79], v[128:131], v[168:171], v[76:79]
    s_waitcnt lgkmcnt(4)
    v_mfma_f32_16x16x32_bf16 v[84:87], v[136:139], v[168:171], v[84:87]
    ds_read_b128 v[128:131], v3 offset:4096
    v_mfma_f32_16x16x32_bf16 v[84:87], v[140:143], v[172:175], v[84:87]
    buffer_load_dwordx4 v[212:215], v4, s[96:99], s50 offen offset:2048 sc1
    v_mfma_f32_16x16x32_bf16 v[80:83], v[140:143], v[164:167], v[80:83]
    ds_read_b128 v[132:135], v3 offset:11264
    v_mfma_f32_16x16x32_bf16 v[80:83], v[136:139], v[160:163], v[80:83]
    s_waitcnt lgkmcnt(4)
    v_mfma_f32_16x16x32_bf16 v[88:91], v[144:147], v[160:163], v[88:91]
    ds_read_b128 v[136:139], v3 offset:5120
    v_mfma_f32_16x16x32_bf16 v[88:91], v[148:151], v[164:167], v[88:91]
    buffer_load_dwordx4 v[216:219], v4, s[96:99], s50 offen offset:256 sc1
    v_mfma_f32_16x16x32_bf16 v[92:95], v[148:151], v[172:175], v[92:95]
    ds_read_b128 v[140:143], v3 offset:12288
    v_mfma_f32_16x16x32_bf16 v[92:95], v[144:147], v[168:171], v[92:95]
    s_waitcnt lgkmcnt(4)
    v_mfma_f32_16x16x32_bf16 v[100:103], v[152:155], v[168:171], v[100:103]
    ds_read_b128 v[144:147], v3 offset:6144
    v_mfma_f32_16x16x32_bf16 v[100:103], v[156:159], v[172:175], v[100:103]
    buffer_load_dwordx4 v[220:223], v4, s[96:99], s50 offen offset:2304 sc1
    v_mfma_f32_16x16x32_bf16 v[96:99], v[156:159], v[164:167], v[96:99]
    ds_read_b128 v[148:151], v3 offset:13312
    v_mfma_f32_16x16x32_bf16 v[96:99], v[152:155], v[160:163], v[96:99]
    s_waitcnt lgkmcnt(4)
    v_mfma_f32_16x16x32_bf16 v[104:107], v[128:131], v[160:163], v[104:107]
    ds_read_b128 v[152:155], v3 offset:14336
    v_mfma_f32_16x16x32_bf16 v[104:107], v[132:135], v[164:167], v[104:107]
    v_mfma_f32_16x16x32_bf16 v[108:111], v[132:135], v[172:175], v[108:111]
    ds_read_b128 v[156:159], v3 offset:21504
    v_mfma_f32_16x16x32_bf16 v[108:111], v[128:131], v[168:171], v[108:111]
    s_waitcnt lgkmcnt(4)
    v_mfma_f32_16x16x32_bf16 v[116:119], v[136:139], v[168:171], v[116:119]
    ds_read_b128 v[128:131], v3 offset:15360
    v_mfma_f32_16x16x32_bf16 v[116:119], v[140:143], v[172:175], v[116:119]
    v_mfma_f32_16x16x32_bf16 v[112:115], v[140:143], v[164:167], v[112:115]
    ds_read_b128 v[132:135], v3 offset:22528
    v_mfma_f32_16x16x32_bf16 v[112:115], v[136:139], v[160:163], v[112:115]
    s_waitcnt lgkmcnt(4)
    v_mfma_f32_16x16x32_bf16 v[120:123], v[144:147], v[160:163], v[120:123]
    ds_read_b128 v[136:139], v3 offset:16384
    v_mfma_f32_16x16x32_bf16 v[120:123], v[148:151], v[164:167], v[120:123]
    v_mfma_f32_16x16x32_bf16 v[124:127], v[148:151], v[172:175], v[124:127]
    ds_read_b128 v[140:143], v3 offset:23552
    v_mfma_f32_16x16x32_bf16 v[124:127], v[144:147], v[168:171], v[124:127]
    s_waitcnt vmcnt(8) lgkmcnt(4)
    v_mfma_f32_16x16x32_bf16 v[76:79], v[152:155], v[184:187], v[76:79]
    ds_read_b128 v[144:147], v3 offset:17408
    s_and_b32 s50, s58, 15
    s_lshl_b32 s50, s50, 13
    s_lshr_b64 s[58:59], s[58:59], 4
    v_mfma_f32_16x16x32_bf16 v[76:79], v[156:159], v[188:191], v[76:79]
    buffer_load_dwordx4 v[160:163], v4, s[96:99], s50 offen offset:0 sc1
    v_mfma_f32_16x16x32_bf16 v[72:75], v[156:159], v[180:183], v[72:75]
    ds_read_b128 v[148:151], v3 offset:24576
    v_mfma_f32_16x16x32_bf16 v[72:75], v[152:155], v[176:179], v[72:75]
    s_waitcnt lgkmcnt(4)
    v_mfma_f32_16x16x32_bf16 v[80:83], v[128:131], v[176:179], v[80:83]
    ds_read_b128 v[152:155], v3 offset:18432
    v_mfma_f32_16x16x32_bf16 v[80:83], v[132:135], v[180:183], v[80:83]
    buffer_load_dwordx4 v[164:167], v4, s[96:99], s50 offen offset:2048 sc1
    v_mfma_f32_16x16x32_bf16 v[84:87], v[132:135], v[188:191], v[84:87]
    ds_read_b128 v[156:159], v3 offset:25600
    v_mfma_f32_16x16x32_bf16 v[84:87], v[128:131], v[184:187], v[84:87]
    s_waitcnt lgkmcnt(4)
    v_mfma_f32_16x16x32_bf16 v[92:95], v[136:139], v[184:187], v[92:95]
    ds_read_b128 v[128:131], v3 offset:19456
    v_mfma_f32_16x16x32_bf16 v[92:95], v[140:143], v[188:191], v[92:95]
    buffer_load_dwordx4 v[168:171], v4, s[96:99], s50 offen offset:256 sc1
    v_mfma_f32_16x16x32_bf16 v[88:91], v[140:143], v[180:183], v[88:91]
    ds_read_b128 v[132:135], v3 offset:26624
    v_mfma_f32_16x16x32_bf16 v[88:91], v[136:139], v[176:179], v[88:91]
    s_waitcnt lgkmcnt(4)
    v_mfma_f32_16x16x32_bf16 v[96:99], v[144:147], v[176:179], v[96:99]
    ds_read_b128 v[136:139], v3 offset:20480
    v_mfma_f32_16x16x32_bf16 v[96:99], v[148:151], v[180:183], v[96:99]
    buffer_load_dwordx4 v[172:175], v4, s[96:99], s50 offen offset:2304 sc1
    v_mfma_f32_16x16x32_bf16 v[100:103], v[148:151], v[188:191], v[100:103]
    ds_read_b128 v[140:143], v3 offset:27648
    s_add_u32 s50, s50, 4096
    v_mfma_f32_16x16x32_bf16 v[100:103], v[144:147], v[184:187], v[100:103]
    s_barrier
    s_waitcnt lgkmcnt(4)
    v_mfma_f32_16x16x32_bf16 v[108:111], v[152:155], v[184:187], v[108:111]
    ds_read_b128 v[144:147], v3 offset:28672
    v_mfma_f32_16x16x32_bf16 v[108:111], v[156:159], v[188:191], v[108:111]
    v_mfma_f32_16x16x32_bf16 v[104:107], v[156:159], v[180:183], v[104:107]
    ds_read_b128 v[148:151], v3 offset:35840
    v_mfma_f32_16x16x32_bf16 v[104:107], v[152:155], v[176:179], v[104:107]
    s_waitcnt lgkmcnt(4)
    v_mfma_f32_16x16x32_bf16 v[112:115], v[128:131], v[176:179], v[112:115]
    ds_read_b128 v[152:155], v3 offset:29696
    v_mfma_f32_16x16x32_bf16 v[112:115], v[132:135], v[180:183], v[112:115]
    v_mfma_f32_16x16x32_bf16 v[116:119], v[132:135], v[188:191], v[116:119]
    ds_read_b128 v[156:159], v3 offset:36864
    v_mfma_f32_16x16x32_bf16 v[116:119], v[128:131], v[184:187], v[116:119]
    s_waitcnt lgkmcnt(4)
    v_mfma_f32_16x16x32_bf16 v[124:127], v[136:139], v[184:187], v[124:127]
    ds_read_b128 v[128:131], v3 offset:30720
    v_mfma_f32_16x16x32_bf16 v[124:127], v[140:143], v[188:191], v[124:127]
    v_mfma_f32_16x16x32_bf16 v[120:123], v[140:143], v[180:183], v[120:123]
    ds_read_b128 v[132:135], v3 offset:37888
    v_mfma_f32_16x16x32_bf16 v[120:123], v[136:139], v[176:179], v[120:123]
    s_waitcnt vmcnt(8) lgkmcnt(4)
    v_mfma_f32_16x16x32_bf16 v[72:75], v[144:147], v[192:195], v[72:75]
    ds_read_b128 v[136:139], v3 offset:31744
    v_mfma_f32_16x16x32_bf16 v[72:75], v[148:151], v[196:199], v[72:75]
    buffer_load_dwordx4 v[176:179], v4, s[96:99], s50 offen offset:0 sc1
    v_mfma_f32_16x16x32_bf16 v[76:79], v[148:151], v[204:207], v[76:79]
    ds_read_b128 v[140:143], v3 offset:38912
    v_mfma_f32_16x16x32_bf16 v[76:79], v[144:147], v[200:203], v[76:79]
    s_waitcnt lgkmcnt(4)
    v_mfma_f32_16x16x32_bf16 v[84:87], v[152:155], v[200:203], v[84:87]
    ds_read_b128 v[144:147], v3 offset:32768
    v_mfma_f32_16x16x32_bf16 v[84:87], v[156:159], v[204:207], v[84:87]
    buffer_load_dwordx4 v[180:183], v4, s[96:99], s50 offen offset:2048 sc1
    v_mfma_f32_16x16x32_bf16 v[80:83], v[156:159], v[196:199], v[80:83]
    ds_read_b128 v[148:151], v3 offset:39936
    v_mfma_f32_16x16x32_bf16 v[80:83], v[152:155], v[192:195], v[80:83]
    s_waitcnt lgkmcnt(4)
    v_mfma_f32_16x16x32_bf16 v[88:91], v[128:131], v[192:195], v[88:91]
    ds_read_b128 v[152:155], v3 offset:33792
    v_mfma_f32_16x16x32_bf16 v[88:91], v[132:135], v[196:199], v[88:91]
    buffer_load_dwordx4 v[184:187], v4, s[96:99], s50 offen offset:256 sc1
    v_mfma_f32_16x16x32_bf16 v[92:95], v[132:135], v[204:207], v[92:95]
    ds_read_b128 v[156:159], v3 offset:40960
    v_mfma_f32_16x16x32_bf16 v[92:95], v[128:131], v[200:203], v[92:95]
    s_waitcnt lgkmcnt(4)
    v_mfma_f32_16x16x32_bf16 v[100:103], v[136:139], v[200:203], v[100:103]
    ds_read_b128 v[128:131], v3 offset:34816
    v_mfma_f32_16x16x32_bf16 v[100:103], v[140:143], v[204:207], v[100:103]
    buffer_load_dwordx4 v[188:191], v4, s[96:99], s50 offen offset:2304 sc1
    v_mfma_f32_16x16x32_bf16 v[96:99], v[140:143], v[196:199], v[96:99]
    ds_read_b128 v[132:135], v3 offset:41984
    v_mfma_f32_16x16x32_bf16 v[96:99], v[136:139], v[192:195], v[96:99]
    s_waitcnt lgkmcnt(4)
    v_mfma_f32_16x16x32_bf16 v[104:107], v[144:147], v[192:195], v[104:107]
    ds_read_b128 v[136:139], v3 offset:43008
    v_mfma_f32_16x16x32_bf16 v[104:107], v[148:151], v[196:199], v[104:107]
    v_mfma_f32_16x16x32_bf16 v[108:111], v[148:151], v[204:207], v[108:111]
    ds_read_b128 v[140:143], v3 offset:50176
    v_mfma_f32_16x16x32_bf16 v[108:111], v[144:147], v[200:203], v[108:111]
    s_waitcnt lgkmcnt(4)
    v_mfma_f32_16x16x32_bf16 v[116:119], v[152:155], v[200:203], v[116:119]
    ds_read_b128 v[144:147], v3 offset:44032
    v_mfma_f32_16x16x32_bf16 v[116:119], v[156:159], v[204:207], v[116:119]
    v_mfma_f32_16x16x32_bf16 v[112:115], v[156:159], v[196:199], v[112:115]
    ds_read_b128 v[148:151], v3 offset:51200
    v_mfma_f32_16x16x32_bf16 v[112:115], v[152:155], v[192:195], v[112:115]
    s_waitcnt lgkmcnt(4)
    v_mfma_f32_16x16x32_bf16 v[120:123], v[128:131], v[192:195], v[120:123]
    ds_read_b128 v[152:155], v3 offset:45056
    v_mfma_f32_16x16x32_bf16 v[120:123], v[132:135], v[196:199], v[120:123]
    v_mfma_f32_16x16x32_bf16 v[124:127], v[132:135], v[204:207], v[124:127]
    ds_read_b128 v[156:159], v3 offset:52224
    v_mfma_f32_16x16x32_bf16 v[124:127], v[128:131], v[200:203], v[124:127]
    s_waitcnt vmcnt(8) lgkmcnt(4)
    v_mfma_f32_16x16x32_bf16 v[76:79], v[136:139], v[216:219], v[76:79]
    ds_read_b128 v[128:131], v3 offset:46080
    s_and_b32 s50, s58, 15
    s_lshl_b32 s50, s50, 13
    s_lshr_b64 s[58:59], s[58:59], 4
    v_mfma_f32_16x16x32_bf16 v[76:79], v[140:143], v[220:223], v[76:79]
    buffer_load_dwordx4 v[192:195], v4, s[96:99], s50 offen offset:0 sc1
    v_mfma_f32_16x16x32_bf16 v[72:75], v[140:143], v[212:215], v[72:75]
    ds_read_b128 v[132:135], v3 offset:53248
    v_mfma_f32_16x16x32_bf16 v[72:75], v[136:139], v[208:211], v[72:75]
    s_waitcnt lgkmcnt(4)
    v_mfma_f32_16x16x32_bf16 v[80:83], v[144:147], v[208:211], v[80:83]
    ds_read_b128 v[136:139], v3 offset:47104
    v_mfma_f32_16x16x32_bf16 v[80:83], v[148:151], v[212:215], v[80:83]
    buffer_load_dwordx4 v[196:199], v4, s[96:99], s50 offen offset:2048 sc1
    v_mfma_f32_16x16x32_bf16 v[84:87], v[148:151], v[220:223], v[84:87]
    ds_read_b128 v[140:143], v3 offset:54272
    v_mfma_f32_16x16x32_bf16 v[84:87], v[144:147], v[216:219], v[84:87]
    s_waitcnt lgkmcnt(4)
    v_mfma_f32_16x16x32_bf16 v[92:95], v[152:155], v[216:219], v[92:95]
    ds_read_b128 v[144:147], v3 offset:48128
    v_mfma_f32_16x16x32_bf16 v[92:95], v[156:159], v[220:223], v[92:95]
    buffer_load_dwordx4 v[200:203], v4, s[96:99], s50 offen offset:256 sc1
    v_mfma_f32_16x16x32_bf16 v[88:91], v[156:159], v[212:215], v[88:91]
    ds_read_b128 v[148:151], v3 offset:55296
    v_mfma_f32_16x16x32_bf16 v[88:91], v[152:155], v[208:211], v[88:91]
    s_waitcnt lgkmcnt(4)
    v_mfma_f32_16x16x32_bf16 v[96:99], v[128:131], v[208:211], v[96:99]
    ds_read_b128 v[152:155], v3 offset:49152
    v_mfma_f32_16x16x32_bf16 v[96:99], v[132:135], v[212:215], v[96:99]
    buffer_load_dwordx4 v[204:207], v4, s[96:99], s50 offen offset:2304 sc1
    v_mfma_f32_16x16x32_bf16 v[100:103], v[132:135], v[220:223], v[100:103]
    ds_read_b128 v[156:159], v3 offset:56320
    s_add_u32 s50, s50, 4096
    v_mfma_f32_16x16x32_bf16 v[100:103], v[128:131], v[216:219], v[100:103]
    s_barrier
    s_waitcnt lgkmcnt(4)
    v_mfma_f32_16x16x32_bf16 v[108:111], v[136:139], v[216:219], v[108:111]
    ds_read_b128 v[128:131], v3 offset:57344
    v_mfma_f32_16x16x32_bf16 v[108:111], v[140:143], v[220:223], v[108:111]
    v_mfma_f32_16x16x32_bf16 v[104:107], v[140:143], v[212:215], v[104:107]
    ds_read_b128 v[132:135], v3 offset:64512
    v_mfma_f32_16x16x32_bf16 v[104:107], v[136:139], v[208:211], v[104:107]
    s_waitcnt lgkmcnt(4)
    v_mfma_f32_16x16x32_bf16 v[112:115], v[144:147], v[208:211], v[112:115]
    ds_read_b128 v[136:139], v3 offset:58368
    v_mfma_f32_16x16x32_bf16 v[112:115], v[148:151], v[212:215], v[112:115]
    v_mfma_f32_16x16x32_bf16 v[116:119], v[148:151], v[220:223], v[116:119]
    ds_read_b128 v[140:143], v5 offset:0
    v_mfma_f32_16x16x32_bf16 v[116:119], v[144:147], v[216:219], v[116:119]
    s_waitcnt lgkmcnt(4)
    v_mfma_f32_16x16x32_bf16 v[124:127], v[152:155], v[216:219], v[124:127]
    ds_read_b128 v[144:147], v3 offset:59392
    v_mfma_f32_16x16x32_bf16 v[124:127], v[156:159], v[220:223], v[124:127]
    v_mfma_f32_16x16x32_bf16 v[120:123], v[156:159], v[212:215], v[120:123]
    ds_read_b128 v[148:151], v5 offset:1024
    v_mfma_f32_16x16x32_bf16 v[120:123], v[152:155], v[208:211], v[120:123]
    s_waitcnt vmcnt(8) lgkmcnt(4)
    v_mfma_f32_16x16x32_bf16 v[72:75], v[128:131], v[160:163], v[72:75]
    ds_read_b128 v[152:155], v3 offset:60416
    v_mfma_f32_16x16x32_bf16 v[72:75], v[132:135], v[164:167], v[72:75]
    buffer_load_dwordx4 v[208:211], v4, s[96:99], s50 offen offset:0 sc1
    v_mfma_f32_16x16x32_bf16 v[76:79], v[132:135], v[172:175], v[76:79]
    ds_read_b128 v[156:159], v5 offset:2048
    v_mfma_f32_16x16x32_bf16 v[76:79], v[128:131], v[168:171], v[76:79]
    s_waitcnt lgkmcnt(4)
    v_mfma_f32_16x16x32_bf16 v[84:87], v[136:139], v[168:171], v[84:87]
    ds_read_b128 v[128:131], v3 offset:61440
    v_mfma_f32_16x16x32_bf16 v[84:87], v[140:143], v[172:175], v[84:87]
    buffer_load_dwordx4 v[212:215], v4, s[96:99], s50 offen offset:2048 sc1
    v_mfma_f32_16x16x32_bf16 v[80:83], v[140:143], v[164:167], v[80:83]
    ds_read_b128 v[132:135], v5 offset:3072
    v_mfma_f32_16x16x32_bf16 v[80:83], v[136:139], v[160:163], v[80:83]
    s_waitcnt lgkmcnt(4)
    v_mfma_f32_16x16x32_bf16 v[88:91], v[144:147], v[160:163], v[88:91]
    ds_read_b128 v[136:139], v3 offset:62464
    v_mfma_f32_16x16x32_bf16 v[88:91], v[148:151], v[164:167], v[88:91]
    buffer_load_dwordx4 v[216:219], v4, s[96:99], s50 offen offset:256 sc1
    v_mfma_f32_16x16x32_bf16 v[92:95], v[148:151], v[172:175], v[92:95]
    ds_read_b128 v[140:143], v5 offset:4096
    v_mfma_f32_16x16x32_bf16 v[92:95], v[144:147], v[168:171], v[92:95]
    s_waitcnt lgkmcnt(4)
    v_mfma_f32_16x16x32_bf16 v[100:103], v[152:155], v[168:171], v[100:103]
    ds_read_b128 v[144:147], v3 offset:63488
    v_mfma_f32_16x16x32_bf16 v[100:103], v[156:159], v[172:175], v[100:103]
    buffer_load_dwordx4 v[220:223], v4, s[96:99], s50 offen offset:2304 sc1
    v_mfma_f32_16x16x32_bf16 v[96:99], v[156:159], v[164:167], v[96:99]
    ds_read_b128 v[148:151], v5 offset:5120
    v_mfma_f32_16x16x32_bf16 v[96:99], v[152:155], v[160:163], v[96:99]
    s_waitcnt lgkmcnt(4)
    v_mfma_f32_16x16x32_bf16 v[104:107], v[128:131], v[160:163], v[104:107]
    ds_read_b128 v[152:155], v5 offset:6144
    v_mfma_f32_16x16x32_bf16 v[104:107], v[132:135], v[164:167], v[104:107]
    v_mfma_f32_16x16x32_bf16 v[108:111], v[132:135], v[172:175], v[108:111]
    ds_read_b128 v[156:159], v5 offset:13312
    v_mfma_f32_16x16x32_bf16 v[108:111], v[128:131], v[168:171], v[108:111]
    s_waitcnt lgkmcnt(4)
    v_mfma_f32_16x16x32_bf16 v[116:119], v[136:139], v[168:171], v[116:119]
    ds_read_b128 v[128:131], v5 offset:7168
    v_mfma_f32_16x16x32_bf16 v[116:119], v[140:143], v[172:175], v[116:119]
    v_mfma_f32_16x16x32_bf16 v[112:115], v[140:143], v[164:167], v[112:115]
    ds_read_b128 v[132:135], v5 offset:14336
    v_mfma_f32_16x16x32_bf16 v[112:115], v[136:139], v[160:163], v[112:115]
    s_waitcnt lgkmcnt(4)
    v_mfma_f32_16x16x32_bf16 v[120:123], v[144:147], v[160:163], v[120:123]
    ds_read_b128 v[136:139], v5 offset:8192
    v_mfma_f32_16x16x32_bf16 v[120:123], v[148:151], v[164:167], v[120:123]
    v_mfma_f32_16x16x32_bf16 v[124:127], v[148:151], v[172:175], v[124:127]
    ds_read_b128 v[140:143], v5 offset:15360
    v_mfma_f32_16x16x32_bf16 v[124:127], v[144:147], v[168:171], v[124:127]
    s_waitcnt vmcnt(8) lgkmcnt(4)
    v_mfma_f32_16x16x32_bf16 v[76:79], v[152:155], v[184:187], v[76:79]
    ds_read_b128 v[144:147], v5 offset:9216
    s_cmp_eq_u32 s63, 1
    s_cselect_b32 s98, 0, s98
    s_and_b32 s50, s58, 15
    s_lshl_b32 s50, s50, 13
    s_lshr_b64 s[58:59], s[58:59], 4
    v_mfma_f32_16x16x32_bf16 v[76:79], v[156:159], v[188:191], v[76:79]
    buffer_load_dwordx4 v[160:163], v4, s[96:99], s50 offen offset:0 sc1
    v_mfma_f32_16x16x32_bf16 v[72:75], v[156:159], v[180:183], v[72:75]
    ds_read_b128 v[148:151], v5 offset:16384
    v_mfma_f32_16x16x32_bf16 v[72:75], v[152:155], v[176:179], v[72:75]
    s_waitcnt lgkmcnt(4)
    v_mfma_f32_16x16x32_bf16 v[80:83], v[128:131], v[176:179], v[80:83]
    ds_read_b128 v[152:155], v5 offset:10240
    v_mfma_f32_16x16x32_bf16 v[80:83], v[132:135], v[180:183], v[80:83]
    buffer_load_dwordx4 v[164:167], v4, s[96:99], s50 offen offset:2048 sc1
    v_mfma_f32_16x16x32_bf16 v[84:87], v[132:135], v[188:191], v[84:87]
    ds_read_b128 v[156:159], v5 offset:17408
    v_mfma_f32_16x16x32_bf16 v[84:87], v[128:131], v[184:187], v[84:87]
    s_waitcnt lgkmcnt(4)
    v_mfma_f32_16x16x32_bf16 v[92:95], v[136:139], v[184:187], v[92:95]
    ds_read_b128 v[128:131], v5 offset:11264
    v_mfma_f32_16x16x32_bf16 v[92:95], v[140:143], v[188:191], v[92:95]
    buffer_load_dwordx4 v[168:171], v4, s[96:99], s50 offen offset:256 sc1
    v_mfma_f32_16x16x32_bf16 v[88:91], v[140:143], v[180:183], v[88:91]
    ds_read_b128 v[132:135], v5 offset:18432
    v_mfma_f32_16x16x32_bf16 v[88:91], v[136:139], v[176:179], v[88:91]
    s_waitcnt lgkmcnt(4)
    v_mfma_f32_16x16x32_bf16 v[96:99], v[144:147], v[176:179], v[96:99]
    ds_read_b128 v[136:139], v5 offset:12288
    v_mfma_f32_16x16x32_bf16 v[96:99], v[148:151], v[180:183], v[96:99]
    buffer_load_dwordx4 v[172:175], v4, s[96:99], s50 offen offset:2304 sc1
    v_mfma_f32_16x16x32_bf16 v[100:103], v[148:151], v[188:191], v[100:103]
    ds_read_b128 v[140:143], v5 offset:19456
    s_add_u32 s50, s50, 4096
    v_mfma_f32_16x16x32_bf16 v[100:103], v[144:147], v[184:187], v[100:103]
    s_barrier
    s_waitcnt lgkmcnt(4)
    v_mfma_f32_16x16x32_bf16 v[108:111], v[152:155], v[184:187], v[108:111]
    ds_read_b128 v[144:147], v5 offset:20480
    v_mfma_f32_16x16x32_bf16 v[108:111], v[156:159], v[188:191], v[108:111]
    v_mfma_f32_16x16x32_bf16 v[104:107], v[156:159], v[180:183], v[104:107]
    ds_read_b128 v[148:151], v5 offset:27648
    v_mfma_f32_16x16x32_bf16 v[104:107], v[152:155], v[176:179], v[104:107]
    s_waitcnt lgkmcnt(4)
    v_mfma_f32_16x16x32_bf16 v[112:115], v[128:131], v[176:179], v[112:115]
    ds_read_b128 v[152:155], v5 offset:21504
    v_mfma_f32_16x16x32_bf16 v[112:115], v[132:135], v[180:183], v[112:115]
    v_mfma_f32_16x16x32_bf16 v[116:119], v[132:135], v[188:191], v[116:119]
    ds_read_b128 v[156:159], v5 offset:28672
    v_mfma_f32_16x16x32_bf16 v[116:119], v[128:131], v[184:187], v[116:119]
    s_waitcnt lgkmcnt(4)
    v_mfma_f32_16x16x32_bf16 v[124:127], v[136:139], v[184:187], v[124:127]
    ds_read_b128 v[128:131], v5 offset:22528
    v_mfma_f32_16x16x32_bf16 v[124:127], v[140:143], v[188:191], v[124:127]
    v_mfma_f32_16x16x32_bf16 v[120:123], v[140:143], v[180:183], v[120:123]
    ds_read_b128 v[132:135], v5 offset:29696
    v_mfma_f32_16x16x32_bf16 v[120:123], v[136:139], v[176:179], v[120:123]
    s_waitcnt vmcnt(8) lgkmcnt(4)
    v_mfma_f32_16x16x32_bf16 v[72:75], v[144:147], v[192:195], v[72:75]
    ds_read_b128 v[136:139], v5 offset:23552
    v_mfma_f32_16x16x32_bf16 v[72:75], v[148:151], v[196:199], v[72:75]
    buffer_load_dwordx4 v[176:179], v4, s[96:99], s50 offen offset:0 sc1
    v_mfma_f32_16x16x32_bf16 v[76:79], v[148:151], v[204:207], v[76:79]
    ds_read_b128 v[140:143], v5 offset:30720
    v_mfma_f32_16x16x32_bf16 v[76:79], v[144:147], v[200:203], v[76:79]
    s_waitcnt lgkmcnt(4)
    v_mfma_f32_16x16x32_bf16 v[84:87], v[152:155], v[200:203], v[84:87]
    ds_read_b128 v[144:147], v5 offset:24576
    v_mfma_f32_16x16x32_bf16 v[84:87], v[156:159], v[204:207], v[84:87]
    buffer_load_dwordx4 v[180:183], v4, s[96:99], s50 offen offset:2048 sc1
    v_mfma_f32_16x16x32_bf16 v[80:83], v[156:159], v[196:199], v[80:83]
    ds_read_b128 v[148:151], v5 offset:31744
    v_mfma_f32_16x16x32_bf16 v[80:83], v[152:155], v[192:195], v[80:83]
    s_waitcnt lgkmcnt(4)
    v_mfma_f32_16x16x32_bf16 v[88:91], v[128:131], v[192:195], v[88:91]
    ds_read_b128 v[152:155], v5 offset:25600
    v_mfma_f32_16x16x32_bf16 v[88:91], v[132:135], v[196:199], v[88:91]
    buffer_load_dwordx4 v[184:187], v4, s[96:99], s50 offen offset:256 sc1
    v_mfma_f32_16x16x32_bf16 v[92:95], v[132:135], v[204:207], v[92:95]
    ds_read_b128 v[156:159], v5 offset:32768
    v_mfma_f32_16x16x32_bf16 v[92:95], v[128:131], v[200:203], v[92:95]
    s_waitcnt lgkmcnt(4)
    v_mfma_f32_16x16x32_bf16 v[100:103], v[136:139], v[200:203], v[100:103]
    ds_read_b128 v[128:131], v5 offset:26624
    v_mfma_f32_16x16x32_bf16 v[100:103], v[140:143], v[204:207], v[100:103]
    buffer_load_dwordx4 v[188:191], v4, s[96:99], s50 offen offset:2304 sc1
    v_mfma_f32_16x16x32_bf16 v[96:99], v[140:143], v[196:199], v[96:99]
    ds_read_b128 v[132:135], v5 offset:33792
    v_mfma_f32_16x16x32_bf16 v[96:99], v[136:139], v[192:195], v[96:99]
    s_waitcnt lgkmcnt(4)
    v_mfma_f32_16x16x32_bf16 v[104:107], v[144:147], v[192:195], v[104:107]
    ds_read_b128 v[136:139], v5 offset:34816
    v_mfma_f32_16x16x32_bf16 v[104:107], v[148:151], v[196:199], v[104:107]
    v_mfma_f32_16x16x32_bf16 v[108:111], v[148:151], v[204:207], v[108:111]
    ds_read_b128 v[140:143], v5 offset:41984
    v_mfma_f32_16x16x32_bf16 v[108:111], v[144:147], v[200:203], v[108:111]
    s_waitcnt lgkmcnt(4)
    v_mfma_f32_16x16x32_bf16 v[116:119], v[152:155], v[200:203], v[116:119]
    ds_read_b128 v[144:147], v5 offset:35840
    v_mfma_f32_16x16x32_bf16 v[116:119], v[156:159], v[204:207], v[116:119]
    v_mfma_f32_16x16x32_bf16 v[112:115], v[156:159], v[196:199], v[112:115]
    ds_read_b128 v[148:151], v5 offset:43008
    v_mfma_f32_16x16x32_bf16 v[112:115], v[152:155], v[192:195], v[112:115]
    s_waitcnt lgkmcnt(4)
    v_mfma_f32_16x16x32_bf16 v[120:123], v[128:131], v[192:195], v[120:123]
    ds_read_b128 v[152:155], v5 offset:36864
    v_mfma_f32_16x16x32_bf16 v[120:123], v[132:135], v[196:199], v[120:123]
    v_mfma_f32_16x16x32_bf16 v[124:127], v[132:135], v[204:207], v[124:127]
    ds_read_b128 v[156:159], v5 offset:44032
    v_mfma_f32_16x16x32_bf16 v[124:127], v[128:131], v[200:203], v[124:127]
    s_waitcnt vmcnt(8) lgkmcnt(4)
    v_mfma_f32_16x16x32_bf16 v[76:79], v[136:139], v[216:219], v[76:79]
    ds_read_b128 v[128:131], v5 offset:37888
    s_and_b32 s50, s58, 15
    s_lshl_b32 s50, s50, 13
    s_lshr_b64 s[58:59], s[58:59], 4
    v_mfma_f32_16x16x32_bf16 v[76:79], v[140:143], v[220:223], v[76:79]
    buffer_load_dwordx4 v[192:195], v4, s[96:99], s50 offen offset:0 sc1
    v_mfma_f32_16x16x32_bf16 v[72:75], v[140:143], v[212:215], v[72:75]
    ds_read_b128 v[132:135], v5 offset:45056
    v_mfma_f32_16x16x32_bf16 v[72:75], v[136:139], v[208:211], v[72:75]
    s_waitcnt lgkmcnt(4)
    v_mfma_f32_16x16x32_bf16 v[80:83], v[144:147], v[208:211], v[80:83]
    ds_read_b128 v[136:139], v5 offset:38912
    v_mfma_f32_16x16x32_bf16 v[80:83], v[148:151], v[212:215], v[80:83]
    buffer_load_dwordx4 v[196:199], v4, s[96:99], s50 offen offset:2048 sc1
    v_mfma_f32_16x16x32_bf16 v[84:87], v[148:151], v[220:223], v[84:87]
    ds_read_b128 v[140:143], v5 offset:46080
    v_mfma_f32_16x16x32_bf16 v[84:87], v[144:147], v[216:219], v[84:87]
    s_waitcnt lgkmcnt(4)
    v_mfma_f32_16x16x32_bf16 v[92:95], v[152:155], v[216:219], v[92:95]
    ds_read_b128 v[144:147], v5 offset:39936
    v_mfma_f32_16x16x32_bf16 v[92:95], v[156:159], v[220:223], v[92:95]
    buffer_load_dwordx4 v[200:203], v4, s[96:99], s50 offen offset:256 sc1
    v_mfma_f32_16x16x32_bf16 v[88:91], v[156:159], v[212:215], v[88:91]
    ds_read_b128 v[148:151], v5 offset:47104
    v_mfma_f32_16x16x32_bf16 v[88:91], v[152:155], v[208:211], v[88:91]
    s_waitcnt lgkmcnt(4)
    v_mfma_f32_16x16x32_bf16 v[96:99], v[128:131], v[208:211], v[96:99]
    ds_read_b128 v[152:155], v5 offset:40960
    v_mfma_f32_16x16x32_bf16 v[96:99], v[132:135], v[212:215], v[96:99]
    buffer_load_dwordx4 v[204:207], v4, s[96:99], s50 offen offset:2304 sc1
    v_mfma_f32_16x16x32_bf16 v[100:103], v[132:135], v[220:223], v[100:103]
    ds_read_b128 v[156:159], v5 offset:48128
    s_add_u32 s50, s50, 4096
    v_mfma_f32_16x16x32_bf16 v[100:103], v[128:131], v[216:219], v[100:103]
    s_barrier
    s_waitcnt lgkmcnt(4)
    v_mfma_f32_16x16x32_bf16 v[108:111], v[136:139], v[216:219], v[108:111]
    ds_read_b128 v[128:131], v3 offset:0
    v_mfma_f32_16x16x32_bf16 v[108:111], v[140:143], v[220:223], v[108:111]
    v_mfma_f32_16x16x32_bf16 v[104:107], v[140:143], v[212:215], v[104:107]
    ds_read_b128 v[132:135], v3 offset:7168
    v_mfma_f32_16x16x32_bf16 v[104:107], v[136:139], v[208:211], v[104:107]
    s_waitcnt lgkmcnt(4)
    v_mfma_f32_16x16x32_bf16 v[112:115], v[144:147], v[208:211], v[112:115]
    ds_read_b128 v[136:139], v3 offset:1024
    v_mfma_f32_16x16x32_bf16 v[112:115], v[148:151], v[212:215], v[112:115]
    v_mfma_f32_16x16x32_bf16 v[116:119], v[148:151], v[220:223], v[116:119]
    ds_read_b128 v[140:143], v3 offset:8192
    v_mfma_f32_16x16x32_bf16 v[116:119], v[144:147], v[216:219], v[116:119]
    s_waitcnt lgkmcnt(4)
    v_mfma_f32_16x16x32_bf16 v[124:127], v[152:155], v[216:219], v[124:127]
    ds_read_b128 v[144:147], v3 offset:2048
    v_mfma_f32_16x16x32_bf16 v[124:127], v[156:159], v[220:223], v[124:127]
    v_mfma_f32_16x16x32_bf16 v[120:123], v[156:159], v[212:215], v[120:123]
    ds_read_b128 v[148:151], v3 offset:9216
    s_sub_u32 s63, s63, 1
    s_cmp_lg_u32 s63, 0
    v_mfma_f32_16x16x32_bf16 v[120:123], v[152:155], v[208:211], v[120:123]
    s_cbranch_scc1 adaLN_cond__grouped_kv_mqa__mixer_gmlp__prompt_kernel_l6
    s_waitcnt vmcnt(0) lgkmcnt(0)
    s_mul_i32 s52, s44, 114688
    s_mul_i32 s53, s41, 7168
    s_add_u32 s52, s52, s53
    s_add_u32 s52, s52, 31457280
    s_add_u32 s53, s52, 4096
    v_pk_mul_f32 v[72:73], v[72:73], v[16:17]
    v_pk_mul_f32 v[74:75], v[74:75], v[18:19]
    v_pk_mul_f32 v[76:77], v[76:77], v[20:21]
    v_pk_mul_f32 v[78:79], v[78:79], v[22:23]
    v_cvt_pk_bf16_f32 v160, v72, v73
    v_cvt_pk_bf16_f32 v161, v74, v75
    v_cvt_pk_bf16_f32 v162, v76, v77
    v_cvt_pk_bf16_f32 v163, v78, v79
    v_pk_mul_f32 v[80:81], v[80:81], v[24:25]
    v_pk_mul_f32 v[82:83], v[82:83], v[26:27]
    v_pk_mul_f32 v[84:85], v[84:85], v[28:29]
    v_pk_mul_f32 v[86:87], v[86:87], v[30:31]
    v_permlane16_swap_b32 v160, v162
    v_permlane16_swap_b32 v161, v163
    buffer_store_dwordx4 v[160:163], v3, s[4:7], s52 offen offset:0 sc1
    v_cvt_pk_bf16_f32 v164, v80, v81
    v_cvt_pk_bf16_f32 v165, v82, v83
    v_cvt_pk_bf16_f32 v166, v84, v85
    v_cvt_pk_bf16_f32 v167, v86, v87
    v_pk_mul_f32 v[88:89], v[88:89], v[32:33]
    v_pk_mul_f32 v[90:91], v[90:91], v[34:35]
    v_pk_mul_f32 v[92:93], v[92:93], v[36:37]
    v_pk_mul_f32 v[94:95], v[94:95], v[38:39]
    v_permlane16_swap_b32 v164, v166
    v_permlane16_swap_b32 v165, v167
    buffer_store_dwordx4 v[164:167], v3, s[4:7], s52 offen offset:1024 sc1
    v_cvt_pk_bf16_f32 v168, v88, v89
    v_cvt_pk_bf16_f32 v169, v90, v91
    v_cvt_pk_bf16_f32 v170, v92, v93
    v_cvt_pk_bf16_f32 v171, v94, v95
    v_pk_mul_f32 v[96:97], v[96:97], v[40:41]
    v_pk_mul_f32 v[98:99], v[98:99], v[42:43]
    v_pk_mul_f32 v[100:101], v[100:101], v[44:45]
    v_pk_mul_f32 v[102:103], v[102:103], v[46:47]
    v_permlane16_swap_b32 v168, v170
    v_permlane16_swap_b32 v169, v171
    buffer_store_dwordx4 v[168:171], v3, s[4:7], s52 offen offset:2048 sc1
    v_cvt_pk_bf16_f32 v172, v96, v97
    v_cvt_pk_bf16_f32 v173, v98, v99
    v_cvt_pk_bf16_f32 v174, v100, v101
    v_cvt_pk_bf16_f32 v175, v102, v103
    v_pk_mul_f32 v[104:105], v[104:105], v[48:49]
    v_pk_mul_f32 v[106:107], v[106:107], v[50:51]
    v_pk_mul_f32 v[108:109], v[108:109], v[52:53]
    v_pk_mul_f32 v[110:111], v[110:111], v[54:55]
    v_permlane16_swap_b32 v172, v174
    v_permlane16_swap_b32 v173, v175
    buffer_store_dwordx4 v[172:175], v3, s[4:7], s52 offen offset:3072 sc1
    v_cvt_pk_bf16_f32 v176, v104, v105
    v_cvt_pk_bf16_f32 v177, v106, v107
    v_cvt_pk_bf16_f32 v178, v108, v109
    v_cvt_pk_bf16_f32 v179, v110, v111
    v_pk_mul_f32 v[112:113], v[112:113], v[56:57]
    v_pk_mul_f32 v[114:115], v[114:115], v[58:59]
    v_pk_mul_f32 v[116:117], v[116:117], v[60:61]
    v_pk_mul_f32 v[118:119], v[118:119], v[62:63]
    v_permlane16_swap_b32 v176, v178
    v_permlane16_swap_b32 v177, v179
    buffer_store_dwordx4 v[176:179], v3, s[4:7], s53 offen offset:0 sc1
    v_cvt_pk_bf16_f32 v180, v112, v113
    v_cvt_pk_bf16_f32 v181, v114, v115
    v_cvt_pk_bf16_f32 v182, v116, v117
    v_cvt_pk_bf16_f32 v183, v118, v119
    v_pk_mul_f32 v[120:121], v[120:121], v[64:65]
    v_pk_mul_f32 v[122:123], v[122:123], v[66:67]
    v_pk_mul_f32 v[124:125], v[124:125], v[68:69]
    v_pk_mul_f32 v[126:127], v[126:127], v[70:71]
    v_permlane16_swap_b32 v180, v182
    v_permlane16_swap_b32 v181, v183
    buffer_store_dwordx4 v[180:183], v3, s[4:7], s53 offen offset:1024 sc1
    v_cvt_pk_bf16_f32 v184, v120, v121
    v_cvt_pk_bf16_f32 v185, v122, v123
    v_cvt_pk_bf16_f32 v186, v124, v125
    v_cvt_pk_bf16_f32 v187, v126, v127
    s_nop 1
    v_permlane16_swap_b32 v184, v186
    v_permlane16_swap_b32 v185, v187
    buffer_store_dwordx4 v[184:187], v3, s[4:7], s53 offen offset:2048 sc1
    ds_read_b128 v[80:83], v7 offset:512
    ds_read_b128 v[84:87], v7 offset:528
    ds_read_b128 v[88:91], v7 offset:576
    ds_read_b128 v[92:95], v7 offset:592
    ds_read_b128 v[96:99], v7 offset:640
    ds_read_b128 v[100:103], v7 offset:656
    ds_read_b128 v[104:107], v7 offset:704
    ds_read_b128 v[108:111], v7 offset:720
    v_pk_mul_f32 v[16:17], 0, 0
    v_pk_mul_f32 v[18:19], 0, 0
    v_pk_mul_f32 v[20:21], 0, 0
    v_pk_mul_f32 v[22:23], 0, 0
    v_pk_mul_f32 v[24:25], 0, 0
    v_pk_mul_f32 v[26:27], 0, 0
    v_pk_mul_f32 v[28:29], 0, 0
    v_pk_mul_f32 v[30:31], 0, 0
    v_pk_mul_f32 v[32:33], 0, 0
    v_pk_mul_f32 v[34:35], 0, 0
    v_pk_mul_f32 v[36:37], 0, 0
    v_pk_mul_f32 v[38:39], 0, 0
    v_pk_mul_f32 v[40:41], 0, 0
    v_pk_mul_f32 v[42:43], 0, 0
    v_pk_mul_f32 v[44:45], 0, 0
    v_pk_mul_f32 v[46:47], 0, 0
    s_mul_i32 s45, s44, 114688
    s_add_u32 s45, s45, 31457280
    s_add_u32 s96, s92, s45
    s_addc_u32 s97, s93, 0
    s_mov_b32 s98, 114688
    s_mov_b32 s50, 0
    s_mov_b32 s51, 0
    v_mov_b32 v240, v248
    v_mov_b32 v241, v249
    v_mov_b32 v242, v250
    v_mov_b32 v243, v251
    s_mov_b32 s63, 6
    v_lshlrev_b32 v112, 16, v224
    v_and_b32 v113, 0xffff0000, v224
    v_lshlrev_b32 v114, 16, v225
    v_and_b32 v115, 0xffff0000, v225
    v_lshlrev_b32 v116, 16, v226
    v_and_b32 v117, 0xffff0000, v226
    v_lshlrev_b32 v118, 16, v227
    v_and_b32 v119, 0xffff0000, v227
    v_lshlrev_b32 v120, 16, v228
    v_and_b32 v121, 0xffff0000, v228
    v_lshlrev_b32 v122, 16, v229
    v_and_b32 v123, 0xffff0000, v229
    v_lshlrev_b32 v124, 16, v230
    v_and_b32 v125, 0xffff0000, v230
    v_lshlrev_b32 v126, 16, v231
    v_and_b32 v127, 0xffff0000, v231
    v_lshlrev_b32 v128, 16, v232
    v_and_b32 v129, 0xffff0000, v232
    v_lshlrev_b32 v130, 16, v233
    v_and_b32 v131, 0xffff0000, v233
    v_lshlrev_b32 v132, 16, v234
    v_and_b32 v133, 0xffff0000, v234
    v_lshlrev_b32 v134, 16, v235
    v_and_b32 v135, 0xffff0000, v235
    v_lshlrev_b32 v136, 16, v236
    v_and_b32 v137, 0xffff0000, v236
    v_lshlrev_b32 v138, 16, v237
    v_and_b32 v139, 0xffff0000, v237
    v_lshlrev_b32 v140, 16, v238
    v_and_b32 v141, 0xffff0000, v238
    v_lshlrev_b32 v142, 16, v239
    v_and_b32 v143, 0xffff0000, v239
    s_lshl_b32 s47, s43, 12
    s_add_u32 s47, s47, 98304
    v_and_b32 v1, 31, v0
    v_lshrrev_b32 v2, 5, v0
    v_xor_b32 v2, v2, v1
    v_and_b32 v2, 7, v2
    v_lshlrev_b32 v1, 7, v1
    v_add_u32 v1, s47, v1
    v_xor_b32 v12, 0, v2
    v_lshl_add_u32 v8, v12, 4, v1
    v_xor_b32 v12, 2, v2
    v_lshl_add_u32 v9, v12, 4, v1
    v_xor_b32 v12, 4, v2
    v_lshl_add_u32 v10, v12, 4, v1
    v_xor_b32 v12, 6, v2
    v_lshl_add_u32 v11, v12, 4, v1
    v_lshrrev_b32 v1, 3, v0
    v_xor_b32 v2, v0, v1
    v_and_b32 v2, 7, v2
    v_lshlrev_b32 v12, 7, v1
    v_lshl_add_u32 v12, v2, 4, v12
    v_add_u32 v12, s47, v12
    v_and_b32 v13, 12, v1
    v_lshlrev_b32 v13, 1, v13
    v_and_b32 v2, 16, v1
    v_lshrrev_b32 v2, 2, v2
    v_or_b32 v13, v13, v2
    v_and_b32 v2, 3, v1
    v_or_b32 v13, v13, v2
    v_lshlrev_b32 v13, 11, v13
    v_and_b32 v2, 7, v0
    v_lshl_add_u32 v13, v2, 4, v13
    s_mov_b32 s62, 2
    s_lshl_b32 s46, s44, 7
    s_add_u32 s46, s46, 1589248
    v_mov_b32 v2, 1
    s_mov_b64 exec, 1
    s_waitcnt vmcnt(0)
    buffer_atomic_add v2, off, s[4:7], s46 sc1
    s_mov_b64 exec, -1
    s_waitcnt lgkmcnt(0)
    s_barrier
    ds_read_b64_tr_b16 v[48:49], v240 offset:0
    ds_read_b64_tr_b16 v[50:51], v240 offset:512
    ds_read_b64_tr_b16 v[52:53], v240 offset:4096
    ds_read_b64_tr_b16 v[54:55], v240 offset:4608
    ds_read_b64_tr_b16 v[56:57], v241 offset:0
    ds_read_b64_tr_b16 v[58:59], v241 offset:512
    ds_read_b64_tr_b16 v[60:61], v241 offset:4096
    ds_read_b64_tr_b16 v[62:63], v241 offset:4608
    ds_read_b64_tr_b16 v[64:65], v242 offset:0
    ds_read_b64_tr_b16 v[66:67], v242 offset:512
    ds_read_b64_tr_b16 v[68:69], v242 offset:4096
    ds_read_b64_tr_b16 v[70:71], v242 offset:4608
    s_mov_b32 s47, 262144
    s_mov_b64 exec, 1
adaLN_cond__grouped_kv_mqa__mixer_gmlp__prompt_kernel_pu:
    v_mov_b32 v1, 0
    buffer_atomic_add v1, off, s[4:7], s46 sc0 sc1
    s_sub_u32 s47, s47, 1
    s_waitcnt vmcnt(0)
    v_cmp_gt_u32 vcc, 16, v1
    s_cmp_eq_u32 s47, 0
    s_cbranch_scc1 adaLN_cond__grouped_kv_mqa__mixer_gmlp__prompt_kernel_pu_x
    s_cbranch_vccnz adaLN_cond__grouped_kv_mqa__mixer_gmlp__prompt_kernel_pu
adaLN_cond__grouped_kv_mqa__mixer_gmlp__prompt_kernel_pu_x:
    s_mov_b64 exec, -1
    s_branch adaLN_cond__grouped_kv_mqa__mixer_gmlp__prompt_kernel_small
adaLN_cond__grouped_kv_mqa__mixer_gmlp__prompt_kernel_after_wout:
    v_permlane16_swap_b32 v16, v20
    v_permlane16_swap_b32 v17, v21
    v_permlane16_swap_b32 v18, v22
    v_permlane16_swap_b32 v19, v23
    v_pk_fma_f32 v[16:17], v[16:17], v[80:81], v[112:113]
    v_pk_fma_f32 v[18:19], v[18:19], v[82:83], v[114:115]
    v_pk_fma_f32 v[20:21], v[20:21], v[84:85], v[116:117]
    v_pk_fma_f32 v[22:23], v[22:23], v[86:87], v[118:119]
    v_cvt_pk_bf16_f32 v224, v16, v17
    v_cvt_pk_bf16_f32 v225, v18, v19
    v_cvt_pk_bf16_f32 v226, v20, v21
    v_cvt_pk_bf16_f32 v227, v22, v23
    ds_write_b128 v8, v[224:227]
    v_permlane16_swap_b32 v24, v28
    v_permlane16_swap_b32 v25, v29
    v_permlane16_swap_b32 v26, v30
    v_permlane16_swap_b32 v27, v31
    v_pk_fma_f32 v[24:25], v[24:25], v[88:89], v[120:121]
    v_pk_fma_f32 v[26:27], v[26:27], v[90:91], v[122:123]
    v_pk_fma_f32 v[28:29], v[28:29], v[92:93], v[124:125]
    v_pk_fma_f32 v[30:31], v[30:31], v[94:95], v[126:127]
    v_cvt_pk_bf16_f32 v228, v24, v25
    v_cvt_pk_bf16_f32 v229, v26, v27
    v_cvt_pk_bf16_f32 v230, v28, v29
    v_cvt_pk_bf16_f32 v231, v30, v31
    ds_write_b128 v9, v[228:231]
    v_permlane16_swap_b32 v32, v36
    v_permlane16_swap_b32 v33, v37
    v_permlane16_swap_b32 v34, v38
    v_permlane16_swap_b32 v35, v39
    v_pk_fma_f32 v[32:33], v[32:33], v[96:97], v[128:129]
    v_pk_fma_f32 v[34:35], v[34:35], v[98:99], v[130:131]
    v_pk_fma_f32 v[36:37], v[36:37], v[100:101], v[132:133]
    v_pk_fma_f32 v[38:39], v[38:39], v[102:103], v[134:135]
    v_cvt_pk_bf16_f32 v232, v32, v33
    v_cvt_pk_bf16_f32 v233, v34, v35
    v_cvt_pk_bf16_f32 v234, v36, v37
    v_cvt_pk_bf16_f32 v235, v38, v39
    ds_write_b128 v10, v[232:235]
    v_permlane16_swap_b32 v40, v44
    v_permlane16_swap_b32 v41, v45
    v_permlane16_swap_b32 v42, v46
    v_permlane16_swap_b32 v43, v47
    v_pk_fma_f32 v[40:41], v[40:41], v[104:105], v[136:137]
    v_pk_fma_f32 v[42:43], v[42:43], v[106:107], v[138:139]
    v_pk_fma_f32 v[44:45], v[44:45], v[108:109], v[140:141]
    v_pk_fma_f32 v[46:47], v[46:47], v[110:111], v[142:143]
    v_cvt_pk_bf16_f32 v236, v40, v41
    v_cvt_pk_bf16_f32 v237, v42, v43
    v_cvt_pk_bf16_f32 v238, v44, v45
    v_cvt_pk_bf16_f32 v239, v46, v47
    ds_write_b128 v11, v[236:239]
    s_waitcnt lgkmcnt(0)
    ds_read_b128 v[16:19], v12 offset:0
    ds_read_b128 v[20:23], v12 offset:1024
    ds_read_b128 v[24:27], v12 offset:2048
    ds_read_b128 v[28:31], v12 offset:3072
    s_add_u32 s45, s49, 0
    s_waitcnt lgkmcnt(3)
    buffer_store_dwordx4 v[16:19], v13, s[32:35], s45 offen sc1
    s_add_u32 s45, s49, 32768
    s_waitcnt lgkmcnt(2)
    buffer_store_dwordx4 v[20:23], v13, s[32:35], s45 offen sc1
    s_add_u32 s45, s49, 8192
    s_waitcnt lgkmcnt(1)
    buffer_store_dwordx4 v[24:27], v13, s[32:35], s45 offen sc1
    s_add_u32 s45, s49, 40960
    s_waitcnt lgkmcnt(0)
    buffer_store_dwordx4 v[28:31], v13, s[32:35], s45 offen sc1
    s_endpgm
adaLN_cond__grouped_kv_mqa__mixer_gmlp__prompt_kernel_slow:
    s_mov_b32 s58, 1
    v_mov_b32 v8, 0xff800000
    v_mov_b32 v9, 0xff800000
    s_mov_b32 s50, 524288
adaLN_cond__grouped_kv_mqa__mixer_gmlp__prompt_kernel_slow1:
    buffer_load_dwordx4 v[136:139], v3, s[4:7], s50 offen sc1
    buffer_load_dwordx4 v[140:143], v3, s[4:7], s50 offen offset:1024 sc1
    s_waitcnt vmcnt(0)
    v_mfma_f32_32x32x16_bf16 v[64:79], v[136:139], v[48:51], 0
    v_mfma_f32_32x32x16_bf16 v[64:79], v[140:143], v[52:55], v[64:79]
    v_mfma_f32_32x32x16_bf16 v[80:95], v[136:139], v[56:59], 0
    v_mfma_f32_32x32x16_bf16 v[80:95], v[140:143], v[60:63], v[80:95]
    s_nop 15
    v_max3_f32 v8, v64, v65, v8
    v_max3_f32 v8, v66, v67, v8
    v_max3_f32 v8, v68, v69, v8
    v_max3_f32 v8, v70, v71, v8
    v_max3_f32 v8, v72, v73, v8
    v_max3_f32 v8, v74, v75, v8
    v_max3_f32 v8, v76, v77, v8
    v_max3_f32 v8, v78, v79, v8
    v_max3_f32 v9, v80, v81, v9
    v_max3_f32 v9, v82, v83, v9
    v_max3_f32 v9, v84, v85, v9
    v_max3_f32 v9, v86, v87, v9
    v_max3_f32 v9, v88, v89, v9
    v_max3_f32 v9, v90, v91, v9
    v_max3_f32 v9, v92, v93, v9
    v_max3_f32 v9, v94, v95, v9
    s_add_u32 s50, s50, 4096
    s_cmp_lt_u32 s50, 786432
    s_cbranch_scc1 adaLN_cond__grouped_kv_mqa__mixer_gmlp__prompt_kernel_slow1
    v_mov_b32 v10, v8
    s_nop 1
    v_permlane32_swap_b32 v8, v10
    v_max_f32 v8, v8, v10
    v_sub_f32 v160, 0, v8
    v_mov_b32 v96, 0
    v_sub_f32 v161, 0, v8
    v_mov_b32 v97, 0
    v_sub_f32 v162, 0, v8
    v_mov_b32 v98, 0
    v_sub_f32 v163, 0, v8
    v_mov_b32 v99, 0
    v_sub_f32 v164, 0, v8
    v_mov_b32 v100, 0
    v_sub_f32 v165, 0, v8
    v_mov_b32 v101, 0
    v_sub_f32 v166, 0, v8
    v_mov_b32 v102, 0
    v_sub_f32 v167, 0, v8
    v_mov_b32 v103, 0
    v_sub_f32 v168, 0, v8
    v_mov_b32 v104, 0
    v_sub_f32 v169, 0, v8
    v_mov_b32 v105, 0
    v_sub_f32 v170, 0, v8
    v_mov_b32 v106, 0
    v_sub_f32 v171, 0, v8
    v_mov_b32 v107, 0
    v_sub_f32 v172, 0, v8
    v_mov_b32 v108, 0
    v_sub_f32 v173, 0, v8
    v_mov_b32 v109, 0
    v_sub_f32 v174, 0, v8
    v_mov_b32 v110, 0
    v_sub_f32 v175, 0, v8
    v_mov_b32 v111, 0
    v_mov_b32 v128, 0
    v_mov_b32 v129, 0
    v_mov_b32 v130, 0
    v_mov_b32 v131, 0
    v_mov_b32 v10, v9
    s_nop 1
    v_permlane32_swap_b32 v9, v10
    v_max_f32 v9, v9, v10
    v_sub_f32 v176, 0, v9
    v_mov_b32 v112, 0
    v_sub_f32 v177, 0, v9
    v_mov_b32 v113, 0
    v_sub_f32 v178, 0, v9
    v_mov_b32 v114, 0
    v_sub_f32 v179, 0, v9
    v_mov_b32 v115, 0
    v_sub_f32 v180, 0, v9
    v_mov_b32 v116, 0
    v_sub_f32 v181, 0, v9
    v_mov_b32 v117, 0
    v_sub_f32 v182, 0, v9
    v_mov_b32 v118, 0
    v_sub_f32 v183, 0, v9
    v_mov_b32 v119, 0
    v_sub_f32 v184, 0, v9
    v_mov_b32 v120, 0
    v_sub_f32 v185, 0, v9
    v_mov_b32 v121, 0
    v_sub_f32 v186, 0, v9
    v_mov_b32 v122, 0
    v_sub_f32 v187, 0, v9
    v_mov_b32 v123, 0
    v_sub_f32 v188, 0, v9
    v_mov_b32 v124, 0
    v_sub_f32 v189, 0, v9
    v_mov_b32 v125, 0
    v_sub_f32 v190, 0, v9
    v_mov_b32 v126, 0
    v_sub_f32 v191, 0, v9
    v_mov_b32 v127, 0
    v_mov_b32 v132, 0
    v_mov_b32 v133, 0
    v_mov_b32 v134, 0
    v_mov_b32 v135, 0
    s_mov_b32 s50, 524288
adaLN_cond__grouped_kv_mqa__mixer_gmlp__prompt_kernel_slow2:
    buffer_load_dwordx4 v[136:139], v3, s[4:7], s50 offen offset:0 sc1
    buffer_load_dwordx4 v[140:143], v3, s[4:7], s50 offen offset:1024 sc1
    buffer_load_dwordx4 v[144:147], v3, s[4:7], s50 offen offset:2048 sc1
    buffer_load_dwordx4 v[148:151], v3, s[4:7], s50 offen offset:3072 sc1
    s_waitcnt vmcnt(0)
    v_mfma_f32_32x32x16_bf16 v[64:79], v[136:139], v[48:51], v[160:175]
    v_mfma_f32_32x32x16_bf16 v[64:79], v[140:143], v[52:55], v[64:79]
    v_mfma_f32_32x32x16_bf16 v[80:95], v[136:139], v[56:59], v[176:191]
    v_mfma_f32_32x32x16_bf16 v[80:95], v[140:143], v[60:63], v[80:95]
    s_nop 15
    v_exp_f32 v64, v64
    v_exp_f32 v65, v65
    v_exp_f32 v66, v66
    v_exp_f32 v67, v67
    v_exp_f32 v68, v68
    v_exp_f32 v69, v69
    v_exp_f32 v70, v70
    v_exp_f32 v71, v71
    v_exp_f32 v72, v72
    v_exp_f32 v73, v73
    v_exp_f32 v74, v74
    v_exp_f32 v75, v75
    v_exp_f32 v76, v76
    v_exp_f32 v77, v77
    v_exp_f32 v78, v78
    v_exp_f32 v79, v79
    v_exp_f32 v80, v80
    v_exp_f32 v81, v81
    v_exp_f32 v82, v82
    v_exp_f32 v83, v83
    v_exp_f32 v84, v84
    v_exp_f32 v85, v85
    v_exp_f32 v86, v86
    v_exp_f32 v87, v87
    v_exp_f32 v88, v88
    v_exp_f32 v89, v89
    v_exp_f32 v90, v90
    v_exp_f32 v91, v91
    v_exp_f32 v92, v92
    v_exp_f32 v93, v93
    v_exp_f32 v94, v94
    v_exp_f32 v95, v95
    s_nop 1
    v_smfmac_f32_32x32x32_bf16 v[96:111], v[144:147], v[64:71], v156
    v_smfmac_f32_32x32x32_bf16 v[96:111], v[148:151], v[72:79], v156
    v_smfmac_f32_16x16x64_bf16 v[128:131], v[152:155], v[64:71], v156
    v_smfmac_f32_16x16x64_bf16 v[128:131], v[152:155], v[72:79], v156
    v_smfmac_f32_32x32x32_bf16 v[112:127], v[144:147], v[80:87], v156
    v_smfmac_f32_32x32x32_bf16 v[112:127], v[148:151], v[88:95], v156
    v_smfmac_f32_16x16x64_bf16 v[132:135], v[152:155], v[80:87], v156
    v_smfmac_f32_16x16x64_bf16 v[132:135], v[152:155], v[88:95], v156
    s_nop 15
    s_add_u32 s50, s50, 4096
    s_cmp_lt_u32 s50, 786432
    s_cbranch_scc1 adaLN_cond__grouped_kv_mqa__mixer_gmlp__prompt_kernel_slow2
    s_branch adaLN_cond__grouped_kv_mqa__mixer_gmlp__prompt_kernel_norm
adaLN_cond__grouped_kv_mqa__mixer_gmlp__prompt_kernel_helper:
    s_mov_b32 s12, s66
    s_mov_b32 s13, s67
    s_mov_b32 s14, 0x200000
    s_mov_b32 s15, 0x00020000
    v_mov_b32 v8, 140032
    v_pk_mul_f32 v[10:11], 0, 0
    s_mov_b64 exec, 1
    ds_write_b64 v8, v[10:11]
    ds_write_b64 v8, v[10:11] offset:8
    s_mov_b64 exec, -1
    s_cmp_lg_u32 s101, 0
    s_cbranch_scc1 adaLN_cond__grouped_kv_mqa__mixer_gmlp__prompt_kernel_e0
    s_cmp_lg_u32 s43, 0
    s_cbranch_scc1 adaLN_cond__grouped_kv_mqa__mixer_gmlp__prompt_kernel_e1
    s_setprio 3
    v_lshlrev_b32 v8, 2, v0
    v_add_u32 v9, 148480, v8
    v_lshlrev_b32 v11, 14, v0
    s_lshl_b32 s47, s100, 7
    s_add_u32 s47, s47, 1572864
    s_mov_b64 exec, 7
    buffer_store_dword v10, v11, s[4:7], s47 offen sc1
    s_mov_b64 exec, -1
    s_mul_i32 s53, s59, 24576
    s_lshl_b32 s48, s58, 8
    s_add_u32 s53, s53, s48
    s_waitcnt lgkmcnt(0)
    s_barrier
    ds_read_b32 v16, v9 offset:0
    ds_read_b32 v17, v9 offset:256
    ds_read_b32 v18, v9 offset:512
    ds_read_b32 v19, v9 offset:768
    ds_read_b32 v20, v9 offset:1024
    ds_read_b32 v21, v9 offset:1280
    ds_read_b32 v22, v9 offset:1536
    ds_read_b32 v23, v9 offset:1792
    s_mul_i32 s95, s95, 0x9e3779b1
    s_add_u32 s95, s95, 0x7f4a7c15
    s_bfe_u32 s47, s58, 0x20002
    s_lshl_b32 s54, s47, 7
    s_lshr_b32 s47, s58, 4
    s_lshl_b32 s47, s47, 6
    s_add_u32 s54, s54, s47
    s_and_b32 s47, s58, 3
    s_lshl_b32 s47, s47, 4
    s_add_u32 s54, s54, s47
    s_lshl_b32 s47, s59, 2
    s_add_u32 s54, s54, s47
    s_add_u32 s54, s54, 1638400
    s_waitcnt lgkmcnt(0)
    v_pk_add_f32 v[16:17], v[16:17], v[18:19]
    v_pk_add_f32 v[20:21], v[20:21], v[22:23]
    v_pk_add_f32 v[16:17], v[16:17], v[20:21]
    v_add_f32 v16, v16, v17
    buffer_store_dword v16, v8, s[4:7], s53 offen sc1
    s_barrier
    v_lshlrev_b32 v11, 9, v0
    v_mov_b32 v12, s95
    s_mov_b32 exec_hi, 0
    s_waitcnt vmcnt(0)
    buffer_atomic_swap v12, v11, s[4:7], s54 offen sc1
    s_mov_b64 exec, -1
    s_setprio 0
    s_branch adaLN_cond__grouped_kv_mqa__mixer_gmlp__prompt_kernel_e2
adaLN_cond__grouped_kv_mqa__mixer_gmlp__prompt_kernel_e1:
    s_waitcnt lgkmcnt(0)
    s_barrier
    s_barrier
    s_branch adaLN_cond__grouped_kv_mqa__mixer_gmlp__prompt_kernel_e2
adaLN_cond__grouped_kv_mqa__mixer_gmlp__prompt_kernel_e0:
    v_lshlrev_b32 v9, 7, v0
    s_lshl_b32 s54, s100, 14
    s_lshl_b32 s48, s43, 12
    s_add_u32 s54, s54, s48
    s_mov_b32 exec_hi, 0
    buffer_load_dword v222, v9, s[12:15], s54 offen
    s_getpc_b64 s[48:49]
adaLN_cond__grouped_kv_mqa__mixer_gmlp__prompt_kernel_pc:
    s_sub_u32 s48, s48, adaLN_cond__grouped_kv_mqa__mixer_gmlp__prompt_kernel_pc-adaLN_cond__grouped_kv_mqa__mixer_gmlp__prompt_kernel
    s_subb_u32 s49, s49, 0
    s_lshr_b32 s47, s46, 1
    s_lshl_b32 s47, s47, 2
    s_add_u32 s47, s47, s43
    s_lshl_b32 s47, s47, 10
    v_add_u32 v9, s47, v9
    v_min_u32 v9, adaLN_cond__grouped_kv_mqa__mixer_gmlp__prompt_kernel_end-adaLN_cond__grouped_kv_mqa__mixer_gmlp__prompt_kernel, v9
    s_mov_b64 exec, 0xff
    global_load_dword v221, v9, s[48:49]
    s_mov_b64 exec, -1
    s_waitcnt lgkmcnt(0)
    s_barrier
adaLN_cond__grouped_kv_mqa__mixer_gmlp__prompt_kernel_e2:
    s_cmp_eq_u32 s50, 0
    s_cselect_b32 s36, s68, s70
    s_cselect_b32 s37, s69, s71
    s_mov_b32 s38, 65536
    s_mov_b32 s39, 0x00020000
    s_cmp_eq_u32 s101, 0
    s_cbranch_scc1 adaLN_cond__grouped_kv_mqa__mixer_gmlp__prompt_kernel_e4
    s_branch adaLN_cond__grouped_kv_mqa__mixer_gmlp__prompt_kernel_e5
adaLN_cond__grouped_kv_mqa__mixer_gmlp__prompt_kernel_e4:
    v_mov_b32 v12, 140032
    s_mov_b32 s47, 2097152
adaLN_cond__grouped_kv_mqa__mixer_gmlp__prompt_kernel_lsx:
    ds_read_b32 v13, v12
    s_sub_u32 s47, s47, 1
    s_waitcnt lgkmcnt(0)
    v_cmp_gt_u32 vcc, 4, v13
    s_cmp_eq_u32 s47, 0
    s_cbranch_scc1 adaLN_cond__grouped_kv_mqa__mixer_gmlp__prompt_kernel_lsx_x
    s_cbranch_vccnz adaLN_cond__grouped_kv_mqa__mixer_gmlp__prompt_kernel_lsx
adaLN_cond__grouped_kv_mqa__mixer_gmlp__prompt_kernel_lsx_x:
adaLN_cond__grouped_kv_mqa__mixer_gmlp__prompt_kernel_e5:
    s_mov_b32 s16, s72
    s_mov_b32 s17, s73
    s_mov_b32 s18, 0x200000
    s_mov_b32 s19, 0x00020000
    s_mov_b32 s20, s76
    s_mov_b32 s21, s77
    s_mov_b32 s22, 0x700000
    s_mov_b32 s23, 0x00020000
    s_mov_b32 s24, s78
    s_mov_b32 s25, s79
    s_mov_b32 s26, 0x800000
    s_mov_b32 s27, 0x00020000
    s_mov_b32 s28, s82
    s_mov_b32 s29, s83
    s_mov_b32 s30, 0x380000
    s_mov_b32 s31, 0x00020000
    v_lshrrev_b32 v8, 3, v0
    s_mov_b32 s45, 2048
    v_mul_lo_u32 v4, v8, s45
    v_and_b32 v8, 2, v8
    v_and_b32 v9, 7, v0
    v_xor_b32 v8, v8, v9
    v_xor_b32 v9, 4, v8
    v_lshl_add_u32 v5, v9, 4, v4
    v_lshl_add_u32 v4, v8, 4, v4
    v_add_u32 v5, 15360, v5
    v_add_u32 v6, 30720, v4
    v_add_u32 v7, 30720, v5
    s_lshl_b32 s54, s43, 14
    s_add_u32 m0, s54, 65536
    s_add_u32 s45, s54, 0
    buffer_load_dwordx4 v3, s[36:39], s45 offen offset:0 lds
    buffer_load_dwordx4 v3, s[36:39], s45 offen offset:1024 lds
    buffer_load_dwordx4 v3, s[36:39], s45 offen offset:2048 lds
    buffer_load_dwordx4 v3, s[36:39], s45 offen offset:3072 lds
    s_add_u32 m0, s54, 69632
    s_add_u32 s45, s54, 4096
    buffer_load_dwordx4 v3, s[36:39], s45 offen offset:0 lds
    buffer_load_dwordx4 v3, s[36:39], s45 offen offset:1024 lds
    buffer_load_dwordx4 v3, s[36:39], s45 offen offset:2048 lds
    buffer_load_dwordx4 v3, s[36:39], s45 offen offset:3072 lds
    s_waitcnt vmcnt(4)
    s_add_u32 m0, s54, 73728
    s_add_u32 s45, s54, 8192
    buffer_load_dwordx4 v3, s[36:39], s45 offen offset:0 lds
    buffer_load_dwordx4 v3, s[36:39], s45 offen offset:1024 lds
    buffer_load_dwordx4 v3, s[36:39], s45 offen offset:2048 lds
    buffer_load_dwordx4 v3, s[36:39], s45 offen offset:3072 lds
    s_waitcnt vmcnt(4)
    s_add_u32 m0, s54, 77824
    s_add_u32 s45, s54, 12288
    buffer_load_dwordx4 v3, s[36:39], s45 offen offset:0 lds
    buffer_load_dwordx4 v3, s[36:39], s45 offen offset:1024 lds
    buffer_load_dwordx4 v3, s[36:39], s45 offen offset:2048 lds
    buffer_load_dwordx4 v3, s[36:39], s45 offen offset:3072 lds
    s_waitcnt vmcnt(4)
    s_lshl_b32 s53, s43, 16
    s_lshl_b32 s54, s41, 7
    s_add_u32 s53, s53, s54
    s_lshl_b32 s54, s43, 12
    s_add_u32 m0, s54, 0
    s_add_u32 s45, s53, 0
    buffer_load_dwordx4 v4, s[12:15], s45 offen offset:0 lds
    buffer_load_dwordx4 v5, s[12:15], s45 offen offset:1024 lds
    buffer_load_dwordx4 v6, s[12:15], s45 offen offset:2048 lds
    buffer_load_dwordx4 v7, s[12:15], s45 offen offset:3072 lds
    s_waitcnt vmcnt(4)
    v_mov_b32 v12, 140036
    v_mov_b32 v13, 1
    s_mov_b64 exec, 1
    s_waitcnt lgkmcnt(0)
    ds_add_u32 v12, v13
    s_mov_b64 exec, -1
    s_add_u32 m0, s54, 16384
    s_add_u32 s45, s53, 262144
    buffer_load_dwordx4 v4, s[12:15], s45 offen offset:0 lds
    buffer_load_dwordx4 v5, s[12:15], s45 offen offset:1024 lds
    buffer_load_dwordx4 v6, s[12:15], s45 offen offset:2048 lds
    buffer_load_dwordx4 v7, s[12:15], s45 offen offset:3072 lds
    s_waitcnt vmcnt(4)
    s_add_u32 m0, s54, 32768
    s_add_u32 s45, s53, 524288
    buffer_load_dwordx4 v4, s[12:15], s45 offen offset:0 lds
    buffer_load_dwordx4 v5, s[12:15], s45 offen offset:1024 lds
    buffer_load_dwordx4 v6, s[12:15], s45 offen offset:2048 lds
    buffer_load_dwordx4 v7, s[12:15], s45 offen offset:3072 lds
    s_waitcnt vmcnt(4)
    s_add_u32 m0, s54, 49152
    s_add_u32 s45, s53, 786432
    buffer_load_dwordx4 v4, s[12:15], s45 offen offset:0 lds
    buffer_load_dwordx4 v5, s[12:15], s45 offen offset:1024 lds
    buffer_load_dwordx4 v6, s[12:15], s45 offen offset:2048 lds
    buffer_load_dwordx4 v7, s[12:15], s45 offen offset:3072 lds
    s_waitcnt vmcnt(4)
    v_lshlrev_b32 v8, 3, v0
    v_mov_b32 v10, -1
    v_mov_b32 v11, -1
    s_lshl_b32 s47, s2, 11
    s_lshl_b32 s48, s43, 9
    s_add_u32 s47, s47, s48
    s_add_u32 s47, s47, 1048576
    buffer_store_dwordx2 v[10:11], v8, s[4:7], s47 offen sc1
    s_cmp_ge_u32 s2, 2
    s_cbranch_scc1 adaLN_cond__grouped_kv_mqa__mixer_gmlp__prompt_kernel_e3
    v_lshlrev_b32 v8, 2, v0
    s_lshl_b32 s47, s2, 10
    s_lshl_b32 s48, s43, 8
    s_add_u32 s47, s47, s48
    buffer_load_dword v16, v8, s[32:35], s47 offen
    s_add_u32 s47, s47, 172032
    s_waitcnt vmcnt(0)
    v_and_b32 v17, 0xffff0000, v16
    v_lshlrev_b32 v16, 16, v16
    v_mul_f32 v18, 0xbfb8aa3b, v16
    v_mul_f32 v19, 0xbfb8aa3b, v17
    v_exp_f32 v18, v18
    v_exp_f32 v19, v19
    s_nop 0
    v_add_f32 v18, 1.0, v18
    v_add_f32 v19, 1.0, v19
    v_rcp_f32 v18, v18
    v_rcp_f32 v19, v19
    s_nop 0
    v_mul_f32 v16, v16, v18
    v_mul_f32 v17, v17, v19
    v_cvt_pk_bf16_f32 v16, v16, v17
    buffer_store_dword v16, v8, s[4:7], s47 offen sc1
adaLN_cond__grouped_kv_mqa__mixer_gmlp__prompt_kernel_e3:
    s_waitcnt vmcnt(0) lgkmcnt(0)
    s_barrier
    s_cmp_ge_u32 s43, 2
    s_cbranch_scc1 adaLN_cond__grouped_kv_mqa__mixer_gmlp__prompt_kernel_h2
    s_lshl_b32 s47, s43, 10
    s_add_u32 s47, s47, 140288
    v_add_u32 v10, s47, v3
    ds_read_b128 v[48:51], v10 offset:0
    ds_read_b128 v[52:55], v10 offset:2048
    ds_read_b128 v[56:59], v10 offset:4096
    ds_read_b128 v[60:63], v10 offset:6144
    v_lshrrev_b32 v11, 1, v15
    v_and_b32 v12, 1, v15
    v_mov_b32 v9, s43
    s_lshl_b32 s47, s51, 12
    s_add_u32 s47, s47, 524288
    s_cmp_eq_u32 s50, 0
    s_cselect_b32 s54, 0x3e8293ee, 1.0
    s_cbranch_scc0 adaLN_cond__grouped_kv_mqa__mixer_gmlp__prompt_kernel_va
    v_lshl_add_u32 v13, v9, 1, v11
    v_lshlrev_b32 v13, 9, v13
    v_lshl_add_u32 v13, v14, 4, v13
    s_lshl_b32 s48, s52, 8
    s_branch adaLN_cond__grouped_kv_mqa__mixer_gmlp__prompt_kernel_ad
adaLN_cond__grouped_kv_mqa__mixer_gmlp__prompt_kernel_va:
    v_and_b32 v13, 3, v14
    v_bfe_u32 v8, v14, 2, 1
    v_lshl_add_u32 v13, v8, 3, v13
    v_bfe_u32 v8, v14, 3, 1
    v_lshl_add_u32 v13, v8, 2, v13
    v_lshl_add_u32 v13, v9, 4, v13
    v_lshl_add_u32 v13, v11, 5, v13
    v_lshlrev_b32 v13, 4, v13
    s_lshl_b32 s48, s52, 10
    s_add_u32 s48, s48, 2048
adaLN_cond__grouped_kv_mqa__mixer_gmlp__prompt_kernel_ad:
    v_lshl_add_u32 v13, v12, 3, v13
    s_add_u32 s47, s47, s48
    s_waitcnt lgkmcnt(0)
    v_pk_add_f32 v[48:49], v[48:49], v[52:53]
    v_pk_add_f32 v[50:51], v[50:51], v[54:55]
    v_pk_add_f32 v[48:49], v[48:49], v[56:57]
    v_pk_add_f32 v[50:51], v[50:51], v[58:59]
    v_pk_add_f32 v[48:49], v[48:49], v[60:61]
    v_pk_add_f32 v[50:51], v[50:51], v[62:63]
    v_pk_mul_f32 v[48:49], v[48:49], s[54:55] op_sel_hi:[1,0]
    v_pk_mul_f32 v[50:51], v[50:51], s[54:55] op_sel_hi:[1,0]
    v_cvt_pk_bf16_f32 v48, v48, v49
    v_cvt_pk_bf16_f32 v49, v50, v51
    buffer_store_dwordx2 v[48:49], v13, s[4:7], s47 offen sc1
    s_lshl_b32 s48, s40, 1
    s_add_u32 s48, s48, s43
    s_lshl_b32 s46, s48, 7
    s_add_u32 s46, s46, 1613824
    v_mov_b32 v2, 1
    s_mov_b64 exec, 1
    s_waitcnt vmcnt(0)
    buffer_atomic_add v2, off, s[4:7], s46 sc1
    s_mov_b64 exec, -1
adaLN_cond__grouped_kv_mqa__mixer_gmlp__prompt_kernel_h2:
    s_lshl_b32 s51, s43, 16
    s_lshl_b32 s52, s41, 7
    s_add_u32 s51, s51, s52
    s_lshl_b32 s52, s43, 12
    s_mul_i32 s55, s43, 7168
    s_mul_i32 s53, s41, 458752
    s_add_u32 s53, s53, s55
    s_lshl_b32 s56, s43, 13
    s_add_u32 m0, s52, 65536
    s_add_u32 s45, s51, 1048576
    buffer_load_dwordx4 v4, s[12:15], s45 offen offset:0  lds
    buffer_load_dwordx4 v5, s[12:15], s45 offen offset:1024  lds
    buffer_load_dwordx4 v6, s[12:15], s45 offen offset:2048  lds
    buffer_load_dwordx4 v7, s[12:15], s45 offen offset:3072  lds
    s_add_u32 m0, s52, 81920
    s_add_u32 s45, s51, 1310720
    buffer_load_dwordx4 v4, s[12:15], s45 offen offset:0  lds
    buffer_load_dwordx4 v5, s[12:15], s45 offen offset:1024  lds
    buffer_load_dwordx4 v6, s[12:15], s45 offen offset:2048  lds
    buffer_load_dwordx4 v7, s[12:15], s45 offen offset:3072  lds
    s_add_u32 m0, s52, 98304
    s_add_u32 s45, s51, 1572864
    buffer_load_dwordx4 v4, s[12:15], s45 offen offset:0  lds
    buffer_load_dwordx4 v5, s[12:15], s45 offen offset:1024  lds
    buffer_load_dwordx4 v6, s[12:15], s45 offen offset:2048  lds
    buffer_load_dwordx4 v7, s[12:15], s45 offen offset:3072  lds
    s_add_u32 m0, s52, 114688
    s_add_u32 s45, s51, 1835008
    buffer_load_dwordx4 v4, s[12:15], s45 offen offset:0  lds
    buffer_load_dwordx4 v5, s[12:15], s45 offen offset:1024  lds
    buffer_load_dwordx4 v6, s[12:15], s45 offen offset:2048  lds
    buffer_load_dwordx4 v7, s[12:15], s45 offen offset:3072  lds
    v_lshrrev_b32 v8, 3, v0
    s_mov_b32 s45, 7168
    v_mul_lo_u32 v16, v8, s45
    v_and_b32 v8, 2, v8
    v_and_b32 v9, 7, v0
    v_xor_b32 v8, v8, v9
    v_xor_b32 v9, 4, v8
    v_lshl_add_u32 v17, v9, 4, v16
    v_lshl_add_u32 v16, v8, 4, v16
    v_add_u32 v17, 56320, v17
    v_add_u32 v18, 112640, v16
    v_add_u32 v19, 112640, v17
    v_lshrrev_b32 v8, 3, v0
    s_mov_b32 s45, 12288
    v_mul_lo_u32 v28, v8, s45
    v_and_b32 v8, 2, v8
    v_and_b32 v9, 7, v0
    v_xor_b32 v8, v8, v9
    v_xor_b32 v9, 4, v8
    v_lshl_add_u32 v29, v9, 4, v28
    v_lshl_add_u32 v28, v8, 4, v28
    v_add_u32 v29, 97280, v29
    v_add_u32 v30, 194560, v28
    v_add_u32 v31, 194560, v29
    v_lshrrev_b32 v8, 4, v0
    v_bfe_u32 v9, v0, 2, 2
    v_lshl_add_u32 v20, v8, 3, v9
    v_lshlrev_b32 v20, 7, v20
    v_and_b32 v8, 1, v8
    v_lshrrev_b32 v9, 1, v9
    v_lshl_add_u32 v8, v8, 1, v9
    v_and_b32 v9, 3, v0
    v_lshl_add_u32 v20, v9, 3, v20
    v_add_u32 v20, 98304, v20
    v_xor_b32 v9, 3, v8
    v_lshl_add_u32 v23, v9, 5, v20
    v_xor_b32 v9, 2, v8
    v_lshl_add_u32 v22, v9, 5, v20
    v_xor_b32 v9, 1, v8
    v_lshl_add_u32 v21, v9, 5, v20
    v_xor_b32 v9, 0, v8
    v_lshl_add_u32 v20, v9, 5, v20
    s_cmp_eq_u32 s43, 1
    s_cselect_b64 vcc, -1, 0
    v_cndmask_b32 v20, v20, v21, vcc
    s_cmp_eq_u32 s43, 2
    s_cselect_b64 vcc, -1, 0
    v_cndmask_b32 v20, v20, v22, vcc
    s_cmp_eq_u32 s43, 3
    s_cselect_b64 vcc, -1, 0
    v_cndmask_b32 v20, v20, v23, vcc
    v_lshrrev_b32 v8, 3, v0
    v_and_b32 v10, 12, v8
    v_lshlrev_b32 v10, 1, v10
    v_and_b32 v9, 16, v8
    v_lshrrev_b32 v9, 2, v9
    v_or_b32 v10, v10, v9
    v_and_b32 v9, 3, v8
    v_or_b32 v10, v10, v9
    v_lshlrev_b32 v10, 12, v10
    v_and_b32 v9, 7, v0
    v_lshl_add_u32 v10, v9, 4, v10
    v_lshlrev_b32 v11, 9, v9
    v_lshl_add_u32 v11, v8, 4, v11
    v_and_b32 v8, 15, v0
    v_lshrrev_b32 v9, 4, v0
    v_mov_b32 v15, 536870912
    v_lshlrev_b32 v21, 4, v9
    v_cmp_gt_u32 vcc, 2, v8
    v_lshl_add_u32 v22, v8, 11, v21
    v_mul_u32_u24 v23, 14336, v8
    v_add_u32 v23, v23, v21
    v_cndmask_b32 v22, v15, v22, vcc
    v_cndmask_b32 v23, v15, v23, vcc
    v_cmp_eq_u32 vcc, 0, v8
    s_nop 1
    v_cndmask_b32 v21, v15, v21, vcc
    s_barrier
    s_waitcnt vmcnt(8)
    s_barrier
    v_and_b32 v12, 7, v0
    v_lshlrev_b32 v12, 7, v12
    s_mul_i32 s47, s43, 1024
    s_add_u32 s47, s47, 1613824
    v_add_u32 v12, s47, v12
    v_mov_b32 v13, -1
    s_bfm_b64 exec, 8, 0
    buffer_load_dword v13, v12, s[4:7], 0 offen sc1
    s_mov_b64 exec, -1
    s_waitcnt vmcnt(1)
    s_barrier
    s_waitcnt vmcnt(0)
    s_mov_b32 s47, 262144
adaLN_cond__grouped_kv_mqa__mixer_gmlp__prompt_kernel_lkv:
    v_cmp_gt_u32 vcc, 16, v13
    s_sub_u32 s47, s47, 1
    s_cbranch_vccz adaLN_cond__grouped_kv_mqa__mixer_gmlp__prompt_kernel_lkv_x
    s_cmp_eq_u32 s47, 0
    s_cbranch_scc1 adaLN_cond__grouped_kv_mqa__mixer_gmlp__prompt_kernel_lkv_x
    s_mov_b64 exec, vcc
    buffer_load_dword v13, v12, s[4:7], 0 offen sc1
    s_mov_b64 exec, -1
    s_waitcnt vmcnt(0)
    s_branch adaLN_cond__grouped_kv_mqa__mixer_gmlp__prompt_kernel_lkv
adaLN_cond__grouped_kv_mqa__mixer_gmlp__prompt_kernel_lkv_x:
    s_barrier
    s_add_u32 m0, s56, 131072
    s_add_u32 s45, s56, 524288
    buffer_load_dwordx4 v3, s[4:7], s45 offen offset:0 sc1 lds
    buffer_load_dwordx4 v3, s[4:7], s45 offen offset:1024 sc1 lds
    buffer_load_dwordx4 v3, s[4:7], s45 offen offset:2048 sc1 lds
    buffer_load_dwordx4 v3, s[4:7], s45 offen offset:3072 sc1 lds
    s_add_u32 m0, s56, 135168
    s_add_u32 s45, s56, 528384
    buffer_load_dwordx4 v3, s[4:7], s45 offen offset:0 sc1 lds
    buffer_load_dwordx4 v3, s[4:7], s45 offen offset:1024 sc1 lds
    buffer_load_dwordx4 v3, s[4:7], s45 offen offset:2048 sc1 lds
    buffer_load_dwordx4 v3, s[4:7], s45 offen offset:3072 sc1 lds
    s_add_u32 s46, s2, s43
    s_cmp_eq_u32 s46, 0
    s_cselect_b32 s46, 0, 536870912
    s_add_u32 s46, s46, 1703936
    v_mov_b32 v13, s95
    s_mov_b64 exec, 1
    buffer_store_dword v13, off, s[4:7], s46 sc1
    s_mov_b64 exec, -1
    s_waitcnt vmcnt(1)
    s_barrier
    s_setprio 3
    s_add_u32 m0, s56, 0
    s_add_u32 s45, s56, 557056
    buffer_load_dwordx4 v3, s[4:7], s45 offen offset:0 sc1 lds
    buffer_load_dwordx4 v3, s[4:7], s45 offen offset:1024 sc1 lds
    buffer_load_dwordx4 v3, s[4:7], s45 offen offset:2048 sc1 lds
    buffer_load_dwordx4 v3, s[4:7], s45 offen offset:3072 sc1 lds
    s_add_u32 m0, s56, 4096
    s_add_u32 s45, s56, 561152
    buffer_load_dwordx4 v3, s[4:7], s45 offen offset:0 sc1 lds
    buffer_load_dwordx4 v3, s[4:7], s45 offen offset:1024 sc1 lds
    buffer_load_dwordx4 v3, s[4:7], s45 offen offset:2048 sc1 lds
    buffer_load_dwordx4 v3, s[4:7], s45 offen offset:3072 sc1 lds
    s_and_b32 s58, s2, 63
    s_lshr_b32 s59, s2, 6
    s_lshl_b32 s46, s59, 2
    s_add_u32 s46, s46, s43
    s_mul_i32 s46, s46, 786432
    s_lshl_b32 s47, s58, 7
    s_add_u32 s46, s46, s47
    s_add_u32 s46, s46, 4096
    s_add_u32 m0, s56, 98304
    s_add_u32 s45, s46, 0
    buffer_load_dwordx4 v28, s[96:99], s45 offen offset:0 nt lds
    buffer_load_dwordx4 v29, s[96:99], s45 offen offset:1024 nt lds
    buffer_load_dwordx4 v30, s[96:99], s45 offen offset:2048 nt lds
    buffer_load_dwordx4 v31, s[96:99], s45 offen offset:3072 nt lds
    s_add_u32 m0, s56, 102400
    s_add_u32 s45, s46, 393216
    buffer_load_dwordx4 v28, s[96:99], s45 offen offset:0 nt lds
    buffer_load_dwordx4 v29, s[96:99], s45 offen offset:1024 nt lds
    buffer_load_dwordx4 v30, s[96:99], s45 offen offset:2048 nt lds
    buffer_load_dwordx4 v31, s[96:99], s45 offen offset:3072 nt lds
    s_lshl_b32 s47, s2, 2
    s_add_u32 s47, s47, s43
    s_lshl_b32 s46, s47, 11
    s_mul_i32 s47, s47, 3584
    v_lshlrev_b32 v12, 7, v0
    s_mov_b64 exec, 0xfffffff
    buffer_load_dword v14, v12, s[28:31], s47 offen
    s_mov_b64 exec, 0xffff
    buffer_load_dword v14, v12, s[16:19], s46 offen
    s_mov_b64 exec, -1
    s_waitcnt vmcnt(10)
    s_barrier
    s_add_u32 m0, s56, 32768
    s_add_u32 s45, s56, 589824
    buffer_load_dwordx4 v3, s[4:7], s45 offen offset:0 sc1 lds
    buffer_load_dwordx4 v3, s[4:7], s45 offen offset:1024 sc1 lds
    buffer_load_dwordx4 v3, s[4:7], s45 offen offset:2048 sc1 lds
    buffer_load_dwordx4 v3, s[4:7], s45 offen offset:3072 sc1 lds
    s_add_u32 m0, s56, 36864
    s_add_u32 s45, s56, 593920
    buffer_load_dwordx4 v3, s[4:7], s45 offen offset:0 sc1 lds
    buffer_load_dwordx4 v3, s[4:7], s45 offen offset:1024 sc1 lds
    buffer_load_dwordx4 v3, s[4:7], s45 offen offset:2048 sc1 lds
    buffer_load_dwordx4 v3, s[4:7], s45 offen offset:3072 sc1 lds
    s_lshl_b32 s46, s59, 9
    s_add_u32 s46, s46, 172032
    buffer_load_dwordx4 v[64:67], v21, s[4:7], s46 offen offset:0 sc1
    buffer_load_dwordx4 v[68:71], v21, s[4:7], s46 offen offset:64 sc1
    buffer_load_dwordx4 v[72:75], v21, s[4:7], s46 offen offset:128 sc1
    buffer_load_dwordx4 v[76:79], v21, s[4:7], s46 offen offset:192 sc1
    buffer_load_dwordx4 v[80:83], v21, s[4:7], s46 offen offset:256 sc1
    buffer_load_dwordx4 v[84:87], v21, s[4:7], s46 offen offset:320 sc1
    buffer_load_dwordx4 v[88:91], v21, s[4:7], s46 offen offset:384 sc1
    buffer_load_dwordx4 v[92:95], v21, s[4:7], s46 offen offset:448 sc1
    s_add_u32 s45, s51, 3407872
    buffer_load_dwordx4 v[128:131], v4, s[28:31], s45 offen offset:0
    buffer_load_dwordx4 v[132:135], v5, s[28:31], s45 offen offset:1024
    buffer_load_dwordx4 v[136:139], v6, s[28:31], s45 offen offset:2048
    buffer_load_dwordx4 v[140:143], v7, s[28:31], s45 offen offset:3072
    s_add_u32 s45, s51, 3145728
    buffer_load_dwordx4 v[144:147], v4, s[28:31], s45 offen offset:0
    buffer_load_dwordx4 v[148:151], v5, s[28:31], s45 offen offset:1024
    buffer_load_dwordx4 v[152:155], v6, s[28:31], s45 offen offset:2048
    buffer_load_dwordx4 v[156:159], v7, s[28:31], s45 offen offset:3072
    s_add_u32 s45, s51, 2883584
    buffer_load_dwordx4 v[160:163], v4, s[28:31], s45 offen offset:0
    buffer_load_dwordx4 v[164:167], v5, s[28:31], s45 offen offset:1024
    buffer_load_dwordx4 v[168:171], v6, s[28:31], s45 offen offset:2048
    buffer_load_dwordx4 v[172:175], v7, s[28:31], s45 offen offset:3072
    s_waitcnt vmcnt(20)
    s_barrier
    s_add_u32 m0, s56, 65536
    s_add_u32 s45, s56, 622592
    buffer_load_dwordx4 v3, s[4:7], s45 offen offset:0 sc1 lds
    buffer_load_dwordx4 v3, s[4:7], s45 offen offset:1024 sc1 lds
    buffer_load_dwordx4 v3, s[4:7], s45 offen offset:2048 sc1 lds
    buffer_load_dwordx4 v3, s[4:7], s45 offen offset:3072 sc1 lds
    s_add_u32 m0, s56, 69632
    s_add_u32 s45, s56, 626688
    buffer_load_dwordx4 v3, s[4:7], s45 offen offset:0 sc1 lds
    buffer_load_dwordx4 v3, s[4:7], s45 offen offset:1024 sc1 lds
    buffer_load_dwordx4 v3, s[4:7], s45 offen offset:2048 sc1 lds
    buffer_load_dwordx4 v3, s[4:7], s45 offen offset:3072 sc1 lds
    s_waitcnt vmcnt(20)
    s_waitcnt lgkmcnt(0)
    ds_read_b64_tr_b16 v[32:33], v20 offset:0
    ds_read_b64_tr_b16 v[34:35], v20 offset:512
    ds_read_b64_tr_b16 v[36:37], v20 offset:4096
    ds_read_b64_tr_b16 v[38:39], v20 offset:4608
    ds_read_b64_tr_b16 v[40:41], v20 offset:8192
    ds_read_b64_tr_b16 v[42:43], v20 offset:8704
    ds_read_b64_tr_b16 v[44:45], v20 offset:12288
    ds_read_b64_tr_b16 v[46:47], v20 offset:12800
    ds_read_b64_tr_b16 v[48:49], v20 offset:16384
    ds_read_b64_tr_b16 v[50:51], v20 offset:16896
    ds_read_b64_tr_b16 v[52:53], v20 offset:20480
    ds_read_b64_tr_b16 v[54:55], v20 offset:20992
    ds_read_b64_tr_b16 v[56:57], v20 offset:24576
    ds_read_b64_tr_b16 v[58:59], v20 offset:25088
    ds_read_b64_tr_b16 v[60:61], v20 offset:28672
    ds_read_b64_tr_b16 v[62:63], v20 offset:29184
    s_waitcnt lgkmcnt(14)
    v_mfma_f32_16x16x32_bf16 v[24:27], v[32:35], v[64:67], 0
    s_waitcnt lgkmcnt(12)
    v_mfma_f32_16x16x32_bf16 v[24:27], v[36:39], v[68:71], v[24:27]
    s_waitcnt lgkmcnt(10)
    v_mfma_f32_16x16x32_bf16 v[24:27], v[40:43], v[72:75], v[24:27]
    s_waitcnt lgkmcnt(8)
    v_mfma_f32_16x16x32_bf16 v[24:27], v[44:47], v[76:79], v[24:27]
    s_waitcnt lgkmcnt(6)
    v_mfma_f32_16x16x32_bf16 v[24:27], v[48:51], v[80:83], v[24:27]
    s_waitcnt lgkmcnt(4)
    v_mfma_f32_16x16x32_bf16 v[24:27], v[52:55], v[84:87], v[24:27]
    s_waitcnt lgkmcnt(2)
    v_mfma_f32_16x16x32_bf16 v[24:27], v[56:59], v[88:91], v[24:27]
    s_waitcnt lgkmcnt(0)
    v_mfma_f32_16x16x32_bf16 v[24:27], v[60:63], v[92:95], v[24:27]
    s_mul_i32 s46, s59, 24576
    s_lshl_b32 s47, s58, 8
    s_add_u32 s46, s46, s47
    s_lshl_b32 s47, s43, 6
    s_add_u32 s46, s46, s47
    s_add_u32 s46, s46, 8192
    s_nop 3
    buffer_store_dwordx4 v[24:27], v21, s[4:7], s46 offen sc1
    s_lshr_b32 s48, s58, 2
    s_lshl_b32 s46, s48, 7
    s_add_u32 s46, s46, 1618944
    v_mov_b32 v2, 1
    s_mov_b64 exec, 1
    s_waitcnt vmcnt(0)
    buffer_atomic_add v2, off, s[4:7], s46 sc1
    s_mov_b64 exec, -1
    s_lshr_b32 s58, s2, 2
    s_and_b32 s59, s2, 3
    s_cmp_lt_u32 s2, 224
    s_cselect_b32 s57, 0, 536870912
    s_lshl_b32 s46, s59, 2
    s_add_u32 s46, s46, s43
    s_mul_i32 s46, s46, 458752
    s_lshl_b32 s47, s58, 7
    s_add_u32 s46, s46, s47
    s_add_u32 s46, s46, s57
    s_add_u32 m0, s56, 131072
    s_add_u32 s45, s46, 0
    buffer_load_dwordx4 v16, s[20:23], s45 offen offset:0 nt lds
    buffer_load_dwordx4 v17, s[20:23], s45 offen offset:1024 nt lds
    buffer_load_dwordx4 v18, s[20:23], s45 offen offset:2048 nt lds
    buffer_load_dwordx4 v19, s[20:23], s45 offen offset:3072 nt lds
    s_add_u32 m0, s56, 135168
    s_add_u32 s45, s46, 229376
    buffer_load_dwordx4 v16, s[20:23], s45 offen offset:0 nt lds
    buffer_load_dwordx4 v17, s[20:23], s45 offen offset:1024 nt lds
    buffer_load_dwordx4 v18, s[20:23], s45 offen offset:2048 nt lds
    buffer_load_dwordx4 v19, s[20:23], s45 offen offset:3072 nt lds
    s_barrier
    s_add_u32 m0, s56, 98304
    s_add_u32 s45, s56, 655360
    buffer_load_dwordx4 v3, s[4:7], s45 offen offset:0 sc1 lds
    buffer_load_dwordx4 v3, s[4:7], s45 offen offset:1024 sc1 lds
    buffer_load_dwordx4 v3, s[4:7], s45 offen offset:2048 sc1 lds
    buffer_load_dwordx4 v3, s[4:7], s45 offen offset:3072 sc1 lds
    s_add_u32 m0, s56, 102400
    s_add_u32 s45, s56, 659456
    buffer_load_dwordx4 v3, s[4:7], s45 offen offset:0 sc1 lds
    buffer_load_dwordx4 v3, s[4:7], s45 offen offset:1024 sc1 lds
    buffer_load_dwordx4 v3, s[4:7], s45 offen offset:2048 sc1 lds
    buffer_load_dwordx4 v3, s[4:7], s45 offen offset:3072 sc1 lds
    s_lshl_b32 s100, s44, 17
    s_lshl_b32 s47, s41, 8
    s_add_u32 s47, s100, s47
    s_add_u32 s45, s47, 0
    buffer_load_dwordx4 v[96:99], v10, s[24:27], s45 offen offset:0 nt
    buffer_load_dwordx4 v[100:103], v10, s[24:27], s45 offen offset:128 nt
    s_add_u32 s45, s47, 65536
    buffer_load_dwordx4 v[104:107], v10, s[24:27], s45 offen offset:0 nt
    buffer_load_dwordx4 v[108:111], v10, s[24:27], s45 offen offset:128 nt
    s_add_u32 s45, s47, 16384
    buffer_load_dwordx4 v[112:115], v10, s[24:27], s45 offen offset:0 nt
    buffer_load_dwordx4 v[116:119], v10, s[24:27], s45 offen offset:128 nt
    s_add_u32 s45, s47, 81920
    buffer_load_dwordx4 v[120:123], v10, s[24:27], s45 offen offset:0 nt
    buffer_load_dwordx4 v[124:127], v10, s[24:27], s45 offen offset:128 nt
    s_add_u32 s45, s51, 2621440
    buffer_load_dwordx4 v[176:179], v4, s[28:31], s45 offen offset:0
    buffer_load_dwordx4 v[180:183], v5, s[28:31], s45 offen offset:1024
    buffer_load_dwordx4 v[184:187], v6, s[28:31], s45 offen offset:2048
    buffer_load_dwordx4 v[188:191], v7, s[28:31], s45 offen offset:3072
    s_waitcnt vmcnt(12)
    s_barrier
    s_add_u32 m0, s56, 0
    s_add_u32 s45, s56, 688128
    buffer_load_dwordx4 v3, s[4:7], s45 offen offset:0 sc1 lds
    buffer_load_dwordx4 v3, s[4:7], s45 offen offset:1024 sc1 lds
    buffer_load_dwordx4 v3, s[4:7], s45 offen offset:2048 sc1 lds
    buffer_load_dwordx4 v3, s[4:7], s45 offen offset:3072 sc1 lds
    s_add_u32 m0, s56, 4096
    s_add_u32 s45, s56, 692224
    buffer_load_dwordx4 v3, s[4:7], s45 offen offset:0 sc1 lds
    buffer_load_dwordx4 v3, s[4:7], s45 offen offset:1024 sc1 lds
    buffer_load_dwordx4 v3, s[4:7], s45 offen offset:2048 sc1 lds
    buffer_load_dwordx4 v3, s[4:7], s45 offen offset:3072 sc1 lds
    s_sub_u32 s101, s2, 224
    s_cmp_ge_u32 s101, 4
    s_cbranch_scc1 adaLN_cond__grouped_kv_mqa__mixer_gmlp__prompt_kernel_nomod
    s_lshl_b32 s49, s101, 2
    s_add_u32 s49, s49, s43
    s_lshl_b32 s46, s49, 7
    s_add_u32 s46, s46, 1618944
    s_mov_b32 s47, 262144
    s_mov_b64 exec, 1
adaLN_cond__grouped_kv_mqa__mixer_gmlp__prompt_kernel_pm1:
    v_mov_b32 v1, 0
    buffer_atomic_add v1, off, s[4:7], s46 sc0 sc1
    s_sub_u32 s47, s47, 1
    s_waitcnt vmcnt(0)
    v_cmp_gt_u32 vcc, 64, v1
    s_cmp_eq_u32 s47, 0
    s_cbranch_scc1 adaLN_cond__grouped_kv_mqa__mixer_gmlp__prompt_kernel_pm1_x
    s_cbranch_vccnz adaLN_cond__grouped_kv_mqa__mixer_gmlp__prompt_kernel_pm1
adaLN_cond__grouped_kv_mqa__mixer_gmlp__prompt_kernel_pm1_x:
    s_mov_b64 exec, -1
    s_lshl_b32 s46, s49, 10
    s_add_u32 s47, s46, 8192
    buffer_load_dwordx4 v[32:35], v3, s[4:7], s47 offen sc1
    s_add_u32 s47, s46, 32768
    buffer_load_dwordx4 v[36:39], v3, s[4:7], s47 offen sc1
    s_add_u32 s47, s46, 57344
    buffer_load_dwordx4 v[40:43], v3, s[4:7], s47 offen sc1
    s_add_u32 s47, s46, 81920
    buffer_load_dwordx4 v[44:47], v3, s[4:7], s47 offen sc1
    s_cmp_eq_u32 s101, 2
    s_cselect_b32 s48, 1.0, 0
    s_waitcnt vmcnt(0)
    v_pk_add_f32 v[32:33], v[32:33], v[36:37]
    v_pk_add_f32 v[34:35], v[34:35], v[38:39]
    v_pk_add_f32 v[32:33], v[32:33], v[40:41]
    v_pk_add_f32 v[34:35], v[34:35], v[42:43]
    v_pk_add_f32 v[32:33], v[32:33], v[44:45]
    v_pk_add_f32 v[34:35], v[34:35], v[46:47]
    v_cvt_pk_bf16_f32 v32, v32, v33
    v_cvt_pk_bf16_f32 v34, v34, v35
    v_and_b32 v33, 0xffff0000, v32
    v_lshlrev_b32 v32, 16, v32
    v_and_b32 v35, 0xffff0000, v34
    v_lshlrev_b32 v34, 16, v34
    v_add_f32 v32, s48, v32
    v_add_f32 v33, s48, v33
    v_add_f32 v34, s48, v34
    v_add_f32 v35, s48, v35
    v_cvt_pk_bf16_f32 v32, v32, v33
    v_cvt_pk_bf16_f32 v34, v34, v35
    v_and_b32 v33, 0xffff0000, v32
    v_lshlrev_b32 v32, 16, v32
    v_and_b32 v35, 0xffff0000, v34
    v_lshlrev_b32 v34, 16, v34
    s_add_u32 s47, s46, 139264
    buffer_store_dwordx4 v[32:35], v3, s[4:7], s47 offen sc1
    v_cvt_pk_bf16_f32 v36, v32, v33
    v_cvt_pk_bf16_f32 v37, v34, v35
    v_lshlrev_b32 v38, 3, v0
    s_sub_u32 s47, 2, s101
    s_cmp_lt_u32 s47, 2
    s_cselect_b32 s48, 0, 536870912
    s_add_u32 s48, s48, 163840
    s_and_b32 s47, s47, 1
    s_lshl_b32 s47, s47, 11
    s_add_u32 s47, s47, s48
    s_lshl_b32 s48, s43, 9
    s_add_u32 s47, s47, s48
    buffer_store_dwordx2 v[36:37], v38, s[4:7], s47 offen sc1
    s_barrier
    s_lshl_b32 s46, 0, 7
    s_add_u32 s46, s46, 1620992
    v_mov_b32 v2, 1
    s_mov_b64 exec, 1
    s_waitcnt vmcnt(0)
    buffer_atomic_add v2, off, s[4:7], s46 sc1
    s_mov_b64 exec, -1
    s_branch adaLN_cond__grouped_kv_mqa__mixer_gmlp__prompt_kernel_mod2
adaLN_cond__grouped_kv_mqa__mixer_gmlp__prompt_kernel_nomod:
    s_waitcnt lgkmcnt(0)
    ds_read_b64_tr_b16 v[32:33], v20 offset:32768
    ds_read_b64_tr_b16 v[34:35], v20 offset:33280
    ds_read_b64_tr_b16 v[36:37], v20 offset:36864
    ds_read_b64_tr_b16 v[38:39], v20 offset:37376
    ds_read_b64_tr_b16 v[40:41], v20 offset:40960
    ds_read_b64_tr_b16 v[42:43], v20 offset:41472
    ds_read_b64_tr_b16 v[44:45], v20 offset:45056
    ds_read_b64_tr_b16 v[46:47], v20 offset:45568
    ds_read_b64_tr_b16 v[48:49], v20 offset:49152
    ds_read_b64_tr_b16 v[50:51], v20 offset:49664
    ds_read_b64_tr_b16 v[52:53], v20 offset:53248
    ds_read_b64_tr_b16 v[54:55], v20 offset:53760
    ds_read_b64_tr_b16 v[56:57], v20 offset:57344
    ds_read_b64_tr_b16 v[58:59], v20 offset:57856
    ds_read_b64_tr_b16 v[60:61], v20 offset:61440
    ds_read_b64_tr_b16 v[62:63], v20 offset:61952
    s_lshl_b32 s48, s58, 2
    s_add_u32 s48, s48, s43
    s_cmp_ge_u32 s48, 112
    s_cselect_b32 s46, 112, 0
    s_cselect_b32 s47, 7, 0
    s_sub_u32 s46, s48, s46
    s_mul_i32 s49, s46, 9363
    s_lshr_b32 s49, s49, 16
    s_mul_i32 s50, s49, 7
    s_sub_u32 s46, s46, s50
    s_add_u32 s46, s46, s47
    s_lshl_b32 s49, s49, 5
    s_lshl_b32 s50, s59, 3
    s_add_u32 s49, s49, s50
    s_mul_i32 s49, s49, 14
    s_add_u32 s49, s49, s46
    s_lshl_b32 s49, s49, 10
    s_add_u32 s49, s49, 14680064
    s_add_u32 s49, s49, s57
    s_waitcnt lgkmcnt(14)
    buffer_store_dwordx4 v[32:35], v3, s[4:7], s49 offen sc1
    s_add_u32 s49, s49, 14336
    s_waitcnt lgkmcnt(12)
    buffer_store_dwordx4 v[36:39], v3, s[4:7], s49 offen sc1
    s_add_u32 s49, s49, 14336
    s_waitcnt lgkmcnt(10)
    buffer_store_dwordx4 v[40:43], v3, s[4:7], s49 offen sc1
    s_add_u32 s49, s49, 14336
    s_waitcnt lgkmcnt(8)
    buffer_store_dwordx4 v[44:47], v3, s[4:7], s49 offen sc1
    s_add_u32 s49, s49, 14336
    s_waitcnt lgkmcnt(6)
    buffer_store_dwordx4 v[48:51], v3, s[4:7], s49 offen sc1
    s_add_u32 s49, s49, 14336
    s_waitcnt lgkmcnt(4)
    buffer_store_dwordx4 v[52:55], v3, s[4:7], s49 offen sc1
    s_add_u32 s49, s49, 14336
    s_waitcnt lgkmcnt(2)
    buffer_store_dwordx4 v[56:59], v3, s[4:7], s49 offen sc1
    s_add_u32 s49, s49, 14336
    s_waitcnt lgkmcnt(0)
    buffer_store_dwordx4 v[60:63], v3, s[4:7], s49 offen sc1
    s_add_u32 s49, s49, 14336
    s_waitcnt vmcnt(8)
    s_barrier
adaLN_cond__grouped_kv_mqa__mixer_gmlp__prompt_kernel_mod2:
    s_add_u32 m0, s56, 32768
    s_add_u32 s45, s56, 720896
    buffer_load_dwordx4 v3, s[4:7], s45 offen offset:0 sc1 lds
    buffer_load_dwordx4 v3, s[4:7], s45 offen offset:1024 sc1 lds
    buffer_load_dwordx4 v3, s[4:7], s45 offen offset:2048 sc1 lds
    buffer_load_dwordx4 v3, s[4:7], s45 offen offset:3072 sc1 lds
    s_add_u32 m0, s56, 36864
    s_add_u32 s45, s56, 724992
    buffer_load_dwordx4 v3, s[4:7], s45 offen offset:0 sc1 lds
    buffer_load_dwordx4 v3, s[4:7], s45 offen offset:1024 sc1 lds
    buffer_load_dwordx4 v3, s[4:7], s45 offen offset:2048 sc1 lds
    buffer_load_dwordx4 v3, s[4:7], s45 offen offset:3072 sc1 lds
    s_add_u32 m0, s52, 65536
    s_add_u32 s45, s51, 1048576
    buffer_load_dwordx4 v4, s[16:19], s45 offen offset:0  lds
    buffer_load_dwordx4 v5, s[16:19], s45 offen offset:1024  lds
    buffer_load_dwordx4 v6, s[16:19], s45 offen offset:2048  lds
    buffer_load_dwordx4 v7, s[16:19], s45 offen offset:3072  lds
    s_add_u32 m0, s52, 81920
    s_add_u32 s45, s51, 1310720
    buffer_load_dwordx4 v4, s[16:19], s45 offen offset:0  lds
    buffer_load_dwordx4 v5, s[16:19], s45 offen offset:1024  lds
    buffer_load_dwordx4 v6, s[16:19], s45 offen offset:2048  lds
    buffer_load_dwordx4 v7, s[16:19], s45 offen offset:3072  lds
    s_lshl_b32 s47, s41, 13
    s_add_u32 s47, s100, s47
    s_add_u32 s47, s47, 39845888
    s_add_u32 s49, s47, 4096
    buffer_store_dwordx4 v[96:99], v11, s[4:7], s47 offen offset:0 sc1
    buffer_store_dwordx4 v[100:103], v11, s[4:7], s49 offen offset:0 sc1
    buffer_store_dwordx4 v[104:107], v11, s[4:7], s47 offen offset:128 sc1
    buffer_store_dwordx4 v[108:111], v11, s[4:7], s49 offen offset:128 sc1
    buffer_store_dwordx4 v[112:115], v11, s[4:7], s47 offen offset:256 sc1
    buffer_store_dwordx4 v[116:119], v11, s[4:7], s49 offen offset:256 sc1
    buffer_store_dwordx4 v[120:123], v11, s[4:7], s47 offen offset:384 sc1
    buffer_store_dwordx4 v[124:127], v11, s[4:7], s49 offen offset:384 sc1
    s_waitcnt vmcnt(16)
    s_barrier
    v_and_b32 v12, 0, v0
    v_lshlrev_b32 v12, 7, v12
    v_add_u32 v12, 1620992, v12
    v_mov_b32 v13, -1
    s_bfm_b64 exec, 1, 0
    buffer_load_dword v13, v12, s[4:7], 0 offen sc1
    s_mov_b64 exec, -1
    s_add_u32 m0, s56, 131072
    s_add_u32 s45, s56, 753664
    buffer_load_dwordx4 v3, s[4:7], s45 offen offset:0 sc1 lds
    buffer_load_dwordx4 v3, s[4:7], s45 offen offset:1024 sc1 lds
    buffer_load_dwordx4 v3, s[4:7], s45 offen offset:2048 sc1 lds
    buffer_load_dwordx4 v3, s[4:7], s45 offen offset:3072 sc1 lds
    s_add_u32 m0, s56, 135168
    s_add_u32 s45, s56, 757760
    buffer_load_dwordx4 v3, s[4:7], s45 offen offset:0 sc1 lds
    buffer_load_dwordx4 v3, s[4:7], s45 offen offset:1024 sc1 lds
    buffer_load_dwordx4 v3, s[4:7], s45 offen offset:2048 sc1 lds
    buffer_load_dwordx4 v3, s[4:7], s45 offen offset:3072 sc1 lds
    s_waitcnt vmcnt(8)
    s_mov_b32 s47, 262144
adaLN_cond__grouped_kv_mqa__mixer_gmlp__prompt_kernel_lm2:
    v_cmp_gt_u32 vcc, 16, v13
    s_sub_u32 s47, s47, 1
    s_cbranch_vccz adaLN_cond__grouped_kv_mqa__mixer_gmlp__prompt_kernel_lm2_x
    s_cmp_eq_u32 s47, 0
    s_cbranch_scc1 adaLN_cond__grouped_kv_mqa__mixer_gmlp__prompt_kernel_lm2_x
    s_mov_b64 exec, vcc
    buffer_load_dword v13, v12, s[4:7], 0 offen sc1
    s_mov_b64 exec, -1
    s_waitcnt vmcnt(0)
    s_branch adaLN_cond__grouped_kv_mqa__mixer_gmlp__prompt_kernel_lm2
adaLN_cond__grouped_kv_mqa__mixer_gmlp__prompt_kernel_lm2_x:
    s_lshl_b32 s46, s59, 9
    s_add_u32 s46, s46, 163840
    buffer_load_dwordx4 v[64:67], v22, s[4:7], s46 offen offset:0 sc1
    buffer_load_dwordx4 v[68:71], v22, s[4:7], s46 offen offset:64 sc1
    buffer_load_dwordx4 v[72:75], v22, s[4:7], s46 offen offset:128 sc1
    buffer_load_dwordx4 v[76:79], v22, s[4:7], s46 offen offset:192 sc1
    buffer_load_dwordx4 v[80:83], v22, s[4:7], s46 offen offset:256 sc1
    buffer_load_dwordx4 v[84:87], v22, s[4:7], s46 offen offset:320 sc1
    buffer_load_dwordx4 v[88:91], v22, s[4:7], s46 offen offset:384 sc1
    buffer_load_dwordx4 v[92:95], v22, s[4:7], s46 offen offset:448 sc1
    s_waitcnt vmcnt(0)
    v_mfma_f32_16x16x32_bf16 v[24:27], v[32:35], v[64:67], 0
    v_mfma_f32_16x16x32_bf16 v[24:27], v[36:39], v[68:71], v[24:27]
    v_mfma_f32_16x16x32_bf16 v[24:27], v[40:43], v[72:75], v[24:27]
    v_mfma_f32_16x16x32_bf16 v[24:27], v[44:47], v[76:79], v[24:27]
    v_mfma_f32_16x16x32_bf16 v[24:27], v[48:51], v[80:83], v[24:27]
    v_mfma_f32_16x16x32_bf16 v[24:27], v[52:55], v[84:87], v[24:27]
    v_mfma_f32_16x16x32_bf16 v[24:27], v[56:59], v[88:91], v[24:27]
    v_mfma_f32_16x16x32_bf16 v[24:27], v[60:63], v[92:95], v[24:27]
    s_mul_i32 s46, s59, 28672
    s_lshl_b32 s47, s48, 6
    s_add_u32 s46, s46, s47
    s_add_u32 s46, s46, 196608
    s_add_u32 s46, s46, s57
    s_nop 4
    buffer_store_dwordx4 v[24:27], v23, s[4:7], s46 offen sc1
    s_add_u32 m0, s52, 98304
    s_add_u32 s45, s51, 1572864
    buffer_load_dwordx4 v4, s[16:19], s45 offen offset:0  lds
    buffer_load_dwordx4 v5, s[16:19], s45 offen offset:1024  lds
    buffer_load_dwordx4 v6, s[16:19], s45 offen offset:2048  lds
    buffer_load_dwordx4 v7, s[16:19], s45 offen offset:3072  lds
    s_add_u32 m0, s52, 114688
    s_add_u32 s45, s51, 1835008
    buffer_load_dwordx4 v4, s[16:19], s45 offen offset:0  lds
    buffer_load_dwordx4 v5, s[16:19], s45 offen offset:1024  lds
    buffer_load_dwordx4 v6, s[16:19], s45 offen offset:2048  lds
    buffer_load_dwordx4 v7, s[16:19], s45 offen offset:3072  lds
    s_barrier
    s_add_u32 m0, s52, 0
    s_add_u32 s45, s51, 0
    buffer_load_dwordx4 v4, s[16:19], s45 offen offset:0  lds
    buffer_load_dwordx4 v5, s[16:19], s45 offen offset:1024  lds
    buffer_load_dwordx4 v6, s[16:19], s45 offen offset:2048  lds
    buffer_load_dwordx4 v7, s[16:19], s45 offen offset:3072  lds
    s_add_u32 m0, s52, 16384
    s_add_u32 s45, s51, 262144
    buffer_load_dwordx4 v4, s[16:19], s45 offen offset:0  lds
    buffer_load_dwordx4 v5, s[16:19], s45 offen offset:1024  lds
    buffer_load_dwordx4 v6, s[16:19], s45 offen offset:2048  lds
    buffer_load_dwordx4 v7, s[16:19], s45 offen offset:3072  lds
    s_waitcnt vmcnt(16)
    s_and_b32 s48, s2, 7
    s_lshl_b32 s46, s48, 7
    s_add_u32 s46, s46, 1617920
    v_mov_b32 v2, 1
    s_mov_b64 exec, 1
    buffer_atomic_add v2, off, s[4:7], s46 sc1
    s_mov_b64 exec, -1
    v_lshlrev_b32 v8, 2, v0
    s_lshl_b32 s46, s41, 8
    s_min_u32 s47, s43, 2
    s_lshl_b32 s48, s47, 8
    s_add_u32 s48, s48, 135168
    v_add_u32 v17, s48, v8
    s_min_u32 s48, s47, 1
    s_add_u32 s47, s47, s48
    s_lshl_b32 s47, s47, 12
    s_add_u32 s46, s46, s47
    s_add_u32 s46, s46, 139264
    buffer_load_dword v18, v8, s[4:7], s46 offen sc1
    s_add_u32 s45, s51, 524288
    buffer_load_dwordx4 v[208:211], v4, s[16:19], s45 offen offset:0
    buffer_load_dwordx4 v[212:215], v5, s[16:19], s45 offen offset:1024
    buffer_load_dwordx4 v[216:219], v6, s[16:19], s45 offen offset:2048
    buffer_load_dwordx4 v[220:223], v7, s[16:19], s45 offen offset:3072
    s_add_u32 s45, s51, 786432
    buffer_load_dwordx4 v[224:227], v4, s[16:19], s45 offen offset:0
    buffer_load_dwordx4 v[228:231], v5, s[16:19], s45 offen offset:1024
    buffer_load_dwordx4 v[232:235], v6, s[16:19], s45 offen offset:2048
    buffer_load_dwordx4 v[236:239], v7, s[16:19], s45 offen offset:3072
    v_add_u32 v16, s52, v3
    s_add_u32 s45, s51, 2097152
    buffer_load_dwordx4 v[192:195], v4, s[28:31], s45 offen offset:0
    buffer_load_dwordx4 v[196:199], v5, s[28:31], s45 offen offset:1024
    buffer_load_dwordx4 v[200:203], v6, s[28:31], s45 offen offset:2048
    buffer_load_dwordx4 v[204:207], v7, s[28:31], s45 offen offset:3072
    s_barrier
    s_setprio 0
    s_waitcnt vmcnt(4)
    ds_write_b128 v16, v[208:211] offset:32768
    ds_write_b128 v16, v[212:215] offset:33792
    ds_write_b128 v16, v[216:219] offset:34816
    ds_write_b128 v16, v[220:223] offset:35840
    ds_write_b128 v16, v[224:227] offset:49152
    ds_write_b128 v16, v[228:231] offset:50176
    ds_write_b128 v16, v[232:235] offset:51200
    ds_write_b128 v16, v[236:239] offset:52224
    s_waitcnt lgkmcnt(0)
    s_barrier
    ds_write_b32 v17, v18
    s_waitcnt lgkmcnt(0)
    s_barrier
    v_and_b32 v12, 1, v0
    v_lshlrev_b32 v12, 7, v12
    s_mul_i32 s47, s43, 256
    s_add_u32 s47, s47, 1617920
    v_add_u32 v12, s47, v12
    v_mov_b32 v13, -1
    s_bfm_b64 exec, 2, 0
    buffer_load_dword v13, v12, s[4:7], 0 offen sc1
    s_mov_b64 exec, -1
    s_barrier
    s_waitcnt vmcnt(0)
    s_mov_b32 s47, 262144
adaLN_cond__grouped_kv_mqa__mixer_gmlp__prompt_kernel_lw:
    v_cmp_gt_u32 vcc, 128, v13
    s_sub_u32 s47, s47, 1
    s_cbranch_vccz adaLN_cond__grouped_kv_mqa__mixer_gmlp__prompt_kernel_lw_x
    s_cmp_eq_u32 s47, 0
    s_cbranch_scc1 adaLN_cond__grouped_kv_mqa__mixer_gmlp__prompt_kernel_lw_x
    s_mov_b64 exec, vcc
    buffer_load_dword v13, v12, s[4:7], 0 offen sc1
    s_mov_b64 exec, -1
    s_waitcnt vmcnt(0)
    s_branch adaLN_cond__grouped_kv_mqa__mixer_gmlp__prompt_kernel_lw
adaLN_cond__grouped_kv_mqa__mixer_gmlp__prompt_kernel_lw_x:
    s_barrier
    s_barrier
    s_barrier
    s_add_u32 s49, s41, 0
    s_and_b32 s49, s49, 15
    s_mul_i32 s49, s49, 28672
    s_add_u32 s49, s49, s53
    s_add_u32 m0, s55, 0
    s_add_u32 s45, s49, 14680064
    buffer_load_dwordx4 v3, s[4:7], s45 offen offset:0 sc1 lds
    buffer_load_dwordx4 v3, s[4:7], s45 offen offset:1024 sc1 lds
    buffer_load_dwordx4 v3, s[4:7], s45 offen offset:2048 sc1 lds
    buffer_load_dwordx4 v3, s[4:7], s45 offen offset:3072 sc1 lds
    s_add_u32 m0, s55, 4096
    s_add_u32 s45, s49, 14684160
    buffer_load_dwordx4 v3, s[4:7], s45 offen offset:0 sc1 lds
    buffer_load_dwordx4 v3, s[4:7], s45 offen offset:1024 sc1 lds
    buffer_load_dwordx4 v3, s[4:7], s45 offen offset:2048 sc1 lds
    s_add_u32 s49, s41, 1
    s_and_b32 s49, s49, 15
    s_mul_i32 s49, s49, 28672
    s_add_u32 s49, s49, s53
    s_add_u32 m0, s55, 28672
    s_add_u32 s45, s49, 14680064
    buffer_load_dwordx4 v3, s[4:7], s45 offen offset:0 sc1 lds
    buffer_load_dwordx4 v3, s[4:7], s45 offen offset:1024 sc1 lds
    buffer_load_dwordx4 v3, s[4:7], s45 offen offset:2048 sc1 lds
    buffer_load_dwordx4 v3, s[4:7], s45 offen offset:3072 sc1 lds
    s_add_u32 m0, s55, 32768
    s_add_u32 s45, s49, 14684160
    buffer_load_dwordx4 v3, s[4:7], s45 offen offset:0 sc1 lds
    buffer_load_dwordx4 v3, s[4:7], s45 offen offset:1024 sc1 lds
    buffer_load_dwordx4 v3, s[4:7], s45 offen offset:2048 sc1 lds
    s_lshr_b32 s46, s43, 1
    s_and_b32 s47, s43, 1
    s_mul_i32 s46, s46, 14336
    s_mul_i32 s47, s47, 7168
    s_add_u32 s46, s46, s47
    s_mul_i32 s47, s41, 448
    s_add_u32 s46, s46, s47
    s_mov_b64 exec, 0xfffffff
    s_add_u32 s45, s46, 196608
    buffer_load_dwordx4 v[48:51], v3, s[4:7], s45 offen sc1
    s_add_u32 s45, s46, 225280
    buffer_load_dwordx4 v[52:55], v3, s[4:7], s45 offen sc1
    s_add_u32 s45, s46, 253952
    buffer_load_dwordx4 v[56:59], v3, s[4:7], s45 offen sc1
    s_add_u32 s45, s46, 282624
    buffer_load_dwordx4 v[60:63], v3, s[4:7], s45 offen sc1
    s_waitcnt vmcnt(0)
    v_pk_add_f32 v[48:49], v[48:49], v[52:53]
    v_pk_add_f32 v[50:51], v[50:51], v[54:55]
    v_pk_add_f32 v[48:49], v[48:49], v[56:57]
    v_pk_add_f32 v[50:51], v[50:51], v[58:59]
    v_pk_add_f32 v[48:49], v[48:49], v[60:61]
    v_pk_add_f32 v[50:51], v[50:51], v[62:63]
    s_mul_i32 s54, s43, 448
    s_add_u32 s54, s54, 131072
    v_add_u32 v13, s54, v3
    ds_write_b128 v13, v[48:51]
    s_mov_b64 exec, 1
    v_mov_b32 v13, 140040
    v_pk_mul_f32 v[10:11], 0, 0
    ds_write_b64 v13, v[10:11]
    ds_write_b64 v13, v[10:11] offset:8
    s_mov_b64 exec, -1
    s_waitcnt lgkmcnt(0)
    s_barrier
    s_add_u32 s49, s41, 2
    s_and_b32 s49, s49, 15
    s_mul_i32 s49, s49, 28672
    s_add_u32 s49, s49, s53
    s_add_u32 m0, s55, 57344
    s_add_u32 s45, s49, 14680064
    buffer_load_dwordx4 v3, s[4:7], s45 offen offset:0 sc1 lds
    buffer_load_dwordx4 v3, s[4:7], s45 offen offset:1024 sc1 lds
    buffer_load_dwordx4 v3, s[4:7], s45 offen offset:2048 sc1 lds
    buffer_load_dwordx4 v3, s[4:7], s45 offen offset:3072 sc1 lds
    s_add_u32 m0, s55, 61440
    s_add_u32 s45, s49, 14684160
    buffer_load_dwordx4 v3, s[4:7], s45 offen offset:0 sc1 lds
    buffer_load_dwordx4 v3, s[4:7], s45 offen offset:1024 sc1 lds
    buffer_load_dwordx4 v3, s[4:7], s45 offen offset:2048 sc1 lds
    s_barrier
    s_add_u32 s49, s41, 3
    s_and_b32 s49, s49, 15
    s_mul_i32 s49, s49, 28672
    s_add_u32 s49, s49, s53
    s_add_u32 m0, s55, 86016
    s_add_u32 s45, s49, 14680064
    buffer_load_dwordx4 v3, s[4:7], s45 offen offset:0 sc1 lds
    buffer_load_dwordx4 v3, s[4:7], s45 offen offset:1024 sc1 lds
    buffer_load_dwordx4 v3, s[4:7], s45 offen offset:2048 sc1 lds
    buffer_load_dwordx4 v3, s[4:7], s45 offen offset:3072 sc1 lds
    s_add_u32 m0, s55, 90112
    s_add_u32 s45, s49, 14684160
    buffer_load_dwordx4 v3, s[4:7], s45 offen offset:0 sc1 lds
    buffer_load_dwordx4 v3, s[4:7], s45 offen offset:1024 sc1 lds
    buffer_load_dwordx4 v3, s[4:7], s45 offen offset:2048 sc1 lds
    s_waitcnt vmcnt(7)
    s_barrier
    s_add_u32 s49, s41, 4
    s_and_b32 s49, s49, 15
    s_mul_i32 s49, s49, 28672
    s_add_u32 s49, s49, s53
    s_add_u32 m0, s55, 0
    s_add_u32 s45, s49, 14680064
    buffer_load_dwordx4 v3, s[4:7], s45 offen offset:0 sc1 lds
    buffer_load_dwordx4 v3, s[4:7], s45 offen offset:1024 sc1 lds
    buffer_load_dwordx4 v3, s[4:7], s45 offen offset:2048 sc1 lds
    buffer_load_dwordx4 v3, s[4:7], s45 offen offset:3072 sc1 lds
    s_add_u32 m0, s55, 4096
    s_add_u32 s45, s49, 14684160
    buffer_load_dwordx4 v3, s[4:7], s45 offen offset:0 sc1 lds
    buffer_load_dwordx4 v3, s[4:7], s45 offen offset:1024 sc1 lds
    buffer_load_dwordx4 v3, s[4:7], s45 offen offset:2048 sc1 lds
    s_waitcnt vmcnt(7)
    s_barrier
    s_add_u32 s49, s41, 5
    s_and_b32 s49, s49, 15
    s_mul_i32 s49, s49, 28672
    s_add_u32 s49, s49, s53
    s_add_u32 m0, s55, 28672
    s_add_u32 s45, s49, 14680064
    buffer_load_dwordx4 v3, s[4:7], s45 offen offset:0 sc1 lds
    buffer_load_dwordx4 v3, s[4:7], s45 offen offset:1024 sc1 lds
    buffer_load_dwordx4 v3, s[4:7], s45 offen offset:2048 sc1 lds
    buffer_load_dwordx4 v3, s[4:7], s45 offen offset:3072 sc1 lds
    s_add_u32 m0, s55, 32768
    s_add_u32 s45, s49, 14684160
    buffer_load_dwordx4 v3, s[4:7], s45 offen offset:0 sc1 lds
    buffer_load_dwordx4 v3, s[4:7], s45 offen offset:1024 sc1 lds
    buffer_load_dwordx4 v3, s[4:7], s45 offen offset:2048 sc1 lds
    v_lshrrev_b32 v12, 4, v0
    v_lshlrev_b32 v12, 10, v12
    v_and_b32 v13, 15, v0
    v_lshl_add_u32 v12, v13, 4, v12
    s_lshl_b32 s48, s44, 12
    s_add_u32 s48, s48, 1048576
    buffer_load_dwordx4 v[32:35], v12, s[4:7], s48 offen offset:0 sc1
    s_waitcnt vmcnt(8)
    s_barrier
    s_add_u32 s49, s41, 6
    s_and_b32 s49, s49, 15
    s_mul_i32 s49, s49, 28672
    s_add_u32 s49, s49, s53
    s_add_u32 m0, s55, 57344
    s_add_u32 s45, s49, 14680064
    buffer_load_dwordx4 v3, s[4:7], s45 offen offset:0 sc1 lds
    buffer_load_dwordx4 v3, s[4:7], s45 offen offset:1024 sc1 lds
    buffer_load_dwordx4 v3, s[4:7], s45 offen offset:2048 sc1 lds
    buffer_load_dwordx4 v3, s[4:7], s45 offen offset:3072 sc1 lds
    s_add_u32 m0, s55, 61440
    s_add_u32 s45, s49, 14684160
    buffer_load_dwordx4 v3, s[4:7], s45 offen offset:0 sc1 lds
    buffer_load_dwordx4 v3, s[4:7], s45 offen offset:1024 sc1 lds
    buffer_load_dwordx4 v3, s[4:7], s45 offen offset:2048 sc1 lds
    buffer_load_dwordx4 v[36:39], v12, s[4:7], s48 offen offset:256 sc1
    s_waitcnt vmcnt(9)
    s_barrier
    s_add_u32 s49, s41, 7
    s_and_b32 s49, s49, 15
    s_mul_i32 s49, s49, 28672
    s_add_u32 s49, s49, s53
    s_add_u32 m0, s55, 86016
    s_add_u32 s45, s49, 14680064
    buffer_load_dwordx4 v3, s[4:7], s45 offen offset:0 sc1 lds
    buffer_load_dwordx4 v3, s[4:7], s45 offen offset:1024 sc1 lds
    buffer_load_dwordx4 v3, s[4:7], s45 offen offset:2048 sc1 lds
    buffer_load_dwordx4 v3, s[4:7], s45 offen offset:3072 sc1 lds
    s_add_u32 m0, s55, 90112
    s_add_u32 s45, s49, 14684160
    buffer_load_dwordx4 v3, s[4:7], s45 offen offset:0 sc1 lds
    buffer_load_dwordx4 v3, s[4:7], s45 offen offset:1024 sc1 lds
    buffer_load_dwordx4 v3, s[4:7], s45 offen offset:2048 sc1 lds
    buffer_load_dwordx4 v[40:43], v12, s[4:7], s48 offen offset:512 sc1
    s_waitcnt vmcnt(9)
    s_barrier
    s_add_u32 s49, s41, 8
    s_and_b32 s49, s49, 15
    s_mul_i32 s49, s49, 28672
    s_add_u32 s49, s49, s53
    s_add_u32 m0, s55, 0
    s_add_u32 s45, s49, 14680064
    buffer_load_dwordx4 v3, s[4:7], s45 offen offset:0 sc1 lds
    buffer_load_dwordx4 v3, s[4:7], s45 offen offset:1024 sc1 lds
    buffer_load_dwordx4 v3, s[4:7], s45 offen offset:2048 sc1 lds
    buffer_load_dwordx4 v3, s[4:7], s45 offen offset:3072 sc1 lds
    s_add_u32 m0, s55, 4096
    s_add_u32 s45, s49, 14684160
    buffer_load_dwordx4 v3, s[4:7], s45 offen offset:0 sc1 lds
    buffer_load_dwordx4 v3, s[4:7], s45 offen offset:1024 sc1 lds
    buffer_load_dwordx4 v3, s[4:7], s45 offen offset:2048 sc1 lds
    buffer_load_dwordx4 v[44:47], v12, s[4:7], s48 offen offset:768 sc1
    s_waitcnt vmcnt(9)
    s_barrier
    s_add_u32 s49, s41, 9
    s_and_b32 s49, s49, 15
    s_mul_i32 s49, s49, 28672
    s_add_u32 s49, s49, s53
    s_add_u32 m0, s55, 28672
    s_add_u32 s45, s49, 14680064
    buffer_load_dwordx4 v3, s[4:7], s45 offen offset:0 sc1 lds
    buffer_load_dwordx4 v3, s[4:7], s45 offen offset:1024 sc1 lds
    buffer_load_dwordx4 v3, s[4:7], s45 offen offset:2048 sc1 lds
    buffer_load_dwordx4 v3, s[4:7], s45 offen offset:3072 sc1 lds
    s_add_u32 m0, s55, 32768
    s_add_u32 s45, s49, 14684160
    buffer_load_dwordx4 v3, s[4:7], s45 offen offset:0 sc1 lds
    buffer_load_dwordx4 v3, s[4:7], s45 offen offset:1024 sc1 lds
    buffer_load_dwordx4 v3, s[4:7], s45 offen offset:2048 sc1 lds
    s_waitcnt vmcnt(8)
    s_barrier
    s_add_u32 s49, s41, 10
    s_and_b32 s49, s49, 15
    s_mul_i32 s49, s49, 28672
    s_add_u32 s49, s49, s53
    s_add_u32 m0, s55, 57344
    s_add_u32 s45, s49, 14680064
    buffer_load_dwordx4 v3, s[4:7], s45 offen offset:0 sc1 lds
    buffer_load_dwordx4 v3, s[4:7], s45 offen offset:1024 sc1 lds
    buffer_load_dwordx4 v3, s[4:7], s45 offen offset:2048 sc1 lds
    buffer_load_dwordx4 v3, s[4:7], s45 offen offset:3072 sc1 lds
    s_add_u32 m0, s55, 61440
    s_add_u32 s45, s49, 14684160
    buffer_load_dwordx4 v3, s[4:7], s45 offen offset:0 sc1 lds
    buffer_load_dwordx4 v3, s[4:7], s45 offen offset:1024 sc1 lds
    buffer_load_dwordx4 v3, s[4:7], s45 offen offset:2048 sc1 lds
    s_mov_b32 s47, 262144
    s_waitcnt vmcnt(14)
adaLN_cond__grouped_kv_mqa__mixer_gmlp__prompt_kernel_s1:
    v_max3_u32 v13, v32, v33, v34
    v_max3_u32 v13, v13, v35, v36
    v_max3_u32 v13, v13, v37, v38
    v_max3_u32 v13, v13, v39, v40
    v_max3_u32 v13, v13, v41, v42
    v_max3_u32 v13, v13, v43, v44
    v_max3_u32 v13, v13, v45, v46
    v_max_u32 v13, v13, v47
    v_cmp_eq_u32 vcc, -1, v13
    s_sub_u32 s47, s47, 1
    s_cbranch_vccz adaLN_cond__grouped_kv_mqa__mixer_gmlp__prompt_kernel_s1_x
    s_cmp_eq_u32 s47, 0
    s_cbranch_scc1 adaLN_cond__grouped_kv_mqa__mixer_gmlp__prompt_kernel_s1_x
    buffer_load_dwordx4 v[32:35], v12, s[4:7], s48 offen offset:0 sc1
    buffer_load_dwordx4 v[36:39], v12, s[4:7], s48 offen offset:256 sc1
    buffer_load_dwordx4 v[40:43], v12, s[4:7], s48 offen offset:512 sc1
    buffer_load_dwordx4 v[44:47], v12, s[4:7], s48 offen offset:768 sc1
    s_waitcnt vmcnt(0)
    s_branch adaLN_cond__grouped_kv_mqa__mixer_gmlp__prompt_kernel_s1
adaLN_cond__grouped_kv_mqa__mixer_gmlp__prompt_kernel_s1_x:
    s_waitcnt vmcnt(7)
    s_barrier
    s_add_u32 s49, s41, 11
    s_and_b32 s49, s49, 15
    s_mul_i32 s49, s49, 28672
    s_add_u32 s49, s49, s53
    s_add_u32 m0, s55, 86016
    s_add_u32 s45, s49, 14680064
    buffer_load_dwordx4 v3, s[4:7], s45 offen offset:0 sc1 lds
    buffer_load_dwordx4 v3, s[4:7], s45 offen offset:1024 sc1 lds
    buffer_load_dwordx4 v3, s[4:7], s45 offen offset:2048 sc1 lds
    buffer_load_dwordx4 v3, s[4:7], s45 offen offset:3072 sc1 lds
    s_add_u32 m0, s55, 90112
    s_add_u32 s45, s49, 14684160
    buffer_load_dwordx4 v3, s[4:7], s45 offen offset:0 sc1 lds
    buffer_load_dwordx4 v3, s[4:7], s45 offen offset:1024 sc1 lds
    buffer_load_dwordx4 v3, s[4:7], s45 offen offset:2048 sc1 lds
    v_pk_add_f32 v[32:33], v[32:33], v[36:37]
    v_pk_add_f32 v[34:35], v[34:35], v[38:39]
    v_pk_add_f32 v[32:33], v[32:33], v[40:41]
    v_pk_add_f32 v[34:35], v[34:35], v[42:43]
    v_pk_add_f32 v[32:33], v[32:33], v[44:45]
    v_pk_add_f32 v[34:35], v[34:35], v[46:47]
    v_mov_b32 v36, v32
    v_mov_b32 v37, v33
    v_mov_b32 v38, v34
    v_mov_b32 v39, v35
    s_nop 0
    s_waitcnt vmcnt(7)
    s_barrier
    s_add_u32 s49, s41, 12
    s_and_b32 s49, s49, 15
    s_mul_i32 s49, s49, 28672
    s_add_u32 s49, s49, s53
    s_add_u32 m0, s55, 0
    s_add_u32 s45, s49, 14680064
    buffer_load_dwordx4 v3, s[4:7], s45 offen offset:0 sc1 lds
    buffer_load_dwordx4 v3, s[4:7], s45 offen offset:1024 sc1 lds
    buffer_load_dwordx4 v3, s[4:7], s45 offen offset:2048 sc1 lds
    buffer_load_dwordx4 v3, s[4:7], s45 offen offset:3072 sc1 lds
    s_add_u32 m0, s55, 4096
    s_add_u32 s45, s49, 14684160
    buffer_load_dwordx4 v3, s[4:7], s45 offen offset:0 sc1 lds
    buffer_load_dwordx4 v3, s[4:7], s45 offen offset:1024 sc1 lds
    buffer_load_dwordx4 v3, s[4:7], s45 offen offset:2048 sc1 lds
    v_permlane16_swap_b32 v32, v36
    v_permlane16_swap_b32 v33, v37
    v_permlane16_swap_b32 v34, v38
    v_permlane16_swap_b32 v35, v39
    v_add_f32 v32, v32, v36
    v_add_f32 v33, v33, v37
    v_add_f32 v34, v34, v38
    v_add_f32 v35, v35, v39
    v_mov_b32 v36, v32
    v_mov_b32 v37, v33
    v_mov_b32 v38, v34
    s_waitcnt vmcnt(7)
    s_barrier
    s_add_u32 s49, s41, 13
    s_and_b32 s49, s49, 15
    s_mul_i32 s49, s49, 28672
    s_add_u32 s49, s49, s53
    s_add_u32 m0, s55, 28672
    s_add_u32 s45, s49, 14680064
    buffer_load_dwordx4 v3, s[4:7], s45 offen offset:0 sc1 lds
    buffer_load_dwordx4 v3, s[4:7], s45 offen offset:1024 sc1 lds
    buffer_load_dwordx4 v3, s[4:7], s45 offen offset:2048 sc1 lds
    buffer_load_dwordx4 v3, s[4:7], s45 offen offset:3072 sc1 lds
    s_add_u32 m0, s55, 32768
    s_add_u32 s45, s49, 14684160
    buffer_load_dwordx4 v3, s[4:7], s45 offen offset:0 sc1 lds
    buffer_load_dwordx4 v3, s[4:7], s45 offen offset:1024 sc1 lds
    buffer_load_dwordx4 v3, s[4:7], s45 offen offset:2048 sc1 lds
    v_mov_b32 v39, v35
    s_nop 0
    v_permlane32_swap_b32 v32, v36
    v_permlane32_swap_b32 v33, v37
    v_permlane32_swap_b32 v34, v38
    v_permlane32_swap_b32 v35, v39
    v_add_f32 v32, v32, v36
    v_add_f32 v33, v33, v37
    v_add_f32 v34, v34, v38
    v_add_f32 v35, v35, v39
    v_mul_f32 v32, 0x3a800000, v32
    v_mul_f32 v33, 0x3a800000, v33
    s_waitcnt vmcnt(7)
    s_barrier
    s_add_u32 s49, s41, 14
    s_and_b32 s49, s49, 15
    s_mul_i32 s49, s49, 28672
    s_add_u32 s49, s49, s53
    s_add_u32 m0, s55, 57344
    s_add_u32 s45, s49, 14680064
    buffer_load_dwordx4 v3, s[4:7], s45 offen offset:0 sc1 lds
    buffer_load_dwordx4 v3, s[4:7], s45 offen offset:1024 sc1 lds
    buffer_load_dwordx4 v3, s[4:7], s45 offen offset:2048 sc1 lds
    buffer_load_dwordx4 v3, s[4:7], s45 offen offset:3072 sc1 lds
    s_add_u32 m0, s55, 61440
    s_add_u32 s45, s49, 14684160
    buffer_load_dwordx4 v3, s[4:7], s45 offen offset:0 sc1 lds
    buffer_load_dwordx4 v3, s[4:7], s45 offen offset:1024 sc1 lds
    buffer_load_dwordx4 v3, s[4:7], s45 offen offset:2048 sc1 lds
    v_mul_f32 v34, 0x3a800000, v34
    v_mul_f32 v35, 0x3a800000, v35
    v_fma_f32 v33, -v32, v32, v33
    v_max_f32 v33, 0, v33
    v_add_f32 v33, 0x3727c5ac, v33
    v_fma_f32 v35, -v34, v34, v35
    v_max_f32 v35, 0, v35
    v_add_f32 v35, 0x3727c5ac, v35
    v_rsq_f32 v36, v33
    v_rsq_f32 v37, v35
    s_nop 0
    s_waitcnt vmcnt(7)
    s_barrier
    s_add_u32 s49, s41, 15
    s_and_b32 s49, s49, 15
    s_mul_i32 s49, s49, 28672
    s_add_u32 s49, s49, s53
    s_add_u32 m0, s55, 86016
    s_add_u32 s45, s49, 14680064
    buffer_load_dwordx4 v3, s[4:7], s45 offen offset:0 sc1 lds
    buffer_load_dwordx4 v3, s[4:7], s45 offen offset:1024 sc1 lds
    buffer_load_dwordx4 v3, s[4:7], s45 offen offset:2048 sc1 lds
    buffer_load_dwordx4 v3, s[4:7], s45 offen offset:3072 sc1 lds
    s_add_u32 m0, s55, 90112
    s_add_u32 s45, s49, 14684160
    buffer_load_dwordx4 v3, s[4:7], s45 offen offset:0 sc1 lds
    buffer_load_dwordx4 v3, s[4:7], s45 offen offset:1024 sc1 lds
    buffer_load_dwordx4 v3, s[4:7], s45 offen offset:2048 sc1 lds
    v_mul_f32 v38, v32, v36
    v_sub_f32 v38, 0, v38
    v_mul_f32 v39, v34, v37
    v_sub_f32 v39, 0, v39
    v_and_b32 v13, 15, v0
    v_lshlrev_b32 v13, 3, v13
    s_lshl_b32 s54, s43, 8
    s_add_u32 s54, s54, 133120
    v_add_u32 v13, s54, v13
    ds_write_b64 v13, v[36:37]
    ds_write_b64 v13, v[38:39] offset:128
    s_waitcnt lgkmcnt(0)
    s_waitcnt vmcnt(7)
    s_barrier
    s_add_u32 m0, s52, 147456
    s_add_u32 s45, s51, 2359296
    buffer_load_dwordx4 v4, s[28:31], s45 offen offset:0  lds
    buffer_load_dwordx4 v5, s[28:31], s45 offen offset:1024  lds
    buffer_load_dwordx4 v6, s[28:31], s45 offen offset:2048  lds
    buffer_load_dwordx4 v7, s[28:31], s45 offen offset:3072  lds
    s_waitcnt vmcnt(4)
    s_barrier
    s_add_u32 m0, s52, 114688
    s_add_u32 s45, s51, 1835008
    buffer_load_dwordx4 v4, s[28:31], s45 offen offset:0  lds
    buffer_load_dwordx4 v5, s[28:31], s45 offen offset:1024  lds
    buffer_load_dwordx4 v6, s[28:31], s45 offen offset:2048  lds
    buffer_load_dwordx4 v7, s[28:31], s45 offen offset:3072  lds
    s_barrier
    s_add_u32 s45, s51, 1572864
    buffer_load_dwordx4 v[208:211], v4, s[28:31], s45 offen offset:0
    buffer_load_dwordx4 v[212:215], v5, s[28:31], s45 offen offset:1024
    buffer_load_dwordx4 v[216:219], v6, s[28:31], s45 offen offset:2048
    buffer_load_dwordx4 v[220:223], v7, s[28:31], s45 offen offset:3072
    s_add_u32 s45, s51, 1310720
    buffer_load_dwordx4 v[224:227], v4, s[28:31], s45 offen offset:0
    buffer_load_dwordx4 v[228:231], v5, s[28:31], s45 offen offset:1024
    buffer_load_dwordx4 v[232:235], v6, s[28:31], s45 offen offset:2048
    buffer_load_dwordx4 v[236:239], v7, s[28:31], s45 offen offset:3072
    s_add_u32 s45, s51, 1048576
    buffer_load_dwordx4 v[96:99], v4, s[28:31], s45 offen offset:0
    buffer_load_dwordx4 v[100:103], v5, s[28:31], s45 offen offset:1024
    buffer_load_dwordx4 v[104:107], v6, s[28:31], s45 offen offset:2048
    buffer_load_dwordx4 v[108:111], v7, s[28:31], s45 offen offset:3072
    s_add_u32 s45, s51, 786432
    buffer_load_dwordx4 v[112:115], v4, s[28:31], s45 offen offset:0
    buffer_load_dwordx4 v[116:119], v5, s[28:31], s45 offen offset:1024
    buffer_load_dwordx4 v[120:123], v6, s[28:31], s45 offen offset:2048
    buffer_load_dwordx4 v[124:127], v7, s[28:31], s45 offen offset:3072
    s_add_u32 s45, s51, 524288
    buffer_load_dwordx4 v[64:67], v4, s[28:31], s45 offen offset:0
    buffer_load_dwordx4 v[68:71], v5, s[28:31], s45 offen offset:1024
    buffer_load_dwordx4 v[72:75], v6, s[28:31], s45 offen offset:2048
    buffer_load_dwordx4 v[76:79], v7, s[28:31], s45 offen offset:3072
    s_add_u32 s45, s51, 262144
    buffer_load_dwordx4 v[80:83], v4, s[28:31], s45 offen offset:0
    buffer_load_dwordx4 v[84:87], v5, s[28:31], s45 offen offset:1024
    buffer_load_dwordx4 v[88:91], v6, s[28:31], s45 offen offset:2048
    buffer_load_dwordx4 v[92:95], v7, s[28:31], s45 offen offset:3072
    s_add_u32 s45, s51, 0
    buffer_load_dwordx4 v[240:243], v4, s[28:31], s45 offen offset:0
    buffer_load_dwordx4 v[244:247], v5, s[28:31], s45 offen offset:1024
    buffer_load_dwordx4 v[248:251], v6, s[28:31], s45 offen offset:2048
    buffer_load_dwordx4 v[252:255], v7, s[28:31], s45 offen offset:3072
    s_lshl_b32 s49, s41, 2
    s_add_u32 s49, s49, s43
    s_lshl_b32 s46, s49, 7
    s_add_u32 s46, s46, 1597440
    s_mov_b32 s57, 0
    s_and_b32 s47, s41, 0
    s_mov_b32 s58, 0xc4d3e2f1
    s_mov_b32 s59, 0x897a6b5
    s_mul_i32 s48, s40, 0x01010101
    s_lshr_b32 s45, s58, 4
    s_and_b32 s45, s45, 0x0f0f0f0f
    s_add_u32 s45, s45, s48
    s_and_b32 s45, s45, 0x0f0f0f0f
    s_lshl_b32 s45, s45, 4
    s_and_b32 s58, s58, 0x0f0f0f0f
    s_add_u32 s58, s58, s48
    s_and_b32 s58, s58, 0x0f0f0f0f
    s_or_b32 s58, s58, s45
    s_lshr_b32 s45, s59, 4
    s_and_b32 s45, s45, 0x0f0f0f0f
    s_add_u32 s45, s45, s48
    s_and_b32 s45, s45, 0x0f0f0f0f
    s_lshl_b32 s45, s45, 4
    s_and_b32 s59, s59, 0x0f0f0f0f
    s_add_u32 s59, s59, s48
    s_and_b32 s59, s59, 0x0f0f0f0f
    s_or_b32 s59, s59, s45
    v_mov_b32 v12, 140040
    s_mov_b32 s47, 2097152
adaLN_cond__grouped_kv_mqa__mixer_gmlp__prompt_kernel_lso:
    ds_read_b32 v13, v12
    s_sub_u32 s47, s47, 1
    s_waitcnt lgkmcnt(0)
    v_cmp_gt_u32 vcc, 4, v13
    s_cmp_eq_u32 s47, 0
    s_cbranch_scc1 adaLN_cond__grouped_kv_mqa__mixer_gmlp__prompt_kernel_lso_x
    s_cbranch_vccnz adaLN_cond__grouped_kv_mqa__mixer_gmlp__prompt_kernel_lso
adaLN_cond__grouped_kv_mqa__mixer_gmlp__prompt_kernel_lso_x:
    s_mov_b32 s47, 262144
    s_mov_b64 exec, 1
adaLN_cond__grouped_kv_mqa__mixer_gmlp__prompt_kernel_pz:
    v_mov_b32 v1, 0
    buffer_atomic_add v1, off, s[4:7], s46 sc0 sc1
    s_sub_u32 s47, s47, 1
    s_waitcnt vmcnt(0)
    v_cmp_gt_u32 vcc, 65535, v1
    s_cmp_eq_u32 s47, 0
    s_cbranch_scc1 adaLN_cond__grouped_kv_mqa__mixer_gmlp__prompt_kernel_pz_x
    s_cbranch_vccnz adaLN_cond__grouped_kv_mqa__mixer_gmlp__prompt_kernel_pz
adaLN_cond__grouped_kv_mqa__mixer_gmlp__prompt_kernel_pz_x:
    s_mov_b64 exec, -1
    s_mov_b32 s57, -1
    s_and_b32 s48, s58, 15
    s_lshr_b64 s[58:59], s[58:59], 4
    s_bitcmp1_b32 s57, s48
    s_cbranch_scc1 adaLN_cond__grouped_kv_mqa__mixer_gmlp__prompt_kernel_z1_x
    s_mov_b32 s47, 262144
    s_mov_b64 exec, 1
adaLN_cond__grouped_kv_mqa__mixer_gmlp__prompt_kernel_z1:
    v_mov_b32 v1, 0
    buffer_atomic_add v1, off, s[4:7], s46 sc0 sc1
    s_sub_u32 s47, s47, 1
    s_waitcnt vmcnt(0)
    v_readfirstlane_b32 s57, v1
    s_cmp_eq_u32 s47, 0
    s_cbranch_scc1 adaLN_cond__grouped_kv_mqa__mixer_gmlp__prompt_kernel_z1_y
    s_bitcmp1_b32 s57, s48
    s_cbranch_scc0 adaLN_cond__grouped_kv_mqa__mixer_gmlp__prompt_kernel_z1
adaLN_cond__grouped_kv_mqa__mixer_gmlp__prompt_kernel_z1_y:
    s_mov_b64 exec, -1
adaLN_cond__grouped_kv_mqa__mixer_gmlp__prompt_kernel_z1_x:
    s_mul_i32 s48, s48, 28672
    s_add_u32 s48, s48, s53
    s_add_u32 m0, s55, 28672
    s_add_u32 s45, s48, 23068672
    buffer_load_dwordx4 v3, s[4:7], s45 offen offset:0 sc1 lds
    buffer_load_dwordx4 v3, s[4:7], s45 offen offset:1024 sc1 lds
    buffer_load_dwordx4 v3, s[4:7], s45 offen offset:2048 sc1 lds
    buffer_load_dwordx4 v3, s[4:7], s45 offen offset:3072 sc1 lds
    s_add_u32 m0, s55, 32768
    s_add_u32 s45, s48, 23072768
    buffer_load_dwordx4 v3, s[4:7], s45 offen offset:0 sc1 lds
    buffer_load_dwordx4 v3, s[4:7], s45 offen offset:1024 sc1 lds
    buffer_load_dwordx4 v3, s[4:7], s45 offen offset:2048 sc1 lds
    s_and_b32 s48, s58, 15
    s_lshr_b64 s[58:59], s[58:59], 4
    s_bitcmp1_b32 s57, s48
    s_cbranch_scc1 adaLN_cond__grouped_kv_mqa__mixer_gmlp__prompt_kernel_z2_x
    s_mov_b32 s47, 262144
    s_mov_b64 exec, 1
adaLN_cond__grouped_kv_mqa__mixer_gmlp__prompt_kernel_z2:
    v_mov_b32 v1, 0
    buffer_atomic_add v1, off, s[4:7], s46 sc0 sc1
    s_sub_u32 s47, s47, 1
    s_waitcnt vmcnt(0)
    v_readfirstlane_b32 s57, v1
    s_cmp_eq_u32 s47, 0
    s_cbranch_scc1 adaLN_cond__grouped_kv_mqa__mixer_gmlp__prompt_kernel_z2_y
    s_bitcmp1_b32 s57, s48
    s_cbranch_scc0 adaLN_cond__grouped_kv_mqa__mixer_gmlp__prompt_kernel_z2
adaLN_cond__grouped_kv_mqa__mixer_gmlp__prompt_kernel_z2_y:
    s_mov_b64 exec, -1
adaLN_cond__grouped_kv_mqa__mixer_gmlp__prompt_kernel_z2_x:
    s_mul_i32 s48, s48, 28672
    s_add_u32 s48, s48, s53
    s_add_u32 m0, s55, 57344
    s_add_u32 s45, s48, 23068672
    buffer_load_dwordx4 v3, s[4:7], s45 offen offset:0 sc1 lds
    buffer_load_dwordx4 v3, s[4:7], s45 offen offset:1024 sc1 lds
    buffer_load_dwordx4 v3, s[4:7], s45 offen offset:2048 sc1 lds
    buffer_load_dwordx4 v3, s[4:7], s45 offen offset:3072 sc1 lds
    s_add_u32 m0, s55, 61440
    s_add_u32 s45, s48, 23072768
    buffer_load_dwordx4 v3, s[4:7], s45 offen offset:0 sc1 lds
    buffer_load_dwordx4 v3, s[4:7], s45 offen offset:1024 sc1 lds
    buffer_load_dwordx4 v3, s[4:7], s45 offen offset:2048 sc1 lds
    v_add_u32 v16, s52, v3
    v_add_u32 v17, 65536, v16
    v_add_u32 v18, 65536, v17
    s_waitcnt vmcnt(7)
    s_barrier
    s_and_b32 s48, s58, 15
    s_lshr_b64 s[58:59], s[58:59], 4
    s_bitcmp1_b32 s57, s48
    s_cbranch_scc1 adaLN_cond__grouped_kv_mqa__mixer_gmlp__prompt_kernel_z3_x
    s_mov_b32 s47, 262144
    s_mov_b64 exec, 1
adaLN_cond__grouped_kv_mqa__mixer_gmlp__prompt_kernel_z3:
    v_mov_b32 v1, 0
    buffer_atomic_add v1, off, s[4:7], s46 sc0 sc1
    s_sub_u32 s47, s47, 1
    s_waitcnt vmcnt(0)
    v_readfirstlane_b32 s57, v1
    s_cmp_eq_u32 s47, 0
    s_cbranch_scc1 adaLN_cond__grouped_kv_mqa__mixer_gmlp__prompt_kernel_z3_y
    s_bitcmp1_b32 s57, s48
    s_cbranch_scc0 adaLN_cond__grouped_kv_mqa__mixer_gmlp__prompt_kernel_z3
adaLN_cond__grouped_kv_mqa__mixer_gmlp__prompt_kernel_z3_y:
    s_mov_b64 exec, -1
adaLN_cond__grouped_kv_mqa__mixer_gmlp__prompt_kernel_z3_x:
    s_mul_i32 s48, s48, 28672
    s_add_u32 s48, s48, s53
    s_add_u32 m0, s55, 86016
    s_add_u32 s45, s48, 23068672
    buffer_load_dwordx4 v3, s[4:7], s45 offen offset:0 sc1 lds
    buffer_load_dwordx4 v3, s[4:7], s45 offen offset:1024 sc1 lds
    buffer_load_dwordx4 v3, s[4:7], s45 offen offset:2048 sc1 lds
    buffer_load_dwordx4 v3, s[4:7], s45 offen offset:3072 sc1 lds
    s_add_u32 m0, s55, 90112
    s_add_u32 s45, s48, 23072768
    buffer_load_dwordx4 v3, s[4:7], s45 offen offset:0 sc1 lds
    buffer_load_dwordx4 v3, s[4:7], s45 offen offset:1024 sc1 lds
    buffer_load_dwordx4 v3, s[4:7], s45 offen offset:2048 sc1 lds
    s_waitcnt vmcnt(7)
    s_barrier
    s_and_b32 s48, s58, 15
    s_lshr_b64 s[58:59], s[58:59], 4
    s_bitcmp1_b32 s57, s48
    s_cbranch_scc1 adaLN_cond__grouped_kv_mqa__mixer_gmlp__prompt_kernel_z4_x
    s_mov_b32 s47, 262144
    s_mov_b64 exec, 1
adaLN_cond__grouped_kv_mqa__mixer_gmlp__prompt_kernel_z4:
    v_mov_b32 v1, 0
    buffer_atomic_add v1, off, s[4:7], s46 sc0 sc1
    s_sub_u32 s47, s47, 1
    s_waitcnt vmcnt(0)
    v_readfirstlane_b32 s57, v1
    s_cmp_eq_u32 s47, 0
    s_cbranch_scc1 adaLN_cond__grouped_kv_mqa__mixer_gmlp__prompt_kernel_z4_y
    s_bitcmp1_b32 s57, s48
    s_cbranch_scc0 adaLN_cond__grouped_kv_mqa__mixer_gmlp__prompt_kernel_z4
adaLN_cond__grouped_kv_mqa__mixer_gmlp__prompt_kernel_z4_y:
    s_mov_b64 exec, -1
adaLN_cond__grouped_kv_mqa__mixer_gmlp__prompt_kernel_z4_x:
    s_mul_i32 s48, s48, 28672
    s_add_u32 s48, s48, s53
    s_add_u32 m0, s55, 0
    s_add_u32 s45, s48, 23068672
    buffer_load_dwordx4 v3, s[4:7], s45 offen offset:0 sc1 lds
    buffer_load_dwordx4 v3, s[4:7], s45 offen offset:1024 sc1 lds
    buffer_load_dwordx4 v3, s[4:7], s45 offen offset:2048 sc1 lds
    buffer_load_dwordx4 v3, s[4:7], s45 offen offset:3072 sc1 lds
    s_add_u32 m0, s55, 4096
    s_add_u32 s45, s48, 23072768
    buffer_load_dwordx4 v3, s[4:7], s45 offen offset:0 sc1 lds
    buffer_load_dwordx4 v3, s[4:7], s45 offen offset:1024 sc1 lds
    buffer_load_dwordx4 v3, s[4:7], s45 offen offset:2048 sc1 lds
    s_waitcnt vmcnt(7)
    s_barrier
    s_and_b32 s48, s58, 15
    s_lshr_b64 s[58:59], s[58:59], 4
    s_bitcmp1_b32 s57, s48
    s_cbranch_scc1 adaLN_cond__grouped_kv_mqa__mixer_gmlp__prompt_kernel_z5_x
    s_mov_b32 s47, 262144
    s_mov_b64 exec, 1
adaLN_cond__grouped_kv_mqa__mixer_gmlp__prompt_kernel_z5:
    v_mov_b32 v1, 0
    buffer_atomic_add v1, off, s[4:7], s46 sc0 sc1
    s_sub_u32 s47, s47, 1
    s_waitcnt vmcnt(0)
    v_readfirstlane_b32 s57, v1
    s_cmp_eq_u32 s47, 0
    s_cbranch_scc1 adaLN_cond__grouped_kv_mqa__mixer_gmlp__prompt_kernel_z5_y
    s_bitcmp1_b32 s57, s48
    s_cbranch_scc0 adaLN_cond__grouped_kv_mqa__mixer_gmlp__prompt_kernel_z5
adaLN_cond__grouped_kv_mqa__mixer_gmlp__prompt_kernel_z5_y:
    s_mov_b64 exec, -1
adaLN_cond__grouped_kv_mqa__mixer_gmlp__prompt_kernel_z5_x:
    s_mul_i32 s48, s48, 28672
    s_add_u32 s48, s48, s53
    s_add_u32 m0, s55, 28672
    s_add_u32 s45, s48, 23068672
    buffer_load_dwordx4 v3, s[4:7], s45 offen offset:0 sc1 lds
    buffer_load_dwordx4 v3, s[4:7], s45 offen offset:1024 sc1 lds
    buffer_load_dwordx4 v3, s[4:7], s45 offen offset:2048 sc1 lds
    buffer_load_dwordx4 v3, s[4:7], s45 offen offset:3072 sc1 lds
    s_add_u32 m0, s55, 32768
    s_add_u32 s45, s48, 23072768
    buffer_load_dwordx4 v3, s[4:7], s45 offen offset:0 sc1 lds
    buffer_load_dwordx4 v3, s[4:7], s45 offen offset:1024 sc1 lds
    buffer_load_dwordx4 v3, s[4:7], s45 offen offset:2048 sc1 lds
    s_waitcnt vmcnt(7)
    s_barrier
    s_and_b32 s48, s58, 15
    s_lshr_b64 s[58:59], s[58:59], 4
    s_bitcmp1_b32 s57, s48
    s_cbranch_scc1 adaLN_cond__grouped_kv_mqa__mixer_gmlp__prompt_kernel_z6_x
    s_mov_b32 s47, 262144
    s_mov_b64 exec, 1
adaLN_cond__grouped_kv_mqa__mixer_gmlp__prompt_kernel_z6:
    v_mov_b32 v1, 0
    buffer_atomic_add v1, off, s[4:7], s46 sc0 sc1
    s_sub_u32 s47, s47, 1
    s_waitcnt vmcnt(0)
    v_readfirstlane_b32 s57, v1
    s_cmp_eq_u32 s47, 0
    s_cbranch_scc1 adaLN_cond__grouped_kv_mqa__mixer_gmlp__prompt_kernel_z6_y
    s_bitcmp1_b32 s57, s48
    s_cbranch_scc0 adaLN_cond__grouped_kv_mqa__mixer_gmlp__prompt_kernel_z6
adaLN_cond__grouped_kv_mqa__mixer_gmlp__prompt_kernel_z6_y:
    s_mov_b64 exec, -1
adaLN_cond__grouped_kv_mqa__mixer_gmlp__prompt_kernel_z6_x:
    s_mul_i32 s48, s48, 28672
    s_add_u32 s48, s48, s53
    s_add_u32 m0, s55, 57344
    s_add_u32 s45, s48, 23068672
    buffer_load_dwordx4 v3, s[4:7], s45 offen offset:0 sc1 lds
    buffer_load_dwordx4 v3, s[4:7], s45 offen offset:1024 sc1 lds
    buffer_load_dwordx4 v3, s[4:7], s45 offen offset:2048 sc1 lds
    buffer_load_dwordx4 v3, s[4:7], s45 offen offset:3072 sc1 lds
    s_add_u32 m0, s55, 61440
    s_add_u32 s45, s48, 23072768
    buffer_load_dwordx4 v3, s[4:7], s45 offen offset:0 sc1 lds
    buffer_load_dwordx4 v3, s[4:7], s45 offen offset:1024 sc1 lds
    buffer_load_dwordx4 v3, s[4:7], s45 offen offset:2048 sc1 lds
    s_waitcnt vmcnt(7)
    s_barrier
    s_and_b32 s48, s58, 15
    s_lshr_b64 s[58:59], s[58:59], 4
    s_bitcmp1_b32 s57, s48
    s_cbranch_scc1 adaLN_cond__grouped_kv_mqa__mixer_gmlp__prompt_kernel_z7_x
    s_mov_b32 s47, 262144
    s_mov_b64 exec, 1
adaLN_cond__grouped_kv_mqa__mixer_gmlp__prompt_kernel_z7:
    v_mov_b32 v1, 0
    buffer_atomic_add v1, off, s[4:7], s46 sc0 sc1
    s_sub_u32 s47, s47, 1
    s_waitcnt vmcnt(0)
    v_readfirstlane_b32 s57, v1
    s_cmp_eq_u32 s47, 0
    s_cbranch_scc1 adaLN_cond__grouped_kv_mqa__mixer_gmlp__prompt_kernel_z7_y
    s_bitcmp1_b32 s57, s48
    s_cbranch_scc0 adaLN_cond__grouped_kv_mqa__mixer_gmlp__prompt_kernel_z7
adaLN_cond__grouped_kv_mqa__mixer_gmlp__prompt_kernel_z7_y:
    s_mov_b64 exec, -1
adaLN_cond__grouped_kv_mqa__mixer_gmlp__prompt_kernel_z7_x:
    s_mul_i32 s48, s48, 28672
    s_add_u32 s48, s48, s53
    s_add_u32 m0, s55, 86016
    s_add_u32 s45, s48, 23068672
    buffer_load_dwordx4 v3, s[4:7], s45 offen offset:0 sc1 lds
    buffer_load_dwordx4 v3, s[4:7], s45 offen offset:1024 sc1 lds
    buffer_load_dwordx4 v3, s[4:7], s45 offen offset:2048 sc1 lds
    buffer_load_dwordx4 v3, s[4:7], s45 offen offset:3072 sc1 lds
    s_add_u32 m0, s55, 90112
    s_add_u32 s45, s48, 23072768
    buffer_load_dwordx4 v3, s[4:7], s45 offen offset:0 sc1 lds
    buffer_load_dwordx4 v3, s[4:7], s45 offen offset:1024 sc1 lds
    buffer_load_dwordx4 v3, s[4:7], s45 offen offset:2048 sc1 lds
    s_waitcnt vmcnt(7)
    s_barrier
    s_and_b32 s48, s58, 15
    s_lshr_b64 s[58:59], s[58:59], 4
    s_bitcmp1_b32 s57, s48
    s_cbranch_scc1 adaLN_cond__grouped_kv_mqa__mixer_gmlp__prompt_kernel_z8_x
    s_mov_b32 s47, 262144
    s_mov_b64 exec, 1
adaLN_cond__grouped_kv_mqa__mixer_gmlp__prompt_kernel_z8:
    v_mov_b32 v1, 0
    buffer_atomic_add v1, off, s[4:7], s46 sc0 sc1
    s_sub_u32 s47, s47, 1
    s_waitcnt vmcnt(0)
    v_readfirstlane_b32 s57, v1
    s_cmp_eq_u32 s47, 0
    s_cbranch_scc1 adaLN_cond__grouped_kv_mqa__mixer_gmlp__prompt_kernel_z8_y
    s_bitcmp1_b32 s57, s48
    s_cbranch_scc0 adaLN_cond__grouped_kv_mqa__mixer_gmlp__prompt_kernel_z8
adaLN_cond__grouped_kv_mqa__mixer_gmlp__prompt_kernel_z8_y:
    s_mov_b64 exec, -1
adaLN_cond__grouped_kv_mqa__mixer_gmlp__prompt_kernel_z8_x:
    s_mul_i32 s48, s48, 28672
    s_add_u32 s48, s48, s53
    s_add_u32 m0, s55, 0
    s_add_u32 s45, s48, 23068672
    buffer_load_dwordx4 v3, s[4:7], s45 offen offset:0 sc1 lds
    buffer_load_dwordx4 v3, s[4:7], s45 offen offset:1024 sc1 lds
    buffer_load_dwordx4 v3, s[4:7], s45 offen offset:2048 sc1 lds
    buffer_load_dwordx4 v3, s[4:7], s45 offen offset:3072 sc1 lds
    s_add_u32 m0, s55, 4096
    s_add_u32 s45, s48, 23072768
    buffer_load_dwordx4 v3, s[4:7], s45 offen offset:0 sc1 lds
    buffer_load_dwordx4 v3, s[4:7], s45 offen offset:1024 sc1 lds
    buffer_load_dwordx4 v3, s[4:7], s45 offen offset:2048 sc1 lds
    s_waitcnt vmcnt(7)
    s_barrier
    s_and_b32 s48, s58, 15
    s_lshr_b64 s[58:59], s[58:59], 4
    s_bitcmp1_b32 s57, s48
    s_cbranch_scc1 adaLN_cond__grouped_kv_mqa__mixer_gmlp__prompt_kernel_z9_x
    s_mov_b32 s47, 262144
    s_mov_b64 exec, 1
adaLN_cond__grouped_kv_mqa__mixer_gmlp__prompt_kernel_z9:
    v_mov_b32 v1, 0
    buffer_atomic_add v1, off, s[4:7], s46 sc0 sc1
    s_sub_u32 s47, s47, 1
    s_waitcnt vmcnt(0)
    v_readfirstlane_b32 s57, v1
    s_cmp_eq_u32 s47, 0
    s_cbranch_scc1 adaLN_cond__grouped_kv_mqa__mixer_gmlp__prompt_kernel_z9_y
    s_bitcmp1_b32 s57, s48
    s_cbranch_scc0 adaLN_cond__grouped_kv_mqa__mixer_gmlp__prompt_kernel_z9
adaLN_cond__grouped_kv_mqa__mixer_gmlp__prompt_kernel_z9_y:
    s_mov_b64 exec, -1
adaLN_cond__grouped_kv_mqa__mixer_gmlp__prompt_kernel_z9_x:
    s_mul_i32 s48, s48, 28672
    s_add_u32 s48, s48, s53
    s_add_u32 m0, s55, 28672
    s_add_u32 s45, s48, 23068672
    buffer_load_dwordx4 v3, s[4:7], s45 offen offset:0 sc1 lds
    buffer_load_dwordx4 v3, s[4:7], s45 offen offset:1024 sc1 lds
    buffer_load_dwordx4 v3, s[4:7], s45 offen offset:2048 sc1 lds
    buffer_load_dwordx4 v3, s[4:7], s45 offen offset:3072 sc1 lds
    s_add_u32 m0, s55, 32768
    s_add_u32 s45, s48, 23072768
    buffer_load_dwordx4 v3, s[4:7], s45 offen offset:0 sc1 lds
    buffer_load_dwordx4 v3, s[4:7], s45 offen offset:1024 sc1 lds
    buffer_load_dwordx4 v3, s[4:7], s45 offen offset:2048 sc1 lds
    s_waitcnt vmcnt(7)
    s_barrier
    s_and_b32 s48, s58, 15
    s_lshr_b64 s[58:59], s[58:59], 4
    s_bitcmp1_b32 s57, s48
    s_cbranch_scc1 adaLN_cond__grouped_kv_mqa__mixer_gmlp__prompt_kernel_z10_x
    s_mov_b32 s47, 262144
    s_mov_b64 exec, 1
adaLN_cond__grouped_kv_mqa__mixer_gmlp__prompt_kernel_z10:
    v_mov_b32 v1, 0
    buffer_atomic_add v1, off, s[4:7], s46 sc0 sc1
    s_sub_u32 s47, s47, 1
    s_waitcnt vmcnt(0)
    v_readfirstlane_b32 s57, v1
    s_cmp_eq_u32 s47, 0
    s_cbranch_scc1 adaLN_cond__grouped_kv_mqa__mixer_gmlp__prompt_kernel_z10_y
    s_bitcmp1_b32 s57, s48
    s_cbranch_scc0 adaLN_cond__grouped_kv_mqa__mixer_gmlp__prompt_kernel_z10
adaLN_cond__grouped_kv_mqa__mixer_gmlp__prompt_kernel_z10_y:
    s_mov_b64 exec, -1
adaLN_cond__grouped_kv_mqa__mixer_gmlp__prompt_kernel_z10_x:
    s_mul_i32 s48, s48, 28672
    s_add_u32 s48, s48, s53
    s_add_u32 m0, s55, 57344
    s_add_u32 s45, s48, 23068672
    buffer_load_dwordx4 v3, s[4:7], s45 offen offset:0 sc1 lds
    buffer_load_dwordx4 v3, s[4:7], s45 offen offset:1024 sc1 lds
    buffer_load_dwordx4 v3, s[4:7], s45 offen offset:2048 sc1 lds
    buffer_load_dwordx4 v3, s[4:7], s45 offen offset:3072 sc1 lds
    s_add_u32 m0, s55, 61440
    s_add_u32 s45, s48, 23072768
    buffer_load_dwordx4 v3, s[4:7], s45 offen offset:0 sc1 lds
    buffer_load_dwordx4 v3, s[4:7], s45 offen offset:1024 sc1 lds
    buffer_load_dwordx4 v3, s[4:7], s45 offen offset:2048 sc1 lds
    s_waitcnt vmcnt(7)
    s_barrier
    s_and_b32 s48, s58, 15
    s_lshr_b64 s[58:59], s[58:59], 4
    s_bitcmp1_b32 s57, s48
    s_cbranch_scc1 adaLN_cond__grouped_kv_mqa__mixer_gmlp__prompt_kernel_z11_x
    s_mov_b32 s47, 262144
    s_mov_b64 exec, 1
adaLN_cond__grouped_kv_mqa__mixer_gmlp__prompt_kernel_z11:
    v_mov_b32 v1, 0
    buffer_atomic_add v1, off, s[4:7], s46 sc0 sc1
    s_sub_u32 s47, s47, 1
    s_waitcnt vmcnt(0)
    v_readfirstlane_b32 s57, v1
    s_cmp_eq_u32 s47, 0
    s_cbranch_scc1 adaLN_cond__grouped_kv_mqa__mixer_gmlp__prompt_kernel_z11_y
    s_bitcmp1_b32 s57, s48
    s_cbranch_scc0 adaLN_cond__grouped_kv_mqa__mixer_gmlp__prompt_kernel_z11
adaLN_cond__grouped_kv_mqa__mixer_gmlp__prompt_kernel_z11_y:
    s_mov_b64 exec, -1
adaLN_cond__grouped_kv_mqa__mixer_gmlp__prompt_kernel_z11_x:
    s_mul_i32 s48, s48, 28672
    s_add_u32 s48, s48, s53
    s_add_u32 m0, s55, 86016
    s_add_u32 s45, s48, 23068672
    buffer_load_dwordx4 v3, s[4:7], s45 offen offset:0 sc1 lds
    buffer_load_dwordx4 v3, s[4:7], s45 offen offset:1024 sc1 lds
    buffer_load_dwordx4 v3, s[4:7], s45 offen offset:2048 sc1 lds
    buffer_load_dwordx4 v3, s[4:7], s45 offen offset:3072 sc1 lds
    s_add_u32 m0, s55, 90112
    s_add_u32 s45, s48, 23072768
    buffer_load_dwordx4 v3, s[4:7], s45 offen offset:0 sc1 lds
    buffer_load_dwordx4 v3, s[4:7], s45 offen offset:1024 sc1 lds
    buffer_load_dwordx4 v3, s[4:7], s45 offen offset:2048 sc1 lds
    s_waitcnt vmcnt(7)
    s_barrier
    s_and_b32 s48, s58, 15
    s_lshr_b64 s[58:59], s[58:59], 4
    s_bitcmp1_b32 s57, s48
    s_cbranch_scc1 adaLN_cond__grouped_kv_mqa__mixer_gmlp__prompt_kernel_z12_x
    s_mov_b32 s47, 262144
    s_mov_b64 exec, 1
adaLN_cond__grouped_kv_mqa__mixer_gmlp__prompt_kernel_z12:
    v_mov_b32 v1, 0
    buffer_atomic_add v1, off, s[4:7], s46 sc0 sc1
    s_sub_u32 s47, s47, 1
    s_waitcnt vmcnt(0)
    v_readfirstlane_b32 s57, v1
    s_cmp_eq_u32 s47, 0
    s_cbranch_scc1 adaLN_cond__grouped_kv_mqa__mixer_gmlp__prompt_kernel_z12_y
    s_bitcmp1_b32 s57, s48
    s_cbranch_scc0 adaLN_cond__grouped_kv_mqa__mixer_gmlp__prompt_kernel_z12
adaLN_cond__grouped_kv_mqa__mixer_gmlp__prompt_kernel_z12_y:
    s_mov_b64 exec, -1
adaLN_cond__grouped_kv_mqa__mixer_gmlp__prompt_kernel_z12_x:
    s_mul_i32 s48, s48, 28672
    s_add_u32 s48, s48, s53
    s_add_u32 m0, s55, 0
    s_add_u32 s45, s48, 23068672
    buffer_load_dwordx4 v3, s[4:7], s45 offen offset:0 sc1 lds
    buffer_load_dwordx4 v3, s[4:7], s45 offen offset:1024 sc1 lds
    buffer_load_dwordx4 v3, s[4:7], s45 offen offset:2048 sc1 lds
    buffer_load_dwordx4 v3, s[4:7], s45 offen offset:3072 sc1 lds
    s_add_u32 m0, s55, 4096
    s_add_u32 s45, s48, 23072768
    buffer_load_dwordx4 v3, s[4:7], s45 offen offset:0 sc1 lds
    buffer_load_dwordx4 v3, s[4:7], s45 offen offset:1024 sc1 lds
    buffer_load_dwordx4 v3, s[4:7], s45 offen offset:2048 sc1 lds
    s_waitcnt vmcnt(7)
    s_barrier
    s_and_b32 s48, s58, 15
    s_lshr_b64 s[58:59], s[58:59], 4
    s_bitcmp1_b32 s57, s48
    s_cbranch_scc1 adaLN_cond__grouped_kv_mqa__mixer_gmlp__prompt_kernel_z13_x
    s_mov_b32 s47, 262144
    s_mov_b64 exec, 1
adaLN_cond__grouped_kv_mqa__mixer_gmlp__prompt_kernel_z13:
    v_mov_b32 v1, 0
    buffer_atomic_add v1, off, s[4:7], s46 sc0 sc1
    s_sub_u32 s47, s47, 1
    s_waitcnt vmcnt(0)
    v_readfirstlane_b32 s57, v1
    s_cmp_eq_u32 s47, 0
    s_cbranch_scc1 adaLN_cond__grouped_kv_mqa__mixer_gmlp__prompt_kernel_z13_y
    s_bitcmp1_b32 s57, s48
    s_cbranch_scc0 adaLN_cond__grouped_kv_mqa__mixer_gmlp__prompt_kernel_z13
adaLN_cond__grouped_kv_mqa__mixer_gmlp__prompt_kernel_z13_y:
    s_mov_b64 exec, -1
adaLN_cond__grouped_kv_mqa__mixer_gmlp__prompt_kernel_z13_x:
    s_mul_i32 s48, s48, 28672
    s_add_u32 s48, s48, s53
    s_add_u32 m0, s55, 28672
    s_add_u32 s45, s48, 23068672
    buffer_load_dwordx4 v3, s[4:7], s45 offen offset:0 sc1 lds
    buffer_load_dwordx4 v3, s[4:7], s45 offen offset:1024 sc1 lds
    buffer_load_dwordx4 v3, s[4:7], s45 offen offset:2048 sc1 lds
    buffer_load_dwordx4 v3, s[4:7], s45 offen offset:3072 sc1 lds
    s_add_u32 m0, s55, 32768
    s_add_u32 s45, s48, 23072768
    buffer_load_dwordx4 v3, s[4:7], s45 offen offset:0 sc1 lds
    buffer_load_dwordx4 v3, s[4:7], s45 offen offset:1024 sc1 lds
    buffer_load_dwordx4 v3, s[4:7], s45 offen offset:2048 sc1 lds
    s_waitcnt vmcnt(7)
    s_barrier
    s_and_b32 s48, s58, 15
    s_lshr_b64 s[58:59], s[58:59], 4
    s_bitcmp1_b32 s57, s48
    s_cbranch_scc1 adaLN_cond__grouped_kv_mqa__mixer_gmlp__prompt_kernel_z14_x
    s_mov_b32 s47, 262144
    s_mov_b64 exec, 1
adaLN_cond__grouped_kv_mqa__mixer_gmlp__prompt_kernel_z14:
    v_mov_b32 v1, 0
    buffer_atomic_add v1, off, s[4:7], s46 sc0 sc1
    s_sub_u32 s47, s47, 1
    s_waitcnt vmcnt(0)
    v_readfirstlane_b32 s57, v1
    s_cmp_eq_u32 s47, 0
    s_cbranch_scc1 adaLN_cond__grouped_kv_mqa__mixer_gmlp__prompt_kernel_z14_y
    s_bitcmp1_b32 s57, s48
    s_cbranch_scc0 adaLN_cond__grouped_kv_mqa__mixer_gmlp__prompt_kernel_z14
adaLN_cond__grouped_kv_mqa__mixer_gmlp__prompt_kernel_z14_y:
    s_mov_b64 exec, -1
adaLN_cond__grouped_kv_mqa__mixer_gmlp__prompt_kernel_z14_x:
    s_mul_i32 s48, s48, 28672
    s_add_u32 s48, s48, s53
    s_add_u32 m0, s55, 57344
    s_add_u32 s45, s48, 23068672
    buffer_load_dwordx4 v3, s[4:7], s45 offen offset:0 sc1 lds
    buffer_load_dwordx4 v3, s[4:7], s45 offen offset:1024 sc1 lds
    buffer_load_dwordx4 v3, s[4:7], s45 offen offset:2048 sc1 lds
    buffer_load_dwordx4 v3, s[4:7], s45 offen offset:3072 sc1 lds
    s_add_u32 m0, s55, 61440
    s_add_u32 s45, s48, 23072768
    buffer_load_dwordx4 v3, s[4:7], s45 offen offset:0 sc1 lds
    buffer_load_dwordx4 v3, s[4:7], s45 offen offset:1024 sc1 lds
    buffer_load_dwordx4 v3, s[4:7], s45 offen offset:2048 sc1 lds
    s_waitcnt vmcnt(7)
    s_barrier
    s_and_b32 s48, s58, 15
    s_lshr_b64 s[58:59], s[58:59], 4
    s_bitcmp1_b32 s57, s48
    s_cbranch_scc1 adaLN_cond__grouped_kv_mqa__mixer_gmlp__prompt_kernel_z15_x
    s_mov_b32 s47, 262144
    s_mov_b64 exec, 1
adaLN_cond__grouped_kv_mqa__mixer_gmlp__prompt_kernel_z15:
    v_mov_b32 v1, 0
    buffer_atomic_add v1, off, s[4:7], s46 sc0 sc1
    s_sub_u32 s47, s47, 1
    s_waitcnt vmcnt(0)
    v_readfirstlane_b32 s57, v1
    s_cmp_eq_u32 s47, 0
    s_cbranch_scc1 adaLN_cond__grouped_kv_mqa__mixer_gmlp__prompt_kernel_z15_y
    s_bitcmp1_b32 s57, s48
    s_cbranch_scc0 adaLN_cond__grouped_kv_mqa__mixer_gmlp__prompt_kernel_z15
adaLN_cond__grouped_kv_mqa__mixer_gmlp__prompt_kernel_z15_y:
    s_mov_b64 exec, -1
adaLN_cond__grouped_kv_mqa__mixer_gmlp__prompt_kernel_z15_x:
    s_mul_i32 s48, s48, 28672
    s_add_u32 s48, s48, s53
    s_add_u32 m0, s55, 86016
    s_add_u32 s45, s48, 23068672
    buffer_load_dwordx4 v3, s[4:7], s45 offen offset:0 sc1 lds
    buffer_load_dwordx4 v3, s[4:7], s45 offen offset:1024 sc1 lds
    buffer_load_dwordx4 v3, s[4:7], s45 offen offset:2048 sc1 lds
    buffer_load_dwordx4 v3, s[4:7], s45 offen offset:3072 sc1 lds
    s_add_u32 m0, s55, 90112
    s_add_u32 s45, s48, 23072768
    buffer_load_dwordx4 v3, s[4:7], s45 offen offset:0 sc1 lds
    buffer_load_dwordx4 v3, s[4:7], s45 offen offset:1024 sc1 lds
    buffer_load_dwordx4 v3, s[4:7], s45 offen offset:2048 sc1 lds
    s_waitcnt vmcnt(7)
    s_barrier
    s_waitcnt vmcnt(0)
    s_barrier
    s_barrier
    ds_write_b128 v16, v[240:243] offset:0
    ds_write_b128 v16, v[244:247] offset:1024
    ds_write_b128 v16, v[248:251] offset:2048
    ds_write_b128 v16, v[252:255] offset:3072
    ds_write_b128 v16, v[80:83] offset:16384
    ds_write_b128 v16, v[84:87] offset:17408
    ds_write_b128 v16, v[88:91] offset:18432
    ds_write_b128 v16, v[92:95] offset:19456
    ds_write_b128 v16, v[64:67] offset:32768
    ds_write_b128 v16, v[68:71] offset:33792
    ds_write_b128 v16, v[72:75] offset:34816
    ds_write_b128 v16, v[76:79] offset:35840
    ds_write_b128 v16, v[112:115] offset:49152
    ds_write_b128 v16, v[116:119] offset:50176
    ds_write_b128 v16, v[120:123] offset:51200
    ds_write_b128 v16, v[124:127] offset:52224
    ds_write_b128 v17, v[96:99] offset:0
    ds_write_b128 v17, v[100:103] offset:1024
    ds_write_b128 v17, v[104:107] offset:2048
    ds_write_b128 v17, v[108:111] offset:3072
    ds_write_b128 v17, v[224:227] offset:16384
    ds_write_b128 v17, v[228:231] offset:17408
    ds_write_b128 v17, v[232:235] offset:18432
    ds_write_b128 v17, v[236:239] offset:19456
    s_waitcnt lgkmcnt(0)
    s_waitcnt lgkmcnt(0)
    s_barrier
    ds_write_b128 v17, v[208:211] offset:32768
    ds_write_b128 v17, v[212:215] offset:33792
    ds_write_b128 v17, v[216:219] offset:34816
    ds_write_b128 v17, v[220:223] offset:35840
    ds_write_b128 v18, v[192:195] offset:0
    ds_write_b128 v18, v[196:199] offset:1024
    ds_write_b128 v18, v[200:203] offset:2048
    ds_write_b128 v18, v[204:207] offset:3072
    s_waitcnt lgkmcnt(0)
    s_barrier
    s_barrier
    ds_write_b128 v16, v[176:179] offset:0
    ds_write_b128 v16, v[180:183] offset:1024
    ds_write_b128 v16, v[184:187] offset:2048
    ds_write_b128 v16, v[188:191] offset:3072
    ds_write_b128 v16, v[160:163] offset:16384
    ds_write_b128 v16, v[164:167] offset:17408
    ds_write_b128 v16, v[168:171] offset:18432
    ds_write_b128 v16, v[172:175] offset:19456
    s_waitcnt lgkmcnt(0)
    s_barrier
    ds_write_b128 v16, v[144:147] offset:32768
    ds_write_b128 v16, v[148:151] offset:33792
    ds_write_b128 v16, v[152:155] offset:34816
    ds_write_b128 v16, v[156:159] offset:35840
    ds_write_b128 v16, v[128:131] offset:49152
    ds_write_b128 v16, v[132:135] offset:50176
    ds_write_b128 v16, v[136:139] offset:51200
    ds_write_b128 v16, v[140:143] offset:52224
    s_waitcnt lgkmcnt(0)
    s_barrier
    s_barrier
    s_barrier
    s_barrier
adaLN_cond__grouped_kv_mqa__mixer_gmlp__prompt_kernel_end:
    s_endpgm
.section .rodata,"a"
.p2align 6
.amdhsa_kernel adaLN_cond__grouped_kv_mqa__mixer_gmlp__prompt_kernel
  .amdhsa_next_free_vgpr 256
  .amdhsa_next_free_sgpr 102
  .amdhsa_accum_offset 256
  .amdhsa_group_segment_fixed_size 0
  .amdhsa_kernarg_size 120
  .amdhsa_user_sgpr_count 2
  .amdhsa_user_sgpr_kernarg_segment_ptr 1
  .amdhsa_system_sgpr_workgroup_id_x 1
.end_amdhsa_kernel
```
